```python
import torch

def _softmax(x, axis=-1):
    return torch.softmax(x, dim=axis)
def _gelu(x):
    return torch.nn.functional.gelu(x, approximate="tanh")
def _silu(x):
    return torch.nn.functional.silu(x)
def _sigmoid(x):
    return torch.sigmoid(x)
def _layernorm(x, axis=-1, eps=1e-5):
    m = x.mean(dim=axis, keepdim=True)
    v = x.var(dim=axis, keepdim=True, unbiased=False)
    return (x - m) / torch.sqrt(v + eps)
def _scatter_add(tgt, idx, src, axis=0):
    return tgt.clone().index_add_(axis, idx, src)
def _segment_sum(src, seg, n):
    out = torch.zeros((n,) + src.shape[1:], dtype=src.dtype)
    return out.index_add_(0, seg, src)
def _pad(x, pw):
    flat = tuple(v for pair in reversed(pw) for v in pair)
    return torch.nn.functional.pad(x, flat)

kernel_name = 'sequential_preLN__linear_kernel_hedgehog__mixer_s_mlp__prompt'

def setup_inputs():

    _w = (lambda a: (lambda t: t.to(torch.bfloat16) if t.is_floating_point() else t)(torch.as_tensor(a)))
    def _A_setup():
        B, S, D, H = 1, 2048, 512, 32
        Dh = D // H
        return {
            "x": _w((lambda *s: torch.randn(*s, dtype=torch.bfloat16) * 0.05)(B, S, D)),
            "wqkv": _w((lambda *s: torch.randn(*s, dtype=torch.bfloat16) * 0.2)(D, 3 * D)),
            "w_phi": _w((lambda *s: torch.randn(*s, dtype=torch.bfloat16) * 0.2)(H, Dh, Dh) * (Dh ** -0.5)),
            "wo": _w((lambda *s: torch.randn(*s, dtype=torch.bfloat16) * 0.05)(D, D)),
        }
    _A_in = _A_setup()

    def _B_setup():
        B, S, D, F = 1, 2048, 512, 1376
        return {
            "x":  _w((lambda *s: torch.randn(*s, dtype=torch.bfloat16) * 0.05)(B, S, D)),
            "w1": _w((lambda *s: torch.randn(*s, dtype=torch.bfloat16) * 3.2)(D, D) * (D ** -0.5)),
            "w2": _w((lambda *s: torch.randn(*s, dtype=torch.bfloat16) * 3.2)(D, D) * (D ** -0.5)),
            "w3": _w((lambda *s: torch.randn(*s, dtype=torch.bfloat16) * 3.2)(D, F) * (D ** -0.5)),
            "w4": _w((lambda *s: torch.randn(*s, dtype=torch.bfloat16) * 3.2)(F, D) * (F ** -0.5)),
        }
    _B_in = _B_setup()

    return {
        "A_x": _A_in["x"],
        "A_wqkv": _A_in["wqkv"],
        "A_w_phi": _A_in["w_phi"],
        "A_wo": _A_in["wo"],
        "B_x": _B_in["x"],
        "B_w1": _B_in["w1"],
        "B_w2": _B_in["w2"],
        "B_w3": _B_in["w3"],
        "B_w4": _B_in["w4"],
    }

def reference(A_x, A_wqkv, A_w_phi, A_wo, B_x, B_w1, B_w2, B_w3, B_w4):
    def _A_ref(x, wqkv, w_phi, wo):
        B, S, D = x.shape
        H = 32; Dh = D // H
        qkv = (lambda x, *d: x.permute(*d))((x @ wqkv).reshape(B, S, 3, H, Dh), 2, 0, 3, 1, 4)
        q, k, v = qkv[0], qkv[1], qkv[2]
        pq = torch.einsum("bhsd,hdf->bhsf", q, w_phi)
        pk = torch.einsum("bhsd,hdf->bhsf", k, w_phi)
        phi_q = torch.concatenate([_softmax(pq, axis=-1), _softmax(-pq, axis=-1)], axis=-1)
        phi_k = torch.concatenate([_softmax(pk, axis=-1), _softmax(-pk, axis=-1)], axis=-1)
        kv = torch.einsum("bhsf,bhsd->bhfd", phi_k, v)
        z  = torch.einsum("bhsf->bhf", phi_k)
        num = torch.einsum("bhqf,bhfd->bhqd", phi_q, kv)
        den = torch.einsum("bhqf,bhf->bhq", phi_q, z)[..., None] + 1e-6
        o = num / den
        return (lambda x, *d: x.permute(*d))(o, 0, 2, 1, 3).reshape(B, S, D) @ wo

    def _B_ref(x, w1, w2, w3, w4):
        B, S, D = x.shape
        h = _gelu(_layernorm(x, axis=-1) @ w1)
        c = D // 4
        g0 = _pad(h[:, :, 0*c:1*c], ((0, 0), (1, 0), (0, 0)))[:, :S, :]
        g1 = _pad(h[:, :, 1*c:2*c], ((0, 0), (0, 1), (0, 0)))[:, 1:, :]
        g2 = _pad(h[:, :, 2*c:3*c], ((0, 0), (2, 0), (0, 0)))[:, :S, :]
        g3 = _pad(h[:, :, 3*c:   ], ((0, 0), (0, 2), (0, 0)))[:, 2:, :]
        hs = torch.concatenate([g0, g1, g2, g3], axis=-1) @ w2
        x1 = x + hs
        h2 = _gelu(_layernorm(x1, axis=-1) @ w3) @ w4
        return x1 + h2

    x = A_x
    h = x + _A_ref(_layernorm(x, axis=-1), A_wqkv, A_w_phi, A_wo)
    h2 = h + _B_ref(_layernorm(h, axis=-1), B_w1, B_w2, B_w3, B_w4)
    return h2
```

```asm
; @launch grid=(256,1,1) block=(256,1,1) lds=163840
.amdgcn_target "amdgcn-amd-amdhsa--gfx950"
.text
.globl sequential_preLN__linear_kernel_hedgehog__mixer_s_mlp__prompt_kernel
.p2align 8
.type sequential_preLN__linear_kernel_hedgehog__mixer_s_mlp__prompt_kernel,@function
sequential_preLN__linear_kernel_hedgehog__mixer_s_mlp__prompt_kernel:
    s_cmp_ge_u32 s2, 256
    s_cbranch_scc1 L_end
    s_load_dwordx16 s[32:47], s[0:1], 0
    s_load_dwordx8 s[48:55], s[0:1], 64
    v_and_b32 v1, 63, v0
    v_lshrrev_b32 v5, 6, v0
    s_nop 0
    v_readfirstlane_b32 s28, v5
    s_nop 3
    s_nop 0
    s_getpc_b64 s[96:97]
L_pcbase:
    s_lshr_b32 s56, s2, 3
    s_lshl_b32 s56, s56, 2
    s_add_u32 s56, s56, s28
    s_lshl_b32 s56, s56, 10
    v_lshlrev_b32 v7, 7, v1
    v_add_u32 v7, s56, v7
    s_mov_b32 s57, L_code_end-L_pcbase-128
    v_min_u32 v7, s57, v7
    s_mov_b32 m0, 163584
    s_mov_b64 exec, 0xff
    global_load_lds_dword v7, s[96:97]
    s_mov_b64 exec, -1
    s_nop 0
    v_and_b32 v2, 31, v1
    v_lshrrev_b32 v3, 5, v1
    v_lshlrev_b32 v4, 4, v1
    s_and_b32 s56, s2, 7
    s_lshr_b32 s57, s2, 3
    s_and_b32 s26, s57, 7
    s_lshr_b32 s27, s57, 3
    s_lshl_b32 s25, s56, 2
    s_add_u32 s25, s25, s27
    s_lshl_b32 s30, s27, 1
    s_add_u32 s30, s30, s26
    s_and_b32 s30, s30, 7
    s_lshr_b32 s62, s28, 1
    s_and_b32 s63, s28, 1
    s_lshl_b32 s31, s25, 16
    s_lshl_b32 s60, s28, 11
    s_lshl_b32 s61, s26, 7
    v_lshrrev_b32 v5, 3, v1
    v_and_b32 v6, 7, v1
    v_lshrrev_b32 v7, 4, v1
    s_lshl_b32 s56, s28, 4
    v_add_u32 v8, s56, v5
    v_xor_b32 v9, v6, v7
    v_lshlrev_b32 v9, 4, v9
    v_lshl_add_u32 v26, v8, 10, v9
    v_add_u32 v10, 4, v7
    v_xor_b32 v9, v6, v10
    v_lshlrev_b32 v9, 4, v9
    v_add_u32 v10, 8, v8
    v_lshl_add_u32 v27, v10, 10, v9
    v_subrev_u32 v27, 1024, v27
    v_and_b32 v9, 2, v5
    v_lshlrev_b32 v9, 1, v9
    v_xor_b32 v9, v6, v9
    v_lshlrev_b32 v9, 4, v9
    v_mul_u32_u24 v10, 3072, v8
    v_add_u32 v28, v10, v9
    v_add_u32 v29, 23552, v28
    s_waitcnt lgkmcnt(0)
    s_mov_b32 s4, s32
    s_and_b32 s5, s33, 0xffff
    s_mov_b32 s6, 0x200000
    s_mov_b32 s7, 0x20000
    s_mov_b32 s8, s34
    s_and_b32 s9, s35, 0xffff
    s_mov_b32 s10, 0x180000
    s_mov_b32 s11, 0x20000
    s_mov_b32 s16, s36
    s_and_b32 s17, s37, 0xffff
    s_mov_b32 s18, 0x4000
    s_mov_b32 s19, 0x20000
    s_lshl_b32 s57, s30, 7
    s_add_u32 s32, s57, s31
    s_mul_i32 s56, s30, 196608
    s_add_u32 s40, s56, s61
    s_add_u32 s56, s30, 1
    s_and_b32 s56, s56, 7
    s_lshl_b32 s57, s56, 7
    s_add_u32 s33, s57, s31
    s_mul_i32 s56, s56, 196608
    s_add_u32 s41, s56, s61
    s_add_u32 m0, s60, 0
    s_nop 0
    buffer_load_dwordx4 v26, s[4:7], s32 offen lds
    buffer_load_dwordx4 v27, s[4:7], s32 offen offset:1024 lds
    s_add_u32 s56, s40, 1024
    s_add_u32 m0, s60, 8192
    s_nop 0
    buffer_load_dwordx4 v28, s[8:11], s56 offen lds
    buffer_load_dwordx4 v29, s[8:11], s56 offen offset:1024 lds
    s_add_u32 m0, s60, 16384
    s_nop 0
    buffer_load_dwordx4 v26, s[4:7], s33 offen lds
    buffer_load_dwordx4 v27, s[4:7], s33 offen offset:1024 lds
    s_add_u32 s56, s41, 1024
    s_add_u32 m0, s60, 24576
    s_nop 0
    buffer_load_dwordx4 v28, s[8:11], s56 offen lds
    buffer_load_dwordx4 v29, s[8:11], s56 offen offset:1024 lds
    s_lshl_b32 s56, s26, 11
    s_and_b32 s57, s28, 1
    s_lshl_b32 s57, s57, 10
    s_add_u32 s56, s56, s57
    s_add_u32 m0, s57, 155648
    s_nop 0
    buffer_load_dwordx4 v4, s[16:19], s56 offen lds
    s_lshl_b32 s56, s2, 1
    s_lshr_b32 s57, s28, 1
    s_add_u32 s56, s56, s57
    s_mul_i32 s56, s56, 3072
    s_and_b32 s57, s28, 1
    s_lshl_b32 s57, s57, 11
    s_add_u32 s56, s56, s57
    s_lshl_b32 s57, s28, 10
    s_add_u32 m0, s57, 122880
    s_nop 0
    buffer_load_dwordx4 v4, s[8:11], s56 offen lds
    v_min_u32 v8, 15, v1
    v_lshlrev_b32 v8, 21, v8
    v_mov_b32 v9, s55
    v_add_co_u32 v8, vcc, s54, v8
    s_nop 1
    v_addc_co_u32 v9, vcc, 0, v9, vcc
    v_writelane_b32 v8, s38, 16
    v_writelane_b32 v9, s39, 16
    v_writelane_b32 v8, s42, 17
    v_writelane_b32 v9, s43, 17
    v_writelane_b32 v8, s44, 18
    v_writelane_b32 v9, s45, 18
    v_writelane_b32 v8, s46, 19
    v_writelane_b32 v9, s47, 19
    v_writelane_b32 v8, s48, 20
    v_writelane_b32 v9, s49, 20
    v_writelane_b32 v8, s50, 21
    v_writelane_b32 v9, s51, 21
    s_mov_b32 m0, 163584
    s_nop 0
    global_load_lds_dword v[8:9], off
    s_mov_b32 s64, 0x3fb8aa3b
    s_mov_b32 s65, 0x3fb8aa3b
    s_mov_b32 s66, 0xbfb8aa3b
    s_mov_b32 s67, 0xbfb8aa3b
    s_mov_b32 s12, s54
    s_and_b32 s13, s55, 0xffff
    s_mov_b32 s14, 0x2000000
    s_mov_b32 s15, 0x20000
    s_mov_b32 s20, s50
    s_and_b32 s21, s51, 0xffff
    s_mov_b32 s22, 0x200000
    s_mov_b32 s23, 0x20000
    s_nop 4
    s_lshl_b32 s56, s2, 2
    s_add_u32 s56, s56, s28
    s_cmp_eq_u32 s56, 0
    s_cbranch_scc0 L_nonce_1
    s_memrealtime s[58:59]
    s_waitcnt lgkmcnt(0)
    s_or_b32 s58, s58, 1
    v_mov_b32 v8, s58
    v_mov_b32 v9, 0
    v_mov_b32 v7, 0
    s_mov_b64 exec, 1
    global_atomic_cmpswap v7, v[8:9], s[52:53] sc1
    s_mov_b64 exec, -1
L_nonce_1:
    s_nop 1
    v_mov_b32 v8, 0x3f803f80
    v_mov_b32 v9, 0x3f803f80
    v_mov_b32 v10, 0x3f803f80
    v_mov_b32 v11, 0x3f803f80
    v_accvgpr_write_b32 a96, v8
    v_accvgpr_write_b32 a97, v8
    v_accvgpr_write_b32 a98, v8
    v_accvgpr_write_b32 a99, v8
    s_and_b32 s57, s28, 1
    s_lshl_b32 s57, s57, 10
    s_add_u32 s56, s57, 157696
    v_add_u32 v5, s56, v4
    ds_write_b128 v5, v[8:11]
    s_lshl_b32 s56, s63, 5
    v_add_u32 v12, s56, v2
    v_lshrrev_b32 v6, 1, v2
    v_and_b32 v6, 7, v6
    v_lshlrev_b32 v7, 7, v12
    s_xor_b32 s56, s28, 0
    s_lshl_b32 s56, s56, 1
    v_add_u32 v8, s56, v3
    v_xor_b32 v8, v8, v6
    v_lshl_add_u32 v120, v8, 4, v7
    s_xor_b32 s56, s28, 1
    s_lshl_b32 s56, s56, 1
    v_add_u32 v8, s56, v3
    v_xor_b32 v8, v8, v6
    v_lshl_add_u32 v121, v8, 4, v7
    s_xor_b32 s56, s28, 2
    s_lshl_b32 s56, s56, 1
    v_add_u32 v8, s56, v3
    v_xor_b32 v8, v8, v6
    v_lshl_add_u32 v122, v8, 4, v7
    s_xor_b32 s56, s28, 3
    s_lshl_b32 s56, s56, 1
    v_add_u32 v8, s56, v3
    v_xor_b32 v8, v8, v6
    v_lshl_add_u32 v123, v8, 4, v7
    v_and_b32 v5, 15, v1
    v_lshrrev_b32 v5, 2, v5
    v_and_b32 v6, 3, v1
    v_bfe_u32 v7, v1, 4, 1
    v_lshrrev_b32 v8, 1, v6
    v_lshl_add_u32 v8, v7, 1, v8
    s_lshl_b32 s56, s62, 2
    v_add_u32 v8, s56, v8
    v_and_b32 v9, 2, v5
    v_lshlrev_b32 v9, 1, v9
    v_xor_b32 v8, v8, v9
    v_lshlrev_b32 v8, 4, v8
    v_and_b32 v9, 1, v6
    v_lshl_add_u32 v8, v9, 3, v8
    v_lshl_add_u32 v9, v3, 3, v5
    v_lshl_add_u32 v8, v9, 7, v8
    s_xor_b32 s56, s28, 0
    s_lshl_b32 s56, s56, 11
    v_add_u32 v124, s56, v8
    s_xor_b32 s56, s28, 1
    s_lshl_b32 s56, s56, 11
    v_add_u32 v125, s56, v8
    s_xor_b32 s56, s28, 2
    s_lshl_b32 s56, s56, 11
    v_add_u32 v126, s56, v8
    s_xor_b32 s56, s28, 3
    s_lshl_b32 s56, s56, 11
    v_add_u32 v127, s56, v8
    v_mov_b32 v112, 0
    v_mov_b32 v113, 0
    v_mov_b32 v114, 0
    v_mov_b32 v115, 0
    v_mov_b32 v31, 0
    global_load_dword v30, v31, s[52:53] sc1
    v_lshrrev_b32 v5, 2, v1
    v_and_b32 v6, 3, v1
    v_lshlrev_b32 v6, 4, v6
    v_lshl_add_u32 v22, v5, 10, v6
    v_mul_u32_u24 v5, 2752, v5
    v_add_u32 v23, v5, v6
    s_lshl_b32 s85, s2, 2
    s_add_u32 s85, s85, s28
    s_nop 0
    s_add_u32 s86, s85, 0
    s_lshl_b32 s80, s86, 10
    s_and_b32 s87, s86, 0xffffffe0
    s_and_b32 s88, s86, 1
    s_lshl_b32 s88, s88, 4
    s_or_b32 s87, s87, s88
    s_bfe_u32 s88, s86, 0x40001
    s_or_b32 s86, s87, s88
    s_lshl_b32 s80, s86, 10
    s_and_b32 s87, s86, 511
    s_lshr_b32 s88, s87, 6
    s_bfe_u32 s89, s87, 0x20004
    s_and_b32 s90, s87, 15
    s_lshr_b32 s91, s89, 1
    s_and_b32 s89, s89, 1
    s_lshl_b32 s90, s90, 1
    s_add_u32 s90, s90, s91
    s_lshl_b32 s91, s88, 2
    s_add_u32 s90, s90, s91
    s_and_b32 s90, s90, 31
    s_lshl_b32 s57, s90, 14
    s_lshl_b32 s88, s88, 7
    s_add_u32 s57, s57, s88
    s_lshl_b32 s89, s89, 6
    s_add_u32 s57, s57, s89
    s_cmp_lt_u32 s85, 512
    s_cselect_b32 s98, s38, s42
    s_cselect_b32 s99, s39, s43
    s_add_u32 s70, s98, s57
    s_addc_u32 s71, s99, 0
    s_add_u32 s86, s85, 1024
    s_lshl_b32 s81, s86, 10
    s_cmp_lt_u32 s85, 512
    s_cbranch_scc0 L_rp_2
    s_and_b32 s87, s86, 0xffffffe0
    s_and_b32 s88, s86, 1
    s_lshl_b32 s88, s88, 4
    s_or_b32 s87, s87, s88
    s_bfe_u32 s88, s86, 0x40001
    s_or_b32 s86, s87, s88
    s_lshl_b32 s81, s86, 10
    s_and_b32 s87, s86, 511
    s_lshr_b32 s88, s87, 6
    s_bfe_u32 s89, s87, 0x20004
    s_and_b32 s90, s87, 15
    s_lshr_b32 s91, s89, 1
    s_and_b32 s89, s89, 1
    s_lshl_b32 s90, s90, 1
    s_add_u32 s90, s90, s91
    s_lshl_b32 s91, s88, 2
    s_add_u32 s90, s90, s91
    s_and_b32 s90, s90, 31
    s_lshl_b32 s57, s90, 14
    s_lshl_b32 s88, s88, 7
    s_add_u32 s57, s57, s88
    s_lshl_b32 s89, s89, 6
    s_add_u32 s57, s57, s89
    s_add_u32 s72, s44, s57
    s_addc_u32 s73, s45, 0
    v_mov_b32 v21, v22
    s_branch L_rp_3
L_rp_2:
    s_sub_u32 s87, s86, 1536
    s_and_b32 s88, s87, 1
    s_bfe_u32 s89, s87, 0x50001
    s_lshr_b32 s87, s87, 6
    s_lshl_b32 s87, s87, 1
    s_add_u32 s87, s87, s88
    s_cmp_lt_u32 s87, 43
    s_cselect_b32 s91, 1, 0
    s_min_u32 s87, s87, 42
    s_mul_i32 s57, s89, 44032
    s_lshl_b32 s88, s87, 6
    s_add_u32 s57, s57, s88
    s_mul_i32 s88, s87, 43
    s_lshr_b32 s88, s88, 8
    s_sub_u32 s90, s87, 18
    s_mul_i32 s90, s90, 52
    s_lshr_b32 s90, s90, 8
    s_add_u32 s90, s90, 3
    s_cmp_lt_u32 s87, 18
    s_cselect_b32 s88, s88, s90
    s_min_u32 s90, s88, 3
    s_mul_i32 s92, s88, 5
    s_add_u32 s90, s90, s92
    s_sub_u32 s87, s87, s90
    s_lshl_b32 s90, s88, 2
    s_sub_u32 s89, s89, s90
    s_and_b32 s89, s89, 31
    s_cmp_lt_u32 s88, 3
    s_cselect_b32 s92, 1, 0
    s_cmp_eq_u32 s87, 4
    s_cselect_b32 s93, s92, 0
    s_cmp_eq_u32 s87, 1
    s_cselect_b32 s94, 1, s93
    s_sub_u32 s95, s87, 1
    s_add_u32 s96, s87, 1
    s_lshr_b32 s96, s96, 1
    s_cmp_eq_u32 s92, 1
    s_cselect_b32 s95, s96, s95
    s_cmp_lt_u32 s87, 3
    s_cselect_b32 s96, s87, 4
    s_lshr_b32 s96, s96, 1
    s_cmp_lt_u32 s87, 3
    s_cselect_b32 s95, s96, s95
    s_lshl_b32 s93, s93, 1
    s_and_b32 s97, s89, 1
    s_add_u32 s93, s93, s97
    s_lshr_b32 s97, s89, 1
    s_add_u32 s89, s89, 16
    s_cmp_eq_u32 s94, 1
    s_cselect_b32 s95, s93, s95
    s_cselect_b32 s89, s97, s89
    s_mul_i32 s88, s88, 192
    s_mul_i32 s95, s95, 48
    s_add_u32 s88, s88, s95
    s_add_u32 s88, s88, s89
    s_add_u32 s88, s88, 1536
    s_lshl_b32 s81, s88, 10
    s_cmp_eq_u32 s91, 0
    s_cselect_b32 s81, 0x40000000, s81
    s_add_u32 s72, s46, s57
    s_addc_u32 s73, s47, 0
    v_mov_b32 v21, v23
L_rp_3:
    s_add_u32 s86, s85, 2048
    s_lshl_b32 s82, s86, 10
    s_sub_u32 s87, s86, 1536
    s_and_b32 s88, s87, 1
    s_bfe_u32 s89, s87, 0x50001
    s_lshr_b32 s87, s87, 6
    s_lshl_b32 s87, s87, 1
    s_add_u32 s87, s87, s88
    s_cmp_lt_u32 s87, 43
    s_cselect_b32 s91, 1, 0
    s_min_u32 s87, s87, 42
    s_mul_i32 s57, s89, 44032
    s_lshl_b32 s88, s87, 6
    s_add_u32 s57, s57, s88
    s_mul_i32 s88, s87, 43
    s_lshr_b32 s88, s88, 8
    s_sub_u32 s90, s87, 18
    s_mul_i32 s90, s90, 52
    s_lshr_b32 s90, s90, 8
    s_add_u32 s90, s90, 3
    s_cmp_lt_u32 s87, 18
    s_cselect_b32 s88, s88, s90
    s_min_u32 s90, s88, 3
    s_mul_i32 s92, s88, 5
    s_add_u32 s90, s90, s92
    s_sub_u32 s87, s87, s90
    s_lshl_b32 s90, s88, 2
    s_sub_u32 s89, s89, s90
    s_and_b32 s89, s89, 31
    s_cmp_lt_u32 s88, 3
    s_cselect_b32 s92, 1, 0
    s_cmp_eq_u32 s87, 4
    s_cselect_b32 s93, s92, 0
    s_cmp_eq_u32 s87, 1
    s_cselect_b32 s94, 1, s93
    s_sub_u32 s95, s87, 1
    s_add_u32 s96, s87, 1
    s_lshr_b32 s96, s96, 1
    s_cmp_eq_u32 s92, 1
    s_cselect_b32 s95, s96, s95
    s_cmp_lt_u32 s87, 3
    s_cselect_b32 s96, s87, 4
    s_lshr_b32 s96, s96, 1
    s_cmp_lt_u32 s87, 3
    s_cselect_b32 s95, s96, s95
    s_lshl_b32 s93, s93, 1
    s_and_b32 s97, s89, 1
    s_add_u32 s93, s93, s97
    s_lshr_b32 s97, s89, 1
    s_add_u32 s89, s89, 16
    s_cmp_eq_u32 s94, 1
    s_cselect_b32 s95, s93, s95
    s_cselect_b32 s89, s97, s89
    s_mul_i32 s88, s88, 192
    s_mul_i32 s95, s95, 48
    s_add_u32 s88, s88, s95
    s_add_u32 s88, s88, s89
    s_add_u32 s88, s88, 1536
    s_lshl_b32 s82, s88, 10
    s_cmp_eq_u32 s91, 0
    s_cselect_b32 s82, 0x40000000, s82
    s_add_u32 s74, s46, s57
    s_addc_u32 s75, s47, 0
    s_add_u32 s86, s85, 3072
    s_lshl_b32 s83, s86, 10
    s_sub_u32 s87, s86, 3072
    s_min_u32 s87, s87, 1471
    s_and_b32 s92, s87, 1
    s_lshr_b32 s87, s87, 1
    s_mul_hi_u32 s89, s87, 0x590b217
    s_mul_i32 s90, s89, 46
    s_sub_u32 s87, s87, s90
    s_lshl_b32 s89, s89, 1
    s_add_u32 s89, s89, s92
    s_mul_i32 s90, s89, 46
    s_add_u32 s90, s90, s87
    s_add_u32 s90, s90, 3072
    s_lshl_b32 s83, s90, 10
    s_sub_u32 s90, s87, 43
    s_cmp_ge_u32 s87, 43
    s_cselect_b32 s87, s90, s87
    s_lshr_b32 s88, s89, 2
    s_and_b32 s89, s89, 3
    s_min_u32 s90, s88, 3
    s_mul_i32 s91, s88, 5
    s_add_u32 s90, s90, s91
    s_lshl_b32 s90, s90, 1
    s_lshr_b32 s91, s89, 1
    s_and_b32 s89, s89, 1
    s_lshl_b32 s87, s87, 1
    s_add_u32 s87, s87, s91
    s_add_u32 s87, s87, s90
    s_sub_u32 s90, s87, 86
    s_cmp_ge_u32 s87, 86
    s_cselect_b32 s87, s90, s87
    s_lshl_b32 s57, s87, 14
    s_lshl_b32 s88, s88, 7
    s_add_u32 s57, s57, s88
    s_lshl_b32 s89, s89, 6
    s_add_u32 s57, s57, s89
    s_add_u32 s76, s48, s57
    s_addc_u32 s77, s49, 0
    s_add_u32 s86, s85, 4096
    s_lshl_b32 s84, s86, 10
    s_sub_u32 s87, s86, 3072
    s_min_u32 s87, s87, 1471
    s_and_b32 s92, s87, 1
    s_lshr_b32 s87, s87, 1
    s_mul_hi_u32 s89, s87, 0x590b217
    s_mul_i32 s90, s89, 46
    s_sub_u32 s87, s87, s90
    s_lshl_b32 s89, s89, 1
    s_add_u32 s89, s89, s92
    s_mul_i32 s90, s89, 46
    s_add_u32 s90, s90, s87
    s_add_u32 s90, s90, 3072
    s_lshl_b32 s84, s90, 10
    s_sub_u32 s90, s87, 43
    s_cmp_ge_u32 s87, 43
    s_cselect_b32 s87, s90, s87
    s_lshr_b32 s88, s89, 2
    s_and_b32 s89, s89, 3
    s_min_u32 s90, s88, 3
    s_mul_i32 s91, s88, 5
    s_add_u32 s90, s90, s91
    s_lshl_b32 s90, s90, 1
    s_lshr_b32 s91, s89, 1
    s_and_b32 s89, s89, 1
    s_lshl_b32 s87, s87, 1
    s_add_u32 s87, s87, s91
    s_add_u32 s87, s87, s90
    s_sub_u32 s90, s87, 86
    s_cmp_ge_u32 s87, 86
    s_cselect_b32 s87, s90, s87
    s_lshl_b32 s57, s87, 14
    s_lshl_b32 s88, s88, 7
    s_add_u32 s57, s57, s88
    s_lshl_b32 s89, s89, 6
    s_add_u32 s57, s57, s89
    s_cmp_ge_u32 s86, 4544
    s_cselect_b32 s84, 0x40000000, s84
    s_add_u32 s78, s48, s57
    s_addc_u32 s79, s49, 0
    s_nop 0
    v_accvgpr_write_b32 a108, v22
    v_accvgpr_write_b32 a109, v21
    v_accvgpr_write_b32 a110, v23
    s_add_u32 s56, s30, 2
    s_and_b32 s56, s56, 7
    s_lshl_b32 s57, s56, 7
    s_add_u32 s34, s57, s31
    s_mul_i32 s56, s56, 196608
    s_add_u32 s42, s56, s61
    s_add_u32 s56, s30, 3
    s_and_b32 s56, s56, 7
    s_lshl_b32 s57, s56, 7
    s_add_u32 s35, s57, s31
    s_mul_i32 s56, s56, 196608
    s_add_u32 s43, s56, s61
    s_add_u32 s56, s30, 4
    s_and_b32 s56, s56, 7
    s_lshl_b32 s57, s56, 7
    s_add_u32 s36, s57, s31
    s_mul_i32 s56, s56, 196608
    s_add_u32 s44, s56, s61
    s_add_u32 s56, s30, 5
    s_and_b32 s56, s56, 7
    s_lshl_b32 s57, s56, 7
    s_add_u32 s37, s57, s31
    s_mul_i32 s56, s56, 196608
    s_add_u32 s45, s56, s61
    s_add_u32 s56, s30, 6
    s_and_b32 s56, s56, 7
    s_lshl_b32 s57, s56, 7
    s_add_u32 s38, s57, s31
    s_mul_i32 s56, s56, 196608
    s_add_u32 s46, s56, s61
    s_add_u32 s56, s30, 7
    s_and_b32 s56, s56, 7
    s_lshl_b32 s57, s56, 7
    s_add_u32 s39, s57, s31
    s_mul_i32 s56, s56, 196608
    s_add_u32 s47, s56, s61
    s_lshl_b32 s56, s63, 5
    v_add_u32 v12, s56, v2
    v_lshrrev_b32 v6, 1, v2
    v_and_b32 v6, 7, v6
    v_lshlrev_b32 v7, 6, v12
    s_lshl_b32 s56, s62, 13
    s_add_u32 s56, s56, 131072
    v_add_u32 v7, s56, v7
    v_add_u32 v8, 0, v3
    v_xor_b32 v8, v8, v6
    v_lshl_add_u32 v8, v8, 3, v7
    v_accvgpr_write_b32 a112, v8
    v_add_u32 v8, 2, v3
    v_xor_b32 v8, v8, v6
    v_lshl_add_u32 v8, v8, 3, v7
    v_accvgpr_write_b32 a113, v8
    v_add_u32 v8, 4, v3
    v_xor_b32 v8, v8, v6
    v_lshl_add_u32 v8, v8, 3, v7
    v_accvgpr_write_b32 a114, v8
    v_add_u32 v8, 6, v3
    v_xor_b32 v8, v8, v6
    v_lshl_add_u32 v8, v8, 3, v7
    v_accvgpr_write_b32 a115, v8
    v_lshrrev_b32 v6, 2, v2
    v_and_b32 v6, 3, v6
    v_lshlrev_b32 v7, 5, v12
    s_lshl_b32 s56, s62, 12
    s_add_u32 s56, s56, 147456
    v_add_u32 v7, s56, v7
    v_add_u32 v8, 0, v3
    v_xor_b32 v8, v8, v6
    v_lshl_add_u32 v8, v8, 3, v7
    v_accvgpr_write_b32 a116, v8
    v_add_u32 v8, 2, v3
    v_xor_b32 v8, v8, v6
    v_lshl_add_u32 v8, v8, 3, v7
    v_accvgpr_write_b32 a117, v8
    v_and_b32 v5, 15, v1
    v_lshrrev_b32 v5, 2, v5
    v_and_b32 v6, 3, v1
    v_bfe_u32 v7, v1, 4, 1
    v_lshl_add_u32 v8, v3, 2, v5
    v_lshlrev_b32 v8, 5, v8
    v_lshl_add_u32 v8, v6, 3, v8
    s_lshl_b32 s56, s62, 10
    s_add_u32 s56, s56, 155648
    v_add_u32 v8, s56, v8
    v_accvgpr_write_b32 a122, v8
    v_lshl_add_u32 v8, v3, 3, v5
    v_lshl_add_u32 v9, v7, 2, v6
    v_lshrrev_b32 v10, 1, v5
    v_lshl_add_u32 v10, v3, 2, v10
    s_lshl_b32 s56, s28, 12
    s_add_u32 s56, s56, 131072
    v_xor_b32 v11, v9, v10
    v_lshlrev_b32 v11, 3, v11
    v_lshl_add_u32 v11, v8, 6, v11
    v_add_u32 v11, s56, v11
    v_accvgpr_write_b32 a118, v11
    v_add_u32 v10, 2, v10
    v_xor_b32 v11, v9, v10
    v_lshlrev_b32 v11, 3, v11
    v_add_u32 v12, 4, v8
    v_lshl_add_u32 v11, v12, 6, v11
    v_add_u32 v11, s56, v11
    v_accvgpr_write_b32 a119, v11
    s_lshl_b32 s56, s28, 11
    s_add_u32 s56, s56, 147456
    v_mov_b32 v13, 157696
    v_cmp_eq_u32 vcc, 1, v7
    v_lshlrev_b32 v10, 1, v3
    v_xor_b32 v11, v6, v10
    v_lshlrev_b32 v11, 3, v11
    v_lshl_add_u32 v11, v8, 5, v11
    v_add_u32 v11, s56, v11
    v_cndmask_b32 v11, v11, v13, vcc
    v_accvgpr_write_b32 a120, v11
    v_add_u32 v10, 1, v10
    v_xor_b32 v11, v6, v10
    v_lshlrev_b32 v11, 3, v11
    v_lshl_add_u32 v11, v12, 5, v11
    v_add_u32 v11, s56, v11
    v_cndmask_b32 v11, v11, v13, vcc
    v_accvgpr_write_b32 a121, v11
    v_min_u32 v8, 16, v2
    v_mul_u32_u24 v7, 17, v3
    v_add_u32 v8, v8, v7
    v_lshlrev_b32 v8, 4, v8
    v_accvgpr_write_b32 a123, v8
    s_lshl_b32 s56, s26, 4
    s_lshl_b32 s57, s28, 2
    s_add_u32 s56, s56, s57
    s_lshl_b32 s56, s56, 5
    s_add_u32 s56, s56, s25
    s_mul_i32 s56, s56, 640
    s_add_u32 s85, s56, 0x500000
    v_cmp_ge_u32 vcc, 16, v2
    s_nop 3
    s_mov_b64 s[58:59], vcc
    s_lshl_b32 s56, s26, 4
    s_lshr_b32 s57, s25, 1
    s_add_u32 s56, s56, s57
    s_lshl_b32 s56, s56, 5
    s_lshl_b32 s57, s28, 3
    s_add_u32 s56, s56, s57
    s_mul_i32 s56, s56, 640
    s_and_b32 s57, s25, 1
    s_mul_i32 s57, s57, 272
    s_add_u32 s56, s56, s57
    s_add_u32 s86, s56, 0x500000
    v_mul_u32_u24 v8, 640, v3
    v_lshl_add_u32 v8, v2, 4, v8
    v_accvgpr_write_b32 a124, v8
    s_waitcnt vmcnt(8)
    s_waitcnt lgkmcnt(0)
    s_barrier
    s_add_u32 m0, s60, 32768
    s_nop 0
    buffer_load_dwordx4 v26, s[4:7], s34 offen lds
    buffer_load_dwordx4 v27, s[4:7], s34 offen offset:1024 lds
    s_add_u32 s56, s42, 1024
    s_add_u32 m0, s60, 40960
    s_nop 0
    buffer_load_dwordx4 v28, s[8:11], s56 offen lds
    buffer_load_dwordx4 v29, s[8:11], s56 offen offset:1024 lds
    ds_read_b128 v[128:131], v120 offset:0
    ds_read_b128 v[132:135], v121 offset:0
    ds_read_b128 v[136:139], v122 offset:0
    ds_read_b128 v[140:143], v123 offset:0
    ds_read_b64_tr_b16 a[64:65], v124 offset:8192
    ds_read_b64_tr_b16 a[66:67], v124 offset:8704
    ds_read_b64_tr_b16 a[68:69], v125 offset:8192
    ds_read_b64_tr_b16 a[70:71], v125 offset:8704
    ds_read_b64_tr_b16 a[72:73], v126 offset:8192
    ds_read_b64_tr_b16 a[74:75], v126 offset:8704
    ds_read_b64_tr_b16 a[76:77], v127 offset:8192
    ds_read_b64_tr_b16 a[78:79], v127 offset:8704
    s_waitcnt vmcnt(8)
    s_waitcnt lgkmcnt(0)
    s_barrier
    v_mfma_f32_32x32x16_bf16 v[32:47], a[64:67], v[128:131], 0
    ds_read_b128 v[144:147], v120 offset:16384
    v_mfma_f32_32x32x16_bf16 v[48:63], a[64:67], a[96:99], 0
    s_add_u32 m0, s60, 0
    s_nop 0
    buffer_load_dwordx4 v26, s[4:7], s35 offen lds
    ds_read_b128 v[148:151], v121 offset:16384
    ds_read_b128 v[152:155], v122 offset:16384
    v_mfma_f32_32x32x16_bf16 v[96:111], a[96:99], v[128:131], 0
    ds_read_b128 v[156:159], v123 offset:16384
    ds_read_b64_tr_b16 a[80:81], v124 offset:24576
    v_mfma_f32_32x32x16_bf16 v[32:47], a[68:71], v[132:135], v[32:47]
    buffer_load_dwordx4 v27, s[4:7], s35 offen offset:1024 lds
    ds_read_b64_tr_b16 a[82:83], v124 offset:25088
    ds_read_b64_tr_b16 a[84:85], v125 offset:24576
    ds_read_b64_tr_b16 a[86:87], v125 offset:25088
    v_mfma_f32_32x32x16_bf16 v[48:63], a[68:71], a[96:99], v[48:63]
    ds_read_b64_tr_b16 a[88:89], v126 offset:24576
    ds_read_b64_tr_b16 a[90:91], v126 offset:25088
    v_mfma_f32_32x32x16_bf16 v[96:111], a[96:99], v[132:135], v[96:111]
    ds_read_b64_tr_b16 a[92:93], v127 offset:24576
    ds_read_b64_tr_b16 a[94:95], v127 offset:25088
    v_mfma_f32_32x32x16_bf16 v[32:47], a[72:75], v[136:139], v[32:47]
    s_add_u32 s56, s43, 1024
    s_add_u32 m0, s60, 8192
    s_nop 0
    buffer_load_dwordx4 v28, s[8:11], s56 offen lds
    v_mfma_f32_32x32x16_bf16 v[48:63], a[72:75], a[96:99], v[48:63]
    v_mfma_f32_32x32x16_bf16 v[32:47], a[76:79], v[140:143], v[32:47]
    buffer_load_dwordx4 v29, s[8:11], s56 offen offset:1024 lds
    v_mfma_f32_32x32x16_bf16 v[48:63], a[76:79], a[96:99], v[48:63]
    v_dot2_f32_bf16 v112, v128, v128, v112
    v_dot2_f32_bf16 v113, v129, v129, v113
    v_dot2_f32_bf16 v114, v130, v130, v114
    v_dot2_f32_bf16 v115, v131, v131, v115
    v_dot2_f32_bf16 v112, v132, v132, v112
    v_dot2_f32_bf16 v113, v133, v133, v113
    v_dot2_f32_bf16 v114, v134, v134, v114
    v_dot2_f32_bf16 v115, v135, v135, v115
    s_waitcnt vmcnt(4)
    s_waitcnt lgkmcnt(0)
    s_barrier
    v_mfma_f32_32x32x16_bf16 v[32:47], a[80:83], v[144:147], v[32:47]
    v_accvgpr_read_b32 v5, a108
    v_accvgpr_read_b32 v6, a109
    v_accvgpr_read_b32 v7, a110
    s_mul_i32 s57, s28, 5120
    s_add_u32 s57, s57, 49152
    s_add_u32 m0, s57, 0
    s_nop 0
    global_load_lds_dwordx4 v5, s[70:71]
    ds_read_b128 v[160:163], v120 offset:32768
    v_mfma_f32_32x32x16_bf16 v[48:63], a[80:83], a[96:99], v[48:63]
    s_add_u32 m0, s57, 1024
    s_nop 0
    global_load_lds_dwordx4 v6, s[72:73]
    ds_read_b128 v[164:167], v121 offset:32768
    ds_read_b128 v[168:171], v122 offset:32768
    v_mfma_f32_32x32x16_bf16 v[96:111], a[96:99], v[144:147], v[96:111]
    s_add_u32 m0, s57, 2048
    s_nop 0
    global_load_lds_dwordx4 v7, s[74:75]
    ds_read_b128 v[172:175], v123 offset:32768
    ds_read_b64_tr_b16 a[64:65], v124 offset:40960
    v_mfma_f32_32x32x16_bf16 v[32:47], a[84:87], v[148:151], v[32:47]
    ds_read_b64_tr_b16 a[66:67], v124 offset:41472
    ds_read_b64_tr_b16 a[68:69], v125 offset:40960
    ds_read_b64_tr_b16 a[70:71], v125 offset:41472
    v_mfma_f32_32x32x16_bf16 v[48:63], a[84:87], a[96:99], v[48:63]
    s_add_u32 m0, s57, 3072
    s_nop 0
    global_load_lds_dwordx4 v5, s[76:77]
    ds_read_b64_tr_b16 a[72:73], v126 offset:40960
    ds_read_b64_tr_b16 a[74:75], v126 offset:41472
    v_mfma_f32_32x32x16_bf16 v[96:111], a[96:99], v[148:151], v[96:111]
    s_add_u32 m0, s57, 4096
    s_nop 0
    global_load_lds_dwordx4 v5, s[78:79]
    ds_read_b64_tr_b16 a[76:77], v127 offset:40960
    ds_read_b64_tr_b16 a[78:79], v127 offset:41472
    v_mfma_f32_32x32x16_bf16 v[32:47], a[88:91], v[152:155], v[32:47]
    s_add_u32 m0, s60, 16384
    s_nop 0
    buffer_load_dwordx4 v26, s[4:7], s36 offen lds
    v_mfma_f32_32x32x16_bf16 v[48:63], a[88:91], a[96:99], v[48:63]
    buffer_load_dwordx4 v27, s[4:7], s36 offen offset:1024 lds
    v_mfma_f32_32x32x16_bf16 v[32:47], a[92:95], v[156:159], v[32:47]
    s_add_u32 s56, s44, 1024
    s_add_u32 m0, s60, 24576
    s_nop 0
    buffer_load_dwordx4 v28, s[8:11], s56 offen lds
    v_mfma_f32_32x32x16_bf16 v[48:63], a[92:95], a[96:99], v[48:63]
    buffer_load_dwordx4 v29, s[8:11], s56 offen offset:1024 lds
    v_dot2_f32_bf16 v112, v144, v144, v112
    v_dot2_f32_bf16 v113, v145, v145, v113
    v_dot2_f32_bf16 v114, v146, v146, v114
    v_dot2_f32_bf16 v115, v147, v147, v115
    v_dot2_f32_bf16 v112, v148, v148, v112
    v_dot2_f32_bf16 v113, v149, v149, v113
    v_dot2_f32_bf16 v114, v150, v150, v114
    v_dot2_f32_bf16 v115, v151, v151, v115
    s_waitcnt vmcnt(9)
    s_waitcnt lgkmcnt(0)
    s_barrier
    v_mfma_f32_32x32x16_bf16 v[32:47], a[64:67], v[160:163], v[32:47]
    ds_read_b128 v[176:179], v120 offset:0
    v_mfma_f32_32x32x16_bf16 v[48:63], a[64:67], a[96:99], v[48:63]
    s_add_u32 m0, s60, 32768
    s_nop 0
    buffer_load_dwordx4 v26, s[4:7], s37 offen lds
    ds_read_b128 v[180:183], v121 offset:0
    ds_read_b128 v[184:187], v122 offset:0
    v_mfma_f32_32x32x16_bf16 v[96:111], a[96:99], v[160:163], v[96:111]
    ds_read_b128 v[188:191], v123 offset:0
    ds_read_b64_tr_b16 a[80:81], v124 offset:8192
    v_mfma_f32_32x32x16_bf16 v[32:47], a[68:71], v[164:167], v[32:47]
    buffer_load_dwordx4 v27, s[4:7], s37 offen offset:1024 lds
    ds_read_b64_tr_b16 a[82:83], v124 offset:8704
    ds_read_b64_tr_b16 a[84:85], v125 offset:8192
    ds_read_b64_tr_b16 a[86:87], v125 offset:8704
    v_mfma_f32_32x32x16_bf16 v[48:63], a[68:71], a[96:99], v[48:63]
    ds_read_b64_tr_b16 a[88:89], v126 offset:8192
    ds_read_b64_tr_b16 a[90:91], v126 offset:8704
    v_mfma_f32_32x32x16_bf16 v[96:111], a[96:99], v[164:167], v[96:111]
    ds_read_b64_tr_b16 a[92:93], v127 offset:8192
    ds_read_b64_tr_b16 a[94:95], v127 offset:8704
    v_mfma_f32_32x32x16_bf16 v[32:47], a[72:75], v[168:171], v[32:47]
    s_add_u32 s56, s45, 1024
    s_add_u32 m0, s60, 40960
    s_nop 0
    buffer_load_dwordx4 v28, s[8:11], s56 offen lds
    v_mfma_f32_32x32x16_bf16 v[48:63], a[72:75], a[96:99], v[48:63]
    v_mfma_f32_32x32x16_bf16 v[32:47], a[76:79], v[172:175], v[32:47]
    buffer_load_dwordx4 v29, s[8:11], s56 offen offset:1024 lds
    v_mfma_f32_32x32x16_bf16 v[48:63], a[76:79], a[96:99], v[48:63]
    v_dot2_f32_bf16 v112, v160, v160, v112
    v_dot2_f32_bf16 v113, v161, v161, v113
    v_dot2_f32_bf16 v114, v162, v162, v114
    v_dot2_f32_bf16 v115, v163, v163, v115
    v_dot2_f32_bf16 v112, v164, v164, v112
    v_dot2_f32_bf16 v113, v165, v165, v113
    v_dot2_f32_bf16 v114, v166, v166, v114
    v_dot2_f32_bf16 v115, v167, v167, v115
    s_waitcnt vmcnt(4)
    s_waitcnt lgkmcnt(0)
    s_barrier
    v_mfma_f32_32x32x16_bf16 v[32:47], a[80:83], v[176:179], v[32:47]
    ds_read_b128 v[192:195], v120 offset:16384
    v_mfma_f32_32x32x16_bf16 v[48:63], a[80:83], a[96:99], v[48:63]
    s_add_u32 m0, s60, 0
    s_nop 0
    buffer_load_dwordx4 v26, s[4:7], s38 offen lds
    ds_read_b128 v[196:199], v121 offset:16384
    ds_read_b128 v[200:203], v122 offset:16384
    ds_read_b128 v[204:207], v123 offset:16384
    ds_read_b64_tr_b16 a[64:65], v124 offset:24576
    v_mfma_f32_32x32x16_bf16 v[96:111], a[96:99], v[176:179], v[96:111]
    ds_read_b64_tr_b16 a[66:67], v124 offset:25088
    ds_read_b64_tr_b16 a[68:69], v125 offset:24576
    ds_read_b64_tr_b16 a[70:71], v125 offset:25088
    ds_read_b64_tr_b16 a[72:73], v126 offset:24576
    v_mfma_f32_32x32x16_bf16 v[32:47], a[84:87], v[180:183], v[32:47]
    buffer_load_dwordx4 v27, s[4:7], s38 offen offset:1024 lds
    ds_read_b64_tr_b16 a[74:75], v126 offset:25088
    ds_read_b64_tr_b16 a[76:77], v127 offset:24576
    ds_read_b64_tr_b16 a[78:79], v127 offset:25088
    v_mfma_f32_32x32x16_bf16 v[48:63], a[84:87], a[96:99], v[48:63]
    v_and_b32 v5, 15, v1
    v_lshrrev_b32 v5, 2, v5
    v_lshl_add_u32 v5, v3, 2, v5
    v_lshlrev_b32 v5, 6, v5
    v_bfe_u32 v6, v1, 4, 1
    v_lshl_add_u32 v5, v6, 5, v5
    v_and_b32 v6, 3, v1
    v_lshl_add_u32 v5, v6, 3, v5
    s_mul_i32 s57, s28, 5120
    s_add_u32 s57, s57, 49152
    v_add_u32 v5, s57, v5
    ds_read_b64_tr_b16 a[0:1], v5 offset:0
    ds_read_b64_tr_b16 a[2:3], v5 offset:512
    ds_read_b64_tr_b16 a[4:5], v5 offset:1024
    v_mfma_f32_32x32x16_bf16 v[96:111], a[96:99], v[180:183], v[96:111]
    ds_read_b64_tr_b16 a[6:7], v5 offset:1536
    ds_read_b64_tr_b16 a[8:9], v5 offset:2048
    ds_read_b64_tr_b16 a[10:11], v5 offset:2560
    ds_read_b64_tr_b16 a[12:13], v5 offset:3072
    v_mfma_f32_32x32x16_bf16 v[32:47], a[88:91], v[184:187], v[32:47]
    s_add_u32 s56, s46, 1024
    s_add_u32 m0, s60, 8192
    s_nop 0
    buffer_load_dwordx4 v28, s[8:11], s56 offen lds
    ds_read_b64_tr_b16 a[14:15], v5 offset:3584
    ds_read_b64_tr_b16 a[16:17], v5 offset:4096
    ds_read_b64_tr_b16 a[18:19], v5 offset:4608
    v_mfma_f32_32x32x16_bf16 v[48:63], a[88:91], a[96:99], v[48:63]
    v_mfma_f32_32x32x16_bf16 v[32:47], a[92:95], v[188:191], v[32:47]
    buffer_load_dwordx4 v29, s[8:11], s56 offen offset:1024 lds
    v_mfma_f32_32x32x16_bf16 v[48:63], a[92:95], a[96:99], v[48:63]
    v_dot2_f32_bf16 v112, v176, v176, v112
    v_dot2_f32_bf16 v113, v177, v177, v113
    v_dot2_f32_bf16 v114, v178, v178, v114
    v_dot2_f32_bf16 v115, v179, v179, v115
    v_dot2_f32_bf16 v112, v180, v180, v112
    v_dot2_f32_bf16 v113, v181, v181, v113
    v_dot2_f32_bf16 v114, v182, v182, v114
    v_dot2_f32_bf16 v115, v183, v183, v115
    s_waitcnt vmcnt(4)
    s_waitcnt lgkmcnt(0)
    s_barrier
    v_mfma_f32_32x32x16_bf16 v[32:47], a[64:67], v[192:195], v[32:47]
    s_add_u32 m0, s60, 16384
    s_nop 0
    buffer_load_dwordx4 v26, s[4:7], s39 offen lds
    ds_read_b128 v[208:211], v120 offset:32768
    v_mfma_f32_32x32x16_bf16 v[48:63], a[64:67], a[96:99], v[48:63]
    buffer_load_dwordx4 v27, s[4:7], s39 offen offset:1024 lds
    ds_read_b128 v[212:215], v121 offset:32768
    ds_read_b128 v[216:219], v122 offset:32768
    v_mfma_f32_32x32x16_bf16 v[96:111], a[96:99], v[192:195], v[96:111]
    s_add_u32 s56, s47, 1024
    s_add_u32 m0, s60, 24576
    s_nop 0
    buffer_load_dwordx4 v28, s[8:11], s56 offen lds
    ds_read_b128 v[220:223], v123 offset:32768
    ds_read_b64_tr_b16 a[80:81], v124 offset:40960
    v_mfma_f32_32x32x16_bf16 v[32:47], a[68:71], v[196:199], v[32:47]
    ds_read_b64_tr_b16 a[82:83], v124 offset:41472
    ds_read_b64_tr_b16 a[84:85], v125 offset:40960
    ds_read_b64_tr_b16 a[86:87], v125 offset:41472
    v_mfma_f32_32x32x16_bf16 v[48:63], a[68:71], a[96:99], v[48:63]
    buffer_load_dwordx4 v29, s[8:11], s56 offen offset:1024 lds
    ds_read_b64_tr_b16 a[88:89], v126 offset:40960
    ds_read_b64_tr_b16 a[90:91], v126 offset:41472
    v_mfma_f32_32x32x16_bf16 v[96:111], a[96:99], v[196:199], v[96:111]
    buffer_store_dwordx4 a[0:3], v4, s[12:15], s80 offen sc1
    ds_read_b64_tr_b16 a[92:93], v127 offset:40960
    ds_read_b64_tr_b16 a[94:95], v127 offset:41472
    v_mfma_f32_32x32x16_bf16 v[32:47], a[72:75], v[200:203], v[32:47]
    buffer_store_dwordx4 a[4:7], v4, s[12:15], s81 offen sc1
    v_mfma_f32_32x32x16_bf16 v[48:63], a[72:75], a[96:99], v[48:63]
    buffer_store_dwordx4 a[8:11], v4, s[12:15], s82 offen sc1
    v_mfma_f32_32x32x16_bf16 v[32:47], a[76:79], v[204:207], v[32:47]
    buffer_store_dwordx4 a[12:15], v4, s[12:15], s83 offen sc1
    v_mfma_f32_32x32x16_bf16 v[48:63], a[76:79], a[96:99], v[48:63]
    buffer_store_dwordx4 a[16:19], v4, s[12:15], s84 offen sc1
    v_dot2_f32_bf16 v112, v192, v192, v112
    v_dot2_f32_bf16 v113, v193, v193, v113
    v_dot2_f32_bf16 v114, v194, v194, v114
    v_dot2_f32_bf16 v115, v195, v195, v115
    v_dot2_f32_bf16 v112, v196, v196, v112
    v_dot2_f32_bf16 v113, v197, v197, v113
    v_dot2_f32_bf16 v114, v198, v198, v114
    v_dot2_f32_bf16 v115, v199, v199, v115
    s_waitcnt vmcnt(9)
    s_waitcnt lgkmcnt(0)
    s_barrier
    v_mfma_f32_32x32x16_bf16 v[32:47], a[80:83], v[208:211], v[32:47]
    ds_read_b128 v[224:227], v120 offset:0
    v_mfma_f32_32x32x16_bf16 v[48:63], a[80:83], a[96:99], v[48:63]
    s_add_u32 s56, s40, 2048
    s_add_u32 m0, s60, 49152
    s_nop 0
    buffer_load_dwordx4 v28, s[8:11], s56 offen lds
    ds_read_b128 v[228:231], v121 offset:0
    ds_read_b128 v[232:235], v122 offset:0
    v_mfma_f32_32x32x16_bf16 v[96:111], a[96:99], v[208:211], v[96:111]
    ds_read_b128 v[236:239], v123 offset:0
    ds_read_b64_tr_b16 a[64:65], v124 offset:8192
    v_mfma_f32_32x32x16_bf16 v[32:47], a[84:87], v[212:215], v[32:47]
    buffer_load_dwordx4 v29, s[8:11], s56 offen offset:1024 lds
    ds_read_b64_tr_b16 a[66:67], v124 offset:8704
    ds_read_b64_tr_b16 a[68:69], v125 offset:8192
    ds_read_b64_tr_b16 a[70:71], v125 offset:8704
    v_mfma_f32_32x32x16_bf16 v[48:63], a[84:87], a[96:99], v[48:63]
    ds_read_b64_tr_b16 a[72:73], v126 offset:8192
    ds_read_b64_tr_b16 a[74:75], v126 offset:8704
    v_mfma_f32_32x32x16_bf16 v[96:111], a[96:99], v[212:215], v[96:111]
    ds_read_b64_tr_b16 a[76:77], v127 offset:8192
    ds_read_b64_tr_b16 a[78:79], v127 offset:8704
    v_mfma_f32_32x32x16_bf16 v[32:47], a[88:91], v[216:219], v[32:47]
    s_add_u32 s56, s41, 2048
    s_add_u32 m0, s60, 57344
    s_nop 0
    buffer_load_dwordx4 v28, s[8:11], s56 offen lds
    v_mfma_f32_32x32x16_bf16 v[48:63], a[88:91], a[96:99], v[48:63]
    v_mfma_f32_32x32x16_bf16 v[32:47], a[92:95], v[220:223], v[32:47]
    buffer_load_dwordx4 v29, s[8:11], s56 offen offset:1024 lds
    v_mfma_f32_32x32x16_bf16 v[48:63], a[92:95], a[96:99], v[48:63]
    v_dot2_f32_bf16 v112, v208, v208, v112
    v_dot2_f32_bf16 v113, v209, v209, v113
    v_dot2_f32_bf16 v114, v210, v210, v114
    v_dot2_f32_bf16 v115, v211, v211, v115
    v_dot2_f32_bf16 v112, v212, v212, v112
    v_dot2_f32_bf16 v113, v213, v213, v113
    v_dot2_f32_bf16 v114, v214, v214, v114
    v_dot2_f32_bf16 v115, v215, v215, v115
    s_waitcnt vmcnt(9)
    s_waitcnt lgkmcnt(0)
    s_barrier
    v_mfma_f32_32x32x16_bf16 v[32:47], a[64:67], v[224:227], v[32:47]
    ds_read_b128 v[240:243], v120 offset:16384
    v_mfma_f32_32x32x16_bf16 v[48:63], a[64:67], a[96:99], v[48:63]
    s_add_u32 s56, s42, 2048
    s_add_u32 m0, s60, 65536
    s_nop 0
    buffer_load_dwordx4 v28, s[8:11], s56 offen lds
    ds_read_b128 v[244:247], v121 offset:16384
    ds_read_b128 v[248:251], v122 offset:16384
    v_mfma_f32_32x32x16_bf16 v[96:111], a[96:99], v[224:227], v[96:111]
    ds_read_b128 v[252:255], v123 offset:16384
    ds_read_b64_tr_b16 a[80:81], v124 offset:24576
    v_mfma_f32_32x32x16_bf16 v[32:47], a[68:71], v[228:231], v[32:47]
    buffer_load_dwordx4 v29, s[8:11], s56 offen offset:1024 lds
    ds_read_b64_tr_b16 a[82:83], v124 offset:25088
    ds_read_b64_tr_b16 a[84:85], v125 offset:24576
    ds_read_b64_tr_b16 a[86:87], v125 offset:25088
    v_mfma_f32_32x32x16_bf16 v[48:63], a[68:71], a[96:99], v[48:63]
    ds_read_b64_tr_b16 a[88:89], v126 offset:24576
    ds_read_b64_tr_b16 a[90:91], v126 offset:25088
    v_mfma_f32_32x32x16_bf16 v[96:111], a[96:99], v[228:231], v[96:111]
    ds_read_b64_tr_b16 a[92:93], v127 offset:24576
    ds_read_b64_tr_b16 a[94:95], v127 offset:25088
    v_mfma_f32_32x32x16_bf16 v[32:47], a[72:75], v[232:235], v[32:47]
    s_add_u32 s56, s43, 2048
    s_add_u32 m0, s60, 73728
    s_nop 0
    buffer_load_dwordx4 v28, s[8:11], s56 offen lds
    v_mfma_f32_32x32x16_bf16 v[48:63], a[72:75], a[96:99], v[48:63]
    v_mfma_f32_32x32x16_bf16 v[32:47], a[76:79], v[236:239], v[32:47]
    buffer_load_dwordx4 v29, s[8:11], s56 offen offset:1024 lds
    v_mfma_f32_32x32x16_bf16 v[48:63], a[76:79], a[96:99], v[48:63]
    v_dot2_f32_bf16 v112, v224, v224, v112
    v_dot2_f32_bf16 v113, v225, v225, v113
    v_dot2_f32_bf16 v114, v226, v226, v114
    v_dot2_f32_bf16 v115, v227, v227, v115
    v_dot2_f32_bf16 v112, v228, v228, v112
    v_dot2_f32_bf16 v113, v229, v229, v113
    v_dot2_f32_bf16 v114, v230, v230, v114
    v_dot2_f32_bf16 v115, v231, v231, v115
    s_waitcnt lgkmcnt(0)
    s_barrier
    v_mfma_f32_32x32x16_bf16 v[32:47], a[80:83], v[240:243], v[32:47]
    v_mfma_f32_32x32x16_bf16 v[48:63], a[80:83], a[96:99], v[48:63]
    s_add_u32 s56, s44, 2048
    s_add_u32 m0, s60, 81920
    s_nop 0
    buffer_load_dwordx4 v28, s[8:11], s56 offen lds
    v_mfma_f32_32x32x16_bf16 v[96:111], a[96:99], v[240:243], v[96:111]
    v_mfma_f32_32x32x16_bf16 v[32:47], a[84:87], v[244:247], v[32:47]
    buffer_load_dwordx4 v29, s[8:11], s56 offen offset:1024 lds
    v_mfma_f32_32x32x16_bf16 v[48:63], a[84:87], a[96:99], v[48:63]
    v_mfma_f32_32x32x16_bf16 v[96:111], a[96:99], v[244:247], v[96:111]
    v_mfma_f32_32x32x16_bf16 v[32:47], a[88:91], v[248:251], v[32:47]
    s_add_u32 s56, s45, 2048
    s_add_u32 m0, s60, 90112
    s_nop 0
    buffer_load_dwordx4 v28, s[8:11], s56 offen lds
    v_mfma_f32_32x32x16_bf16 v[48:63], a[88:91], a[96:99], v[48:63]
    v_mfma_f32_32x32x16_bf16 v[32:47], a[92:95], v[252:255], v[32:47]
    buffer_load_dwordx4 v29, s[8:11], s56 offen offset:1024 lds
    v_mfma_f32_32x32x16_bf16 v[48:63], a[92:95], a[96:99], v[48:63]
    v_dot2_f32_bf16 v112, v240, v240, v112
    v_dot2_f32_bf16 v113, v241, v241, v113
    v_dot2_f32_bf16 v114, v242, v242, v114
    v_dot2_f32_bf16 v115, v243, v243, v115
    v_dot2_f32_bf16 v112, v244, v244, v112
    v_dot2_f32_bf16 v113, v245, v245, v113
    v_dot2_f32_bf16 v114, v246, v246, v114
    v_dot2_f32_bf16 v115, v247, v247, v115
    v_add_u32 v120, 0x10000, v124
    v_add_u32 v121, 0x10000, v125
    v_add_u32 v122, 0x10000, v126
    v_add_u32 v123, 0x10000, v127
    s_waitcnt vmcnt(8)
    s_barrier
    ds_read_b64_tr_b16 a[64:65], v124 offset:49152
    ds_read_b64_tr_b16 a[66:67], v124 offset:49664
    ds_read_b64_tr_b16 a[68:69], v125 offset:49152
    ds_read_b64_tr_b16 a[70:71], v125 offset:49664
    ds_read_b64_tr_b16 a[72:73], v126 offset:49152
    ds_read_b64_tr_b16 a[74:75], v126 offset:49664
    ds_read_b64_tr_b16 a[76:77], v127 offset:49152
    ds_read_b64_tr_b16 a[78:79], v127 offset:49664
    s_waitcnt lgkmcnt(6)
    v_mfma_f32_32x32x16_bf16 v[64:79], a[64:67], v[128:131], 0
    s_add_u32 s56, s46, 2048
    s_add_u32 m0, s60, 98304
    s_nop 0
    buffer_load_dwordx4 v28, s[8:11], s56 offen lds
    ds_read_b64_tr_b16 a[80:81], v124 offset:57344
    v_mfma_f32_32x32x16_bf16 v[80:95], a[64:67], a[96:99], 0
    ds_read_b64_tr_b16 a[82:83], v124 offset:57856
    ds_read_b64_tr_b16 a[84:85], v125 offset:57344
    s_waitcnt lgkmcnt(7)
    v_mfma_f32_32x32x16_bf16 v[64:79], a[68:71], v[132:135], v[64:79]
    buffer_load_dwordx4 v29, s[8:11], s56 offen offset:1024 lds
    ds_read_b64_tr_b16 a[86:87], v125 offset:57856
    ds_read_b64_tr_b16 a[88:89], v126 offset:57344
    ds_read_b64_tr_b16 a[90:91], v126 offset:57856
    v_mfma_f32_32x32x16_bf16 v[80:95], a[68:71], a[96:99], v[80:95]
    ds_read_b64_tr_b16 a[92:93], v127 offset:57344
    ds_read_b64_tr_b16 a[94:95], v127 offset:57856
    s_waitcnt lgkmcnt(10)
    v_mfma_f32_32x32x16_bf16 v[64:79], a[72:75], v[136:139], v[64:79]
    s_add_u32 s56, s47, 2048
    s_add_u32 m0, s60, 106496
    s_nop 0
    buffer_load_dwordx4 v28, s[8:11], s56 offen lds
    v_accvgpr_read_b32 v6, a122
    ds_read_b64_tr_b16 a[100:101], v6
    ds_read_b64_tr_b16 a[102:103], v6 offset:256
    v_mfma_f32_32x32x16_bf16 v[80:95], a[72:75], a[96:99], v[80:95]
    ds_read_b64_tr_b16 a[104:105], v6 offset:512
    ds_read_b64_tr_b16 a[106:107], v6 offset:768
    s_waitcnt lgkmcnt(12)
    v_mfma_f32_32x32x16_bf16 v[64:79], a[76:79], v[140:143], v[64:79]
    buffer_load_dwordx4 v29, s[8:11], s56 offen offset:1024 lds
    v_add_f32 v112, v112, v113
    v_add_f32 v114, v114, v115
    v_add_f32 v112, v112, v114
    v_mfma_f32_32x32x16_bf16 v[80:95], a[76:79], a[96:99], v[80:95]
    v_mov_b32 v113, v112
    s_nop 1
    v_permlane32_swap_b32 v112, v113
    v_add_f32 v112, v112, v113
    v_mov_b32 v113, v112
    v_mov_b32 v112, v96
    s_lshl_b32 s56, s28, 8
    s_add_u32 s56, s56, 161792
    v_lshl_add_u32 v5, v2, 3, s56
    ds_write_b64 v5, v[112:113]
    v_readfirstlane_b32 s24, v30
    s_nop 3
    s_nop 3
    s_cmp_lg_u32 s24, 0
    s_cbranch_scc1 L_tag_4_ok
    s_mov_b32 s56, 0
L_tag_4:
    global_load_dword v30, v31, s[52:53] sc1
    s_add_u32 s56, s56, 1
    s_waitcnt vmcnt(0)
    v_readfirstlane_b32 s24, v30
    s_cmp_gt_u32 s56, 200000
    s_cbranch_scc1 L_end
    s_nop 2
    s_cmp_eq_u32 s24, 0
    s_cbranch_scc1 L_tag_4
L_tag_4_ok:
    s_nop 1
    s_waitcnt vmcnt(8)
    s_waitcnt lgkmcnt(0)
    s_barrier
    s_nop 0
    s_cmp_eq_u32 s28, 0
    s_cbranch_scc0 L_s0f_5
    s_lshl_b32 s56, s2, 3
    s_add_u32 s56, s56, 0xac8000
    v_mov_b32 v6, s24
    v_mov_b32 v7, s24
    v_mov_b32 v5, 0
    s_mov_b64 exec, 1
    buffer_store_dwordx2 v[6:7], v5, s[12:15], s56 offen sc1
    s_mov_b64 exec, -1
L_s0f_5:
    s_nop 0
    v_mfma_f32_32x32x16_bf16 v[64:79], a[80:83], v[144:147], v[64:79]
    ds_read_b64_tr_b16 a[64:65], v120 offset:0
    v_mfma_f32_32x32x16_bf16 v[80:95], a[80:83], a[96:99], v[80:95]
    ds_read_b64_tr_b16 a[66:67], v120 offset:512
    ds_read_b64_tr_b16 a[68:69], v121 offset:0
    ds_read_b64_tr_b16 a[70:71], v121 offset:512
    ds_read_b64_tr_b16 a[72:73], v122 offset:0
    ds_read_b64_tr_b16 a[74:75], v122 offset:512
    v_mfma_f32_32x32x16_bf16 v[64:79], a[84:87], v[148:151], v[64:79]
    ds_read_b64_tr_b16 a[76:77], v123 offset:0
    ds_read_b64_tr_b16 a[78:79], v123 offset:512
    s_xor_b32 s56, s28, 2
    s_lshl_b32 s56, s56, 8
    s_add_u32 s56, s56, 161792
    v_lshl_add_u32 v5, v2, 3, s56
    ds_read_b64 v[114:115], v5
    s_waitcnt lgkmcnt(0)
    v_add_f32 v112, v112, v114
    v_add_f32 v113, v113, v115
    v_mul_f32 v112, 0x3b000000, v112
    v_mfma_f32_32x32x16_bf16 v[80:95], a[84:87], a[96:99], v[80:95]
    v_mul_f32 v113, 0x3b000000, v113
    v_fma_f32 v113, -v112, v112, v113
    v_max_f32 v113, 0, v113
    v_add_f32 v113, 0x3727c5ac, v113
    v_rsq_f32 v24, v113
    v_mfma_f32_32x32x16_bf16 v[64:79], a[88:91], v[152:155], v[64:79]
    v_mul_f32 v25, v24, v112
    v_sub_f32 v25, 0, v25
    v_mul_f32 v32, v24, v32
    v_mul_f32 v33, v24, v33
    v_mul_f32 v34, v24, v34
    v_mul_f32 v35, v24, v35
    v_mfma_f32_32x32x16_bf16 v[80:95], a[88:91], a[96:99], v[80:95]
    v_mul_f32 v36, v24, v36
    v_mul_f32 v37, v24, v37
    v_mul_f32 v38, v24, v38
    v_mul_f32 v39, v24, v39
    v_mul_f32 v40, v24, v40
    v_mul_f32 v41, v24, v41
    v_mfma_f32_32x32x16_bf16 v[64:79], a[92:95], v[156:159], v[64:79]
    v_mul_f32 v42, v24, v42
    v_mul_f32 v43, v24, v43
    v_mul_f32 v44, v24, v44
    v_mul_f32 v45, v24, v45
    v_mul_f32 v46, v24, v46
    v_mfma_f32_32x32x16_bf16 v[80:95], a[92:95], a[96:99], v[80:95]
    v_mul_f32 v47, v24, v47
    v_fmac_f32 v32, v25, v48
    v_fmac_f32 v33, v25, v49
    v_fmac_f32 v34, v25, v50
    v_fmac_f32 v35, v25, v51
    v_fmac_f32 v36, v25, v52
    v_fmac_f32 v37, v25, v53
    v_fmac_f32 v38, v25, v54
    v_fmac_f32 v39, v25, v55
    v_fmac_f32 v40, v25, v56
    v_fmac_f32 v41, v25, v57
    v_mfma_f32_32x32x16_bf16 v[64:79], a[64:67], v[160:163], v[64:79]
    ds_read_b64_tr_b16 a[80:81], v120 offset:8192
    v_mfma_f32_32x32x16_bf16 v[80:95], a[64:67], a[96:99], v[80:95]
    ds_read_b64_tr_b16 a[82:83], v120 offset:8704
    ds_read_b64_tr_b16 a[84:85], v121 offset:8192
    ds_read_b64_tr_b16 a[86:87], v121 offset:8704
    ds_read_b64_tr_b16 a[88:89], v122 offset:8192
    ds_read_b64_tr_b16 a[90:91], v122 offset:8704
    v_mfma_f32_32x32x16_bf16 v[64:79], a[68:71], v[164:167], v[64:79]
    ds_read_b64_tr_b16 a[92:93], v123 offset:8192
    ds_read_b64_tr_b16 a[94:95], v123 offset:8704
    v_fmac_f32 v42, v25, v58
    v_fmac_f32 v43, v25, v59
    v_fmac_f32 v44, v25, v60
    v_fmac_f32 v45, v25, v61
    v_mfma_f32_32x32x16_bf16 v[80:95], a[68:71], a[96:99], v[80:95]
    v_fmac_f32 v46, v25, v62
    v_fmac_f32 v47, v25, v63
    v_cvt_pk_bf16_f32 v8, v32, v33
    v_cvt_pk_bf16_f32 v9, v34, v35
    v_cvt_pk_bf16_f32 v10, v36, v37
    v_mfma_f32_32x32x16_bf16 v[64:79], a[72:75], v[168:171], v[64:79]
    v_cvt_pk_bf16_f32 v11, v38, v39
    v_cvt_pk_bf16_f32 v12, v40, v41
    v_cvt_pk_bf16_f32 v13, v42, v43
    v_cvt_pk_bf16_f32 v14, v44, v45
    v_cvt_pk_bf16_f32 v15, v46, v47
    v_mfma_f32_32x32x16_bf16 v[32:47], a[100:103], v[8:11], 0
    v_mfma_f32_32x32x16_bf16 v[80:95], a[72:75], a[96:99], v[80:95]
    v_mfma_f32_32x32x16_bf16 v[48:63], a[104:107], v[12:15], 0
    s_nop 9
    v_max3_f32 v96, v32, v33, v34
    v_min3_f32 v97, v32, v33, v34
    v_max3_f32 v96, v96, v35, v36
    v_min3_f32 v97, v97, v35, v36
    v_max3_f32 v96, v96, v37, v38
    v_mfma_f32_32x32x16_bf16 v[64:79], a[76:79], v[172:175], v[64:79]
    v_min3_f32 v97, v97, v37, v38
    v_max_f32 v96, v96, v39
    v_min_f32 v97, v97, v39
    v_mov_b32 v98, v96
    v_mov_b32 v99, v97
    v_mfma_f32_32x32x16_bf16 v[80:95], a[76:79], a[96:99], v[80:95]
    v_nop
    v_permlane32_swap_b32 v96, v98
    v_permlane32_swap_b32 v97, v99
    v_max_f32 v96, v96, v98
    v_min_f32 v97, v97, v99
    v_mul_f32 v100, s66, v96
    v_mul_f32 v102, s64, v97
    v_fma_f32 v104, v32, s64, v100
    v_fma_f32 v112, v32, s66, v102
    v_fma_f32 v105, v33, s64, v100
    v_fma_f32 v113, v33, s66, v102
    s_waitcnt vmcnt(0)
    s_waitcnt lgkmcnt(0)
    s_barrier
    v_mfma_f32_32x32x16_bf16 v[64:79], a[80:83], v[176:179], v[64:79]
    s_add_u32 m0, s60, 114688
    s_nop 0
    buffer_load_dwordx4 v28, s[8:11], s40 offen lds
    ds_read_b64_tr_b16 a[64:65], v120 offset:16384
    v_mfma_f32_32x32x16_bf16 v[80:95], a[80:83], a[96:99], v[80:95]
    ds_read_b64_tr_b16 a[66:67], v120 offset:16896
    ds_read_b64_tr_b16 a[68:69], v121 offset:16384
    ds_read_b64_tr_b16 a[70:71], v121 offset:16896
    ds_read_b64_tr_b16 a[72:73], v122 offset:16384
    ds_read_b64_tr_b16 a[74:75], v122 offset:16896
    v_mfma_f32_32x32x16_bf16 v[64:79], a[84:87], v[180:183], v[64:79]
    buffer_load_dwordx4 v29, s[8:11], s40 offen offset:1024 lds
    ds_read_b64_tr_b16 a[76:77], v123 offset:16384
    ds_read_b64_tr_b16 a[78:79], v123 offset:16896
    v_fma_f32 v106, v34, s64, v100
    v_fma_f32 v114, v34, s66, v102
    v_fma_f32 v107, v35, s64, v100
    v_fma_f32 v115, v35, s66, v102
    v_mfma_f32_32x32x16_bf16 v[80:95], a[84:87], a[96:99], v[80:95]
    v_fma_f32 v108, v36, s64, v100
    v_fma_f32 v116, v36, s66, v102
    v_fma_f32 v109, v37, s64, v100
    v_fma_f32 v117, v37, s66, v102
    v_fma_f32 v110, v38, s64, v100
    v_mfma_f32_32x32x16_bf16 v[64:79], a[88:91], v[184:187], v[64:79]
    s_add_u32 m0, s60, 122880
    s_nop 0
    buffer_load_dwordx4 v28, s[8:11], s41 offen lds
    v_fma_f32 v118, v38, s66, v102
    v_fma_f32 v111, v39, s64, v100
    v_fma_f32 v119, v39, s66, v102
    v_exp_f32 v104, v104
    v_exp_f32 v112, v112
    v_exp_f32 v105, v105
    v_mfma_f32_32x32x16_bf16 v[80:95], a[88:91], a[96:99], v[80:95]
    v_exp_f32 v113, v113
    v_exp_f32 v106, v106
    v_exp_f32 v114, v114
    v_exp_f32 v107, v107
    v_exp_f32 v115, v115
    v_exp_f32 v108, v108
    v_mfma_f32_32x32x16_bf16 v[64:79], a[92:95], v[188:191], v[64:79]
    buffer_load_dwordx4 v29, s[8:11], s41 offen offset:1024 lds
    v_exp_f32 v116, v116
    v_exp_f32 v109, v109
    v_exp_f32 v117, v117
    v_exp_f32 v110, v110
    v_exp_f32 v118, v118
    v_mfma_f32_32x32x16_bf16 v[80:95], a[92:95], a[96:99], v[80:95]
    v_exp_f32 v111, v111
    v_exp_f32 v119, v119
    v_add_f32 v32, v104, v105
    v_add_f32 v36, v112, v113
    v_add_f32 v33, v106, v107
    v_add_f32 v37, v114, v115
    v_add_f32 v34, v108, v109
    v_add_f32 v38, v116, v117
    v_add_f32 v35, v110, v111
    v_add_f32 v39, v118, v119
    v_add_f32 v32, v32, v33
    s_waitcnt lgkmcnt(6)
    v_mfma_f32_32x32x16_bf16 v[64:79], a[64:67], v[192:195], v[64:79]
    s_add_u32 m0, s60, 0
    s_nop 0
    buffer_load_dwordx4 v28, s[8:11], s42 offen lds
    ds_read_b64_tr_b16 a[80:81], v120 offset:24576
    v_mfma_f32_32x32x16_bf16 v[80:95], a[64:67], a[96:99], v[80:95]
    ds_read_b64_tr_b16 a[82:83], v120 offset:25088
    ds_read_b64_tr_b16 a[84:85], v121 offset:24576
    ds_read_b64_tr_b16 a[86:87], v121 offset:25088
    ds_read_b64_tr_b16 a[88:89], v122 offset:24576
    ds_read_b64_tr_b16 a[90:91], v122 offset:25088
    s_waitcnt lgkmcnt(10)
    v_mfma_f32_32x32x16_bf16 v[64:79], a[68:71], v[196:199], v[64:79]
    buffer_load_dwordx4 v29, s[8:11], s42 offen offset:1024 lds
    ds_read_b64_tr_b16 a[92:93], v123 offset:24576
    ds_read_b64_tr_b16 a[94:95], v123 offset:25088
    v_add_f32 v34, v34, v35
    v_add_f32 v36, v36, v37
    v_add_f32 v38, v38, v39
    v_add_f32 v32, v32, v34
    v_mfma_f32_32x32x16_bf16 v[80:95], a[68:71], a[96:99], v[80:95]
    v_add_f32 v36, v36, v38
    v_mov_b32 v98, v32
    v_mov_b32 v99, v36
    v_nop
    v_permlane32_swap_b32 v32, v98
    s_waitcnt lgkmcnt(10)
    v_mfma_f32_32x32x16_bf16 v[64:79], a[72:75], v[200:203], v[64:79]
    s_add_u32 m0, s60, 8192
    s_nop 0
    buffer_load_dwordx4 v28, s[8:11], s43 offen lds
    v_permlane32_swap_b32 v36, v99
    v_add_f32 v32, v32, v98
    v_add_f32 v36, v36, v99
    v_rcp_f32 v100, v32
    v_rcp_f32 v102, v36
    v_mul_f32 v104, v100, v104
    v_mfma_f32_32x32x16_bf16 v[80:95], a[72:75], a[96:99], v[80:95]
    v_mul_f32 v105, v100, v105
    v_mul_f32 v106, v100, v106
    v_mul_f32 v107, v100, v107
    v_mul_f32 v108, v100, v108
    v_mul_f32 v109, v100, v109
    s_waitcnt lgkmcnt(8)
    v_mfma_f32_32x32x16_bf16 v[64:79], a[76:79], v[204:207], v[64:79]
    buffer_load_dwordx4 v29, s[8:11], s43 offen offset:1024 lds
    v_mul_f32 v110, v100, v110
    v_mul_f32 v111, v100, v111
    v_mul_f32 v112, v102, v112
    v_mul_f32 v113, v102, v113
    v_mul_f32 v114, v102, v114
    v_mul_f32 v115, v102, v115
    v_mfma_f32_32x32x16_bf16 v[80:95], a[76:79], a[96:99], v[80:95]
    v_mul_f32 v116, v102, v116
    v_mul_f32 v117, v102, v117
    v_mul_f32 v118, v102, v118
    v_mul_f32 v119, v102, v119
    v_cvt_pk_bf16_f32 v8, v104, v105
    v_cvt_pk_bf16_f32 v9, v106, v107
    v_cvt_pk_bf16_f32 v10, v108, v109
    v_cvt_pk_bf16_f32 v11, v110, v111
    v_cvt_pk_bf16_f32 v12, v112, v113
    v_cvt_pk_bf16_f32 v13, v114, v115
    s_waitcnt lgkmcnt(6)
    v_mfma_f32_32x32x16_bf16 v[64:79], a[80:83], v[208:211], v[64:79]
    s_add_u32 m0, s60, 16384
    s_nop 0
    buffer_load_dwordx4 v28, s[8:11], s44 offen lds
    ds_read_b64_tr_b16 a[64:65], v120 offset:32768
    v_mfma_f32_32x32x16_bf16 v[80:95], a[80:83], a[96:99], v[80:95]
    ds_read_b64_tr_b16 a[66:67], v120 offset:33280
    ds_read_b64_tr_b16 a[68:69], v121 offset:32768
    ds_read_b64_tr_b16 a[70:71], v121 offset:33280
    ds_read_b64_tr_b16 a[72:73], v122 offset:32768
    ds_read_b64_tr_b16 a[74:75], v122 offset:33280
    s_waitcnt lgkmcnt(10)
    v_mfma_f32_32x32x16_bf16 v[64:79], a[84:87], v[212:215], v[64:79]
    buffer_load_dwordx4 v29, s[8:11], s44 offen offset:1024 lds
    ds_read_b64_tr_b16 a[76:77], v123 offset:32768
    ds_read_b64_tr_b16 a[78:79], v123 offset:33280
    v_cvt_pk_bf16_f32 v14, v116, v117
    v_cvt_pk_bf16_f32 v15, v118, v119
    v_max3_f32 v96, v48, v49, v50
    v_min3_f32 v97, v48, v49, v50
    v_mfma_f32_32x32x16_bf16 v[80:95], a[84:87], a[96:99], v[80:95]
    v_max3_f32 v96, v96, v51, v52
    v_min3_f32 v97, v97, v51, v52
    v_max3_f32 v96, v96, v53, v54
    v_min3_f32 v97, v97, v53, v54
    v_max_f32 v96, v96, v55
    s_waitcnt lgkmcnt(10)
    v_mfma_f32_32x32x16_bf16 v[64:79], a[88:91], v[216:219], v[64:79]
    s_add_u32 m0, s60, 49152
    s_nop 0
    buffer_load_dwordx4 v28, s[8:11], s45 offen lds
    v_min_f32 v97, v97, v55
    v_mov_b32 v98, v96
    v_mov_b32 v99, v97
    v_nop
    v_permlane32_swap_b32 v96, v98
    v_permlane32_swap_b32 v97, v99
    v_mfma_f32_32x32x16_bf16 v[80:95], a[88:91], a[96:99], v[80:95]
    v_max_f32 v96, v96, v98
    v_min_f32 v97, v97, v99
    v_mul_f32 v100, s66, v96
    v_mul_f32 v102, s64, v97
    v_fma_f32 v104, v48, s64, v100
    v_fma_f32 v112, v48, s66, v102
    s_waitcnt lgkmcnt(8)
    v_mfma_f32_32x32x16_bf16 v[64:79], a[92:95], v[220:223], v[64:79]
    buffer_load_dwordx4 v29, s[8:11], s45 offen offset:1024 lds
    v_fma_f32 v105, v49, s64, v100
    v_fma_f32 v113, v49, s66, v102
    v_fma_f32 v106, v50, s64, v100
    v_fma_f32 v114, v50, s66, v102
    v_fma_f32 v107, v51, s64, v100
    v_mfma_f32_32x32x16_bf16 v[80:95], a[92:95], a[96:99], v[80:95]
    v_fma_f32 v115, v51, s66, v102
    v_fma_f32 v108, v52, s64, v100
    v_fma_f32 v116, v52, s66, v102
    v_fma_f32 v109, v53, s64, v100
    v_fma_f32 v117, v53, s66, v102
    v_fma_f32 v110, v54, s64, v100
    v_fma_f32 v118, v54, s66, v102
    v_fma_f32 v111, v55, s64, v100
    v_fma_f32 v119, v55, s66, v102
    v_exp_f32 v104, v104
    v_exp_f32 v112, v112
    s_waitcnt lgkmcnt(6)
    v_mfma_f32_32x32x16_bf16 v[64:79], a[64:67], v[224:227], v[64:79]
    s_add_u32 m0, s60, 57344
    s_nop 0
    buffer_load_dwordx4 v28, s[8:11], s46 offen lds
    ds_read_b64_tr_b16 a[80:81], v120 offset:40960
    v_mfma_f32_32x32x16_bf16 v[80:95], a[64:67], a[96:99], v[80:95]
    ds_read_b64_tr_b16 a[82:83], v120 offset:41472
    ds_read_b64_tr_b16 a[84:85], v121 offset:40960
    ds_read_b64_tr_b16 a[86:87], v121 offset:41472
    ds_read_b64_tr_b16 a[88:89], v122 offset:40960
    ds_read_b64_tr_b16 a[90:91], v122 offset:41472
    s_waitcnt lgkmcnt(10)
    v_mfma_f32_32x32x16_bf16 v[64:79], a[68:71], v[228:231], v[64:79]
    buffer_load_dwordx4 v29, s[8:11], s46 offen offset:1024 lds
    ds_read_b64_tr_b16 a[92:93], v123 offset:40960
    ds_read_b64_tr_b16 a[94:95], v123 offset:41472
    v_exp_f32 v105, v105
    v_exp_f32 v113, v113
    v_exp_f32 v106, v106
    v_exp_f32 v114, v114
    v_mfma_f32_32x32x16_bf16 v[80:95], a[68:71], a[96:99], v[80:95]
    v_exp_f32 v107, v107
    v_exp_f32 v115, v115
    v_exp_f32 v108, v108
    v_exp_f32 v116, v116
    v_exp_f32 v109, v109
    s_waitcnt lgkmcnt(10)
    v_mfma_f32_32x32x16_bf16 v[64:79], a[72:75], v[232:235], v[64:79]
    s_add_u32 m0, s60, 65536
    s_nop 0
    buffer_load_dwordx4 v28, s[8:11], s47 offen lds
    v_exp_f32 v117, v117
    v_exp_f32 v110, v110
    v_exp_f32 v118, v118
    v_exp_f32 v111, v111
    v_exp_f32 v119, v119
    v_add_f32 v48, v104, v105
    v_mfma_f32_32x32x16_bf16 v[80:95], a[72:75], a[96:99], v[80:95]
    v_add_f32 v52, v112, v113
    v_add_f32 v49, v106, v107
    v_add_f32 v53, v114, v115
    v_add_f32 v50, v108, v109
    v_add_f32 v54, v116, v117
    s_waitcnt lgkmcnt(8)
    v_mfma_f32_32x32x16_bf16 v[64:79], a[76:79], v[236:239], v[64:79]
    buffer_load_dwordx4 v29, s[8:11], s47 offen offset:1024 lds
    v_add_f32 v51, v110, v111
    v_add_f32 v55, v118, v119
    v_add_f32 v48, v48, v49
    v_add_f32 v50, v50, v51
    v_add_f32 v52, v52, v53
    v_add_f32 v54, v54, v55
    v_mfma_f32_32x32x16_bf16 v[80:95], a[76:79], a[96:99], v[80:95]
    v_add_f32 v48, v48, v50
    v_add_f32 v52, v52, v54
    v_mov_b32 v98, v48
    v_mov_b32 v99, v52
    v_nop
    v_permlane32_swap_b32 v48, v98
    v_permlane32_swap_b32 v52, v99
    v_add_f32 v48, v48, v98
    v_add_f32 v52, v52, v99
    v_rcp_f32 v100, v48
    s_waitcnt lgkmcnt(6)
    v_mfma_f32_32x32x16_bf16 v[64:79], a[80:83], v[240:243], v[64:79]
    s_lshl_b32 s57, s25, 10
    s_lshl_b32 s56, s28, 8
    s_add_u32 s57, s57, s56
    s_add_u32 s57, s57, 0xac0000
    v_lshlrev_b32 v7, 2, v1
    s_mov_b32 m0, 163584
    s_nop 0
    buffer_load_dword v7, s[12:15], s57 offen lds
    v_rcp_f32 v102, v52
    v_mfma_f32_32x32x16_bf16 v[80:95], a[80:83], a[96:99], v[80:95]
    v_mul_f32 v104, v100, v104
    v_mul_f32 v105, v100, v105
    v_mul_f32 v106, v100, v106
    v_mul_f32 v107, v100, v107
    s_waitcnt lgkmcnt(4)
    v_mfma_f32_32x32x16_bf16 v[64:79], a[84:87], v[244:247], v[64:79]
    s_lshl_b32 s57, s25, 13
    s_lshl_b32 s56, s26, 10
    s_add_u32 s57, s57, s56
    s_lshl_b32 s56, s28, 8
    s_add_u32 s57, s57, s56
    s_add_u32 s57, s57, 0xa20000
    v_lshlrev_b32 v7, 2, v1
    s_mov_b32 m0, 163584
    s_nop 0
    buffer_load_dword v7, s[12:15], s57 offen lds
    v_mul_f32 v108, v100, v108
    v_mul_f32 v109, v100, v109
    v_mul_f32 v110, v100, v110
    v_mul_f32 v111, v100, v111
    v_mul_f32 v112, v102, v112
    v_mfma_f32_32x32x16_bf16 v[80:95], a[84:87], a[96:99], v[80:95]
    v_mul_f32 v113, v102, v113
    v_mul_f32 v114, v102, v114
    v_mul_f32 v115, v102, v115
    v_mul_f32 v116, v102, v116
    s_waitcnt lgkmcnt(2)
    v_mfma_f32_32x32x16_bf16 v[64:79], a[88:91], v[248:251], v[64:79]
    s_lshl_b32 s57, s25, 16
    s_lshl_b32 s56, s26, 13
    s_add_u32 s57, s57, s56
    s_lshl_b32 s56, s28, 11
    s_add_u32 s57, s57, s56
    s_add_u32 s57, s57, 0xc00000
    v_lshlrev_b32 v7, 5, v1
    s_mov_b32 m0, 163584
    s_nop 0
    buffer_load_dword v7, s[12:15], s57 offen lds
    v_mul_f32 v117, v102, v117
    v_mul_f32 v118, v102, v118
    v_mul_f32 v119, v102, v119
    v_cvt_pk_bf16_f32 v16, v104, v105
    v_cvt_pk_bf16_f32 v17, v106, v107
    v_mfma_f32_32x32x16_bf16 v[80:95], a[88:91], a[96:99], v[80:95]
    v_cvt_pk_bf16_f32 v18, v108, v109
    v_cvt_pk_bf16_f32 v19, v110, v111
    v_cvt_pk_bf16_f32 v20, v112, v113
    v_cvt_pk_bf16_f32 v21, v114, v115
    v_cvt_pk_bf16_f32 v22, v116, v117
    s_waitcnt lgkmcnt(0)
    v_mfma_f32_32x32x16_bf16 v[64:79], a[92:95], v[252:255], v[64:79]
    s_lshl_b32 s57, s25, 16
    s_lshl_b32 s56, s26, 13
    s_add_u32 s57, s57, s56
    s_lshl_b32 s56, s28, 11
    s_add_u32 s57, s57, s56
    s_add_u32 s57, s57, 0xe00000
    v_lshlrev_b32 v7, 5, v1
    s_mov_b32 m0, 163584
    s_nop 0
    buffer_load_dword v7, s[12:15], s57 offen lds
    v_cvt_pk_bf16_f32 v23, v118, v119
    v_accvgpr_read_b32 v96, a112
    ds_write_b64 v96, v[8:9]
    ds_write_b64 v96, v[16:17] offset:4096
    v_mfma_f32_32x32x16_bf16 v[80:95], a[92:95], a[96:99], v[80:95]
    v_accvgpr_read_b32 v96, a113
    ds_write_b64 v96, v[10:11]
    ds_write_b64 v96, v[18:19] offset:4096
    v_accvgpr_read_b32 v96, a114
    ds_write_b64 v96, v[12:13]
    ds_write_b64 v96, v[20:21] offset:4096
    v_accvgpr_read_b32 v96, a115
    ds_write_b64 v96, v[14:15]
    ds_write_b64 v96, v[22:23] offset:4096
    s_mov_b32 s98, 0xac8000
    v_lshlrev_b32 v23, 5, v1
    buffer_load_dwordx4 v[48:51], v23, s[12:15], s98 offen sc1
    buffer_load_dwordx4 v[52:55], v23, s[12:15], s98 offen offset:16 sc1
    v_accvgpr_read_b32 v104, a116
    v_accvgpr_read_b32 v105, a117
    v_pk_mul_f32 v[64:65], v[64:65], v[24:25] op_sel_hi:[1,0]
    v_pk_fma_f32 v[64:65], v[80:81], v[24:25], v[64:65] op_sel:[0,1,0] op_sel_hi:[1,1,1]
    v_pk_mul_f32 v[66:67], v[66:67], v[24:25] op_sel_hi:[1,0]
    v_pk_fma_f32 v[66:67], v[82:83], v[24:25], v[66:67] op_sel:[0,1,0] op_sel_hi:[1,1,1]
    v_pk_mul_f32 v[68:69], v[68:69], v[24:25] op_sel_hi:[1,0]
    v_pk_fma_f32 v[68:69], v[84:85], v[24:25], v[68:69] op_sel:[0,1,0] op_sel_hi:[1,1,1]
    v_pk_mul_f32 v[70:71], v[70:71], v[24:25] op_sel_hi:[1,0]
    v_pk_fma_f32 v[70:71], v[86:87], v[24:25], v[70:71] op_sel:[0,1,0] op_sel_hi:[1,1,1]
    v_pk_mul_f32 v[72:73], v[72:73], v[24:25] op_sel_hi:[1,0]
    v_pk_fma_f32 v[72:73], v[88:89], v[24:25], v[72:73] op_sel:[0,1,0] op_sel_hi:[1,1,1]
    v_pk_mul_f32 v[74:75], v[74:75], v[24:25] op_sel_hi:[1,0]
    v_pk_fma_f32 v[74:75], v[90:91], v[24:25], v[74:75] op_sel:[0,1,0] op_sel_hi:[1,1,1]
    v_pk_mul_f32 v[76:77], v[76:77], v[24:25] op_sel_hi:[1,0]
    v_pk_fma_f32 v[76:77], v[92:93], v[24:25], v[76:77] op_sel:[0,1,0] op_sel_hi:[1,1,1]
    v_pk_mul_f32 v[78:79], v[78:79], v[24:25] op_sel_hi:[1,0]
    v_pk_fma_f32 v[78:79], v[94:95], v[24:25], v[78:79] op_sel:[0,1,0] op_sel_hi:[1,1,1]
    v_cvt_pk_bf16_f32 v96, v64, v65
    v_cvt_pk_bf16_f32 v97, v66, v67
    v_cvt_pk_bf16_f32 v98, v68, v69
    v_cvt_pk_bf16_f32 v99, v70, v71
    v_cvt_pk_bf16_f32 v100, v72, v73
    v_cvt_pk_bf16_f32 v101, v74, v75
    v_cvt_pk_bf16_f32 v102, v76, v77
    v_cvt_pk_bf16_f32 v103, v78, v79
    ds_write_b64 v104, v[96:97]
    ds_write_b64 v104, v[100:101] offset:2048
    ds_write_b64 v105, v[98:99]
    ds_write_b64 v105, v[102:103] offset:2048
    v_accvgpr_read_b32 v16, a118
    v_accvgpr_read_b32 v17, a119
    v_accvgpr_read_b32 v18, a120
    v_accvgpr_read_b32 v19, a121
    v_accvgpr_read_b32 v20, a123
    s_waitcnt lgkmcnt(0)
    s_barrier
    ds_read_b64_tr_b16 v[64:65], v16 offset:0
    ds_read_b64_tr_b16 v[66:67], v17 offset:0
    ds_read_b64_tr_b16 v[68:69], v18 offset:0
    ds_read_b64_tr_b16 v[70:71], v19 offset:0
    ds_read_b64_tr_b16 v[72:73], v16 offset:1024
    ds_read_b64_tr_b16 v[74:75], v17 offset:1024
    ds_read_b64_tr_b16 v[76:77], v18 offset:512
    ds_read_b64_tr_b16 v[78:79], v19 offset:512
    ds_read_b64_tr_b16 v[80:81], v16 offset:2048
    ds_read_b64_tr_b16 v[82:83], v17 offset:2048
    ds_read_b64_tr_b16 v[84:85], v18 offset:1024
    ds_read_b64_tr_b16 v[86:87], v19 offset:1024
    ds_read_b64_tr_b16 v[88:89], v16 offset:3072
    ds_read_b64_tr_b16 v[90:91], v17 offset:3072
    ds_read_b64_tr_b16 v[92:93], v18 offset:1536
    ds_read_b64_tr_b16 v[94:95], v19 offset:1536
    v_mov_b32 v97, s24
    v_mov_b32 v99, s24
    v_mov_b32 v101, s24
    v_mov_b32 v103, s24
    v_mov_b32 v105, s24
    v_mov_b32 v107, s24
    v_mov_b32 v109, s24
    v_mov_b32 v111, s24
    s_waitcnt lgkmcnt(12)
    v_mfma_f32_32x32x16_bf16 v[32:47], v[64:67], v[68:71], 0
    s_waitcnt lgkmcnt(8)
    v_mfma_f32_32x32x16_bf16 v[32:47], v[72:75], v[76:79], v[32:47]
    s_waitcnt lgkmcnt(4)
    v_mfma_f32_32x32x16_bf16 v[32:47], v[80:83], v[84:87], v[32:47]
    s_waitcnt lgkmcnt(0)
    v_mfma_f32_32x32x16_bf16 v[32:47], v[88:91], v[92:95], v[32:47]
    s_mov_b64 exec, s[58:59]
    s_nop 10
    v_cvt_pk_bf16_f32 v96, v32, v33
    v_cvt_pk_bf16_f32 v98, v34, v35
    buffer_store_dwordx4 v[96:99], v20, s[12:15], s85 offen sc1
    s_add_u32 s85, s85, 20480
    v_cvt_pk_bf16_f32 v100, v36, v37
    v_cvt_pk_bf16_f32 v102, v38, v39
    buffer_store_dwordx4 v[100:103], v20, s[12:15], s85 offen sc1
    s_add_u32 s85, s85, 20480
    v_cvt_pk_bf16_f32 v104, v40, v41
    v_cvt_pk_bf16_f32 v106, v42, v43
    buffer_store_dwordx4 v[104:107], v20, s[12:15], s85 offen sc1
    s_add_u32 s85, s85, 20480
    v_cvt_pk_bf16_f32 v108, v44, v45
    v_cvt_pk_bf16_f32 v110, v46, v47
    buffer_store_dwordx4 v[108:111], v20, s[12:15], s85 offen sc1
    s_mov_b64 exec, -1
    s_getreg_b32 s56, hwreg(HW_REG_XCC_ID)
    s_and_b32 s68, s56, 15
    s_lshl_b32 s56, s25, 3
    s_add_u32 s56, s56, s26
    s_lshl_b32 s56, s56, 3
    s_add_u32 s56, s56, 0xac9000
    v_mov_b32 v6, s68
    v_mov_b32 v7, s24
    v_mov_b32 v5, 0
    s_mov_b64 exec, 1
    buffer_store_dwordx2 v[6:7], v5, s[12:15], s56 offen sc1
    s_mov_b64 exec, -1
    s_waitcnt vmcnt(6)
    v_xor_b32 v5, s24, v48
    v_bitop3_b32 v5, v49, s24, v5 bitop3:0xbe
    v_bitop3_b32 v5, v50, s24, v5 bitop3:0xbe
    v_bitop3_b32 v5, v51, s24, v5 bitop3:0xbe
    s_waitcnt vmcnt(5)
    v_bitop3_b32 v5, v52, s24, v5 bitop3:0xbe
    v_bitop3_b32 v5, v53, s24, v5 bitop3:0xbe
    v_bitop3_b32 v5, v54, s24, v5 bitop3:0xbe
    v_bitop3_b32 v5, v55, s24, v5 bitop3:0xbe
    v_cmp_ne_u32 vcc, 0, v5
    s_nop 4
    s_cbranch_vccz L_s0_6_ok
    s_mov_b32 s69, 0
L_s0_6:
    buffer_load_dwordx4 v[48:51], v23, s[12:15], s98 offen sc1
    buffer_load_dwordx4 v[52:55], v23, s[12:15], s98 offen offset:16 sc1
    s_add_u32 s69, s69, 1
    s_cmp_gt_u32 s69, 200000
    s_cbranch_scc1 L_end
    s_waitcnt vmcnt(0)
    v_xor_b32 v5, s24, v48
    v_bitop3_b32 v5, v49, s24, v5 bitop3:0xbe
    v_bitop3_b32 v5, v50, s24, v5 bitop3:0xbe
    v_bitop3_b32 v5, v51, s24, v5 bitop3:0xbe
    v_bitop3_b32 v5, v52, s24, v5 bitop3:0xbe
    v_bitop3_b32 v5, v53, s24, v5 bitop3:0xbe
    v_bitop3_b32 v5, v54, s24, v5 bitop3:0xbe
    v_bitop3_b32 v5, v55, s24, v5 bitop3:0xbe
    v_cmp_ne_u32 vcc, 0, v5
    s_nop 4
    s_cbranch_vccnz L_s0_6
L_s0_6_ok:
    s_nop 1
    s_barrier
    ds_read_b64_tr_b16 a[64:65], v120 offset:49152
    ds_read_b64_tr_b16 a[66:67], v120 offset:49664
    ds_read_b64_tr_b16 a[68:69], v121 offset:49152
    ds_read_b64_tr_b16 a[70:71], v121 offset:49664
    ds_read_b64_tr_b16 a[72:73], v122 offset:49152
    ds_read_b64_tr_b16 a[74:75], v122 offset:49664
    ds_read_b64_tr_b16 a[76:77], v123 offset:49152
    ds_read_b64_tr_b16 a[78:79], v123 offset:49664
    s_waitcnt lgkmcnt(6)
    v_mfma_f32_32x32x16_bf16 v[32:47], a[64:67], v[128:131], 0
    s_lshl_b32 s56, s26, 7
    s_add_u32 s56, s56, s31
    s_add_u32 m0, s60, 24576
    s_nop 0
    buffer_load_dwordx4 v26, s[4:7], s56 offen lds
    ds_read_b64_tr_b16 a[80:81], v120 offset:57344
    v_mfma_f32_32x32x16_bf16 v[48:63], a[64:67], a[96:99], 0
    ds_read_b64_tr_b16 a[82:83], v120 offset:57856
    ds_read_b64_tr_b16 a[84:85], v121 offset:57344
    s_waitcnt lgkmcnt(7)
    v_mfma_f32_32x32x16_bf16 v[32:47], a[68:71], v[132:135], v[32:47]
    buffer_load_dwordx4 v27, s[4:7], s56 offen offset:1024 lds
    ds_read_b64_tr_b16 a[86:87], v121 offset:57856
    ds_read_b64_tr_b16 a[88:89], v122 offset:57344
    ds_read_b64_tr_b16 a[90:91], v122 offset:57856
    s_waitcnt lgkmcnt(8)
    v_mfma_f32_32x32x16_bf16 v[32:47], a[72:75], v[136:139], v[32:47]
    s_lshl_b32 s70, s26, 2
    s_add_u32 s70, s70, s28
    s_mul_i32 s70, s70, 16
    s_add_u32 s70, s70, 0
    s_lshl_b32 s70, s70, 10
    s_mul_i32 s71, s27, 4
    s_add_u32 s71, s71, 0
    s_and_b32 s71, s71, 15
    s_lshl_b32 s72, s71, 10
    s_add_u32 s72, s72, s70
    s_add_u32 s71, s71, 4
    buffer_load_dwordx4 a[128:131], v4, s[12:15], s72 offen offset:0 sc1
    ds_read_b64_tr_b16 a[92:93], v123 offset:57344
    ds_read_b64_tr_b16 a[94:95], v123 offset:57856
    v_mfma_f32_32x32x16_bf16 v[48:63], a[72:75], a[96:99], v[48:63]
    s_waitcnt lgkmcnt(8)
    v_mfma_f32_32x32x16_bf16 v[32:47], a[76:79], v[140:143], v[32:47]
    buffer_load_dwordx4 a[132:135], v4, s[12:15], s72 offen offset:1024 sc1
    s_waitcnt lgkmcnt(6)
    v_mfma_f32_32x32x16_bf16 v[32:47], a[80:83], v[144:147], v[32:47]
    ds_read_b64_tr_b16 a[64:65], v124 offset:0
    v_mfma_f32_32x32x16_bf16 v[48:63], a[80:83], a[96:99], v[48:63]
    buffer_load_dwordx4 a[136:139], v4, s[12:15], s72 offen offset:2048 sc1
    ds_read_b64_tr_b16 a[66:67], v124 offset:512
    ds_read_b64_tr_b16 a[68:69], v125 offset:0
    s_waitcnt lgkmcnt(7)
    v_mfma_f32_32x32x16_bf16 v[32:47], a[84:87], v[148:151], v[32:47]
    ds_read_b64_tr_b16 a[70:71], v125 offset:512
    ds_read_b64_tr_b16 a[72:73], v126 offset:0
    ds_read_b64_tr_b16 a[74:75], v126 offset:512
    s_waitcnt lgkmcnt(8)
    v_mfma_f32_32x32x16_bf16 v[32:47], a[88:91], v[152:155], v[32:47]
    ds_read_b64_tr_b16 a[76:77], v127 offset:0
    ds_read_b64_tr_b16 a[78:79], v127 offset:512
    v_mfma_f32_32x32x16_bf16 v[48:63], a[88:91], a[96:99], v[48:63]
    buffer_load_dwordx4 a[140:143], v4, s[12:15], s72 offen offset:3072 sc1
    s_waitcnt lgkmcnt(8)
    v_mfma_f32_32x32x16_bf16 v[32:47], a[92:95], v[156:159], v[32:47]
    s_waitcnt lgkmcnt(6)
    v_mfma_f32_32x32x16_bf16 v[32:47], a[64:67], v[160:163], v[32:47]
    ds_read_b64_tr_b16 a[80:81], v124 offset:8192
    v_mfma_f32_32x32x16_bf16 v[48:63], a[64:67], a[96:99], v[48:63]
    s_and_b32 s71, s71, 15
    s_lshl_b32 s72, s71, 10
    s_add_u32 s72, s72, s70
    s_add_u32 s71, s71, 4
    buffer_load_dwordx4 a[144:147], v4, s[12:15], s72 offen offset:0 sc1
    ds_read_b64_tr_b16 a[82:83], v124 offset:8704
    ds_read_b64_tr_b16 a[84:85], v125 offset:8192
    s_waitcnt lgkmcnt(7)
    v_mfma_f32_32x32x16_bf16 v[32:47], a[68:71], v[164:167], v[32:47]
    ds_read_b64_tr_b16 a[86:87], v125 offset:8704
    ds_read_b64_tr_b16 a[88:89], v126 offset:8192
    ds_read_b64_tr_b16 a[90:91], v126 offset:8704
    s_waitcnt lgkmcnt(8)
    v_mfma_f32_32x32x16_bf16 v[32:47], a[72:75], v[168:171], v[32:47]
    ds_read_b64_tr_b16 a[92:93], v127 offset:8192
    ds_read_b64_tr_b16 a[94:95], v127 offset:8704
    v_mfma_f32_32x32x16_bf16 v[48:63], a[72:75], a[96:99], v[48:63]
    buffer_load_dwordx4 a[148:151], v4, s[12:15], s72 offen offset:1024 sc1
    s_waitcnt lgkmcnt(8)
    v_mfma_f32_32x32x16_bf16 v[32:47], a[76:79], v[172:175], v[32:47]
    s_waitcnt lgkmcnt(6)
    v_mfma_f32_32x32x16_bf16 v[32:47], a[80:83], v[176:179], v[32:47]
    ds_read_b64_tr_b16 a[64:65], v124 offset:16384
    v_mfma_f32_32x32x16_bf16 v[48:63], a[80:83], a[96:99], v[48:63]
    buffer_load_dwordx4 a[152:155], v4, s[12:15], s72 offen offset:2048 sc1
    ds_read_b64_tr_b16 a[66:67], v124 offset:16896
    ds_read_b64_tr_b16 a[68:69], v125 offset:16384
    s_waitcnt lgkmcnt(7)
    v_mfma_f32_32x32x16_bf16 v[32:47], a[84:87], v[180:183], v[32:47]
    ds_read_b64_tr_b16 a[70:71], v125 offset:16896
    ds_read_b64_tr_b16 a[72:73], v126 offset:16384
    ds_read_b64_tr_b16 a[74:75], v126 offset:16896
    s_waitcnt lgkmcnt(8)
    v_mfma_f32_32x32x16_bf16 v[32:47], a[88:91], v[184:187], v[32:47]
    ds_read_b64_tr_b16 a[76:77], v127 offset:16384
    ds_read_b64_tr_b16 a[78:79], v127 offset:16896
    v_mfma_f32_32x32x16_bf16 v[48:63], a[88:91], a[96:99], v[48:63]
    buffer_load_dwordx4 a[156:159], v4, s[12:15], s72 offen offset:3072 sc1
    s_waitcnt lgkmcnt(8)
    v_mfma_f32_32x32x16_bf16 v[32:47], a[92:95], v[188:191], v[32:47]
    v_accvgpr_read_b32 v22, a124
    s_mov_b64 exec, s[58:59]
    buffer_load_dwordx4 v[64:67], v22, s[12:15], s86 offen offset:0 sc1
    buffer_load_dwordx4 v[68:71], v22, s[12:15], s86 offen offset:1280 sc1
    buffer_load_dwordx4 v[72:75], v22, s[12:15], s86 offen offset:2560 sc1
    buffer_load_dwordx4 v[76:79], v22, s[12:15], s86 offen offset:3840 sc1
    s_mov_b64 exec, -1
    s_waitcnt lgkmcnt(6)
    v_mfma_f32_32x32x16_bf16 v[32:47], a[64:67], v[192:195], v[32:47]
    ds_read_b64_tr_b16 a[80:81], v124 offset:49152
    v_mfma_f32_32x32x16_bf16 v[48:63], a[64:67], a[96:99], v[48:63]
    ds_read_b64_tr_b16 a[82:83], v124 offset:49664
    ds_read_b64_tr_b16 a[84:85], v125 offset:49152
    s_waitcnt lgkmcnt(7)
    v_mfma_f32_32x32x16_bf16 v[32:47], a[68:71], v[196:199], v[32:47]
    ds_read_b64_tr_b16 a[86:87], v125 offset:49664
    ds_read_b64_tr_b16 a[88:89], v126 offset:49152
    ds_read_b64_tr_b16 a[90:91], v126 offset:49664
    s_waitcnt lgkmcnt(8)
    v_mfma_f32_32x32x16_bf16 v[32:47], a[72:75], v[200:203], v[32:47]
    ds_read_b64_tr_b16 a[92:93], v127 offset:49152
    ds_read_b64_tr_b16 a[94:95], v127 offset:49664
    v_mfma_f32_32x32x16_bf16 v[48:63], a[72:75], a[96:99], v[48:63]
    s_waitcnt lgkmcnt(8)
    v_mfma_f32_32x32x16_bf16 v[32:47], a[76:79], v[204:207], v[32:47]
    s_waitcnt lgkmcnt(6)
    v_mfma_f32_32x32x16_bf16 v[32:47], a[80:83], v[208:211], v[32:47]
    s_and_b32 s71, s71, 15
    s_lshl_b32 s72, s71, 10
    s_add_u32 s72, s72, s70
    s_add_u32 s71, s71, 4
    buffer_load_dwordx4 a[160:163], v4, s[12:15], s72 offen offset:0 sc1
    ds_read_b64_tr_b16 a[64:65], v124 offset:57344
    v_mfma_f32_32x32x16_bf16 v[48:63], a[80:83], a[96:99], v[48:63]
    ds_read_b64_tr_b16 a[66:67], v124 offset:57856
    ds_read_b64_tr_b16 a[68:69], v125 offset:57344
    s_waitcnt lgkmcnt(7)
    v_mfma_f32_32x32x16_bf16 v[32:47], a[84:87], v[212:215], v[32:47]
    buffer_load_dwordx4 a[164:167], v4, s[12:15], s72 offen offset:1024 sc1
    ds_read_b64_tr_b16 a[70:71], v125 offset:57856
    ds_read_b64_tr_b16 a[72:73], v126 offset:57344
    ds_read_b64_tr_b16 a[74:75], v126 offset:57856
    s_waitcnt lgkmcnt(8)
    v_mfma_f32_32x32x16_bf16 v[32:47], a[88:91], v[216:219], v[32:47]
    ds_read_b64_tr_b16 a[76:77], v127 offset:57344
    ds_read_b64_tr_b16 a[78:79], v127 offset:57856
    v_mfma_f32_32x32x16_bf16 v[48:63], a[88:91], a[96:99], v[48:63]
    buffer_load_dwordx4 a[168:171], v4, s[12:15], s72 offen offset:2048 sc1
    s_waitcnt lgkmcnt(8)
    v_mfma_f32_32x32x16_bf16 v[32:47], a[92:95], v[220:223], v[32:47]
    s_mov_b64 exec, s[58:59]
    s_waitcnt vmcnt(6)
    v_xor_b32 v5, s24, v65
    v_bitop3_b32 v5, v67, s24, v5 bitop3:0xbe
    s_waitcnt vmcnt(5)
    v_bitop3_b32 v5, v69, s24, v5 bitop3:0xbe
    v_bitop3_b32 v5, v71, s24, v5 bitop3:0xbe
    s_waitcnt vmcnt(4)
    v_bitop3_b32 v5, v73, s24, v5 bitop3:0xbe
    v_bitop3_b32 v5, v75, s24, v5 bitop3:0xbe
    s_waitcnt vmcnt(3)
    v_bitop3_b32 v5, v77, s24, v5 bitop3:0xbe
    v_bitop3_b32 v5, v79, s24, v5 bitop3:0xbe
    v_cmp_ne_u32 vcc, 0, v5
    s_nop 4
    s_cbranch_vccz L_rkv_7_ok
    s_mov_b32 s69, 0
L_rkv_7:
    buffer_load_dwordx4 v[64:67], v22, s[12:15], s86 offen offset:0 sc1
    buffer_load_dwordx4 v[68:71], v22, s[12:15], s86 offen offset:1280 sc1
    buffer_load_dwordx4 v[72:75], v22, s[12:15], s86 offen offset:2560 sc1
    buffer_load_dwordx4 v[76:79], v22, s[12:15], s86 offen offset:3840 sc1
    s_add_u32 s69, s69, 1
    s_cmp_gt_u32 s69, 200000
    s_cbranch_scc1 L_end
    s_waitcnt vmcnt(0)
    v_xor_b32 v5, s24, v65
    v_bitop3_b32 v5, v67, s24, v5 bitop3:0xbe
    v_bitop3_b32 v5, v69, s24, v5 bitop3:0xbe
    v_bitop3_b32 v5, v71, s24, v5 bitop3:0xbe
    v_bitop3_b32 v5, v73, s24, v5 bitop3:0xbe
    v_bitop3_b32 v5, v75, s24, v5 bitop3:0xbe
    v_bitop3_b32 v5, v77, s24, v5 bitop3:0xbe
    v_bitop3_b32 v5, v79, s24, v5 bitop3:0xbe
    v_cmp_ne_u32 vcc, 0, v5
    s_nop 4
    s_cbranch_vccnz L_rkv_7
L_rkv_7_ok:
    s_nop 1
    s_mov_b64 exec, -1
    v_lshlrev_b32 v80, 16, v64
    v_and_b32 v81, 0xffff0000, v64
    v_lshlrev_b32 v82, 16, v66
    v_and_b32 v83, 0xffff0000, v66
    v_lshlrev_b32 v84, 16, v68
    v_and_b32 v85, 0xffff0000, v68
    v_lshlrev_b32 v86, 16, v70
    v_and_b32 v87, 0xffff0000, v70
    v_pk_add_f32 v[80:81], v[80:81], v[84:85]
    v_pk_add_f32 v[82:83], v[82:83], v[86:87]
    v_lshlrev_b32 v84, 16, v72
    v_and_b32 v85, 0xffff0000, v72
    v_lshlrev_b32 v86, 16, v74
    v_and_b32 v87, 0xffff0000, v74
    v_pk_add_f32 v[80:81], v[80:81], v[84:85]
    v_pk_add_f32 v[82:83], v[82:83], v[86:87]
    v_lshlrev_b32 v84, 16, v76
    v_and_b32 v85, 0xffff0000, v76
    v_lshlrev_b32 v86, 16, v78
    v_and_b32 v87, 0xffff0000, v78
    v_pk_add_f32 v[80:81], v[80:81], v[84:85]
    v_pk_add_f32 v[82:83], v[82:83], v[86:87]
    v_mov_b32 v84, v80
    v_mov_b32 v85, v81
    v_mov_b32 v86, v82
    v_mov_b32 v87, v83
    v_permlane32_swap_b32 v80, v84
    v_permlane32_swap_b32 v81, v85
    v_permlane32_swap_b32 v82, v86
    v_permlane32_swap_b32 v83, v87
    v_pk_add_f32 v[80:81], v[80:81], v[84:85]
    v_pk_add_f32 v[82:83], v[82:83], v[86:87]
    s_lshl_b32 s56, s28, 9
    s_add_u32 s56, s56, 159744
    v_lshl_add_u32 v8, v2, 4, s56
    ds_write_b128 v8, v[80:83]
    s_waitcnt lgkmcnt(0)
    s_barrier
    s_nop 0
    s_cmp_eq_u32 s28, 0
    s_cbranch_scc0 L_rk2_8
    v_lshlrev_b32 v8, 4, v2
    v_add_u32 v8, 159744, v8
    ds_read_b128 v[64:67], v8
    ds_read_b128 v[68:71], v8 offset:512
    ds_read_b128 v[72:75], v8 offset:1024
    ds_read_b128 v[76:79], v8 offset:1536
    s_lshr_b32 s56, s25, 3
    s_lshl_b32 s57, s26, 2
    s_add_u32 s56, s56, s57
    s_lshl_b32 s56, s56, 12
    s_bfe_u32 s57, s25, 0x20001
    s_lshl_b32 s57, s57, 10
    s_add_u32 s56, s56, s57
    s_and_b32 s57, s25, 1
    s_mul_i32 s57, s57, 272
    s_add_u32 s56, s56, s57
    s_add_u32 s56, s56, 0xa00000
    v_lshlrev_b32 v8, 4, v2
    s_waitcnt lgkmcnt(0)
    v_pk_add_f32 v[64:65], v[64:65], v[68:69]
    v_pk_add_f32 v[66:67], v[66:67], v[70:71]
    v_pk_add_f32 v[72:73], v[72:73], v[76:77]
    v_pk_add_f32 v[74:75], v[74:75], v[78:79]
    v_pk_add_f32 v[64:65], v[64:65], v[72:73]
    v_pk_add_f32 v[66:67], v[66:67], v[74:75]
    v_cvt_pk_bf16_f32 v68, v64, v65
    v_cvt_pk_bf16_f32 v70, v66, v67
    v_mov_b32 v69, s24
    v_mov_b32 v71, s24
    s_mov_b32 s57, 0x1ffff
    s_mov_b32 exec_hi, 0
    s_mov_b32 exec_lo, s57
    buffer_store_dwordx4 v[68:71], v8, s[12:15], s56 offen sc1
    s_mov_b64 exec, -1
L_rk2_8:
    s_nop 0
    v_mfma_f32_32x32x16_bf16 v[32:47], a[64:67], v[224:227], v[32:47]
    buffer_load_dwordx4 a[172:175], v4, s[12:15], s72 offen offset:3072 sc1
    ds_read_b64_tr_b16 a[80:81], v120 offset:0
    v_mfma_f32_32x32x16_bf16 v[48:63], a[64:67], a[96:99], v[48:63]
    ds_read_b64_tr_b16 a[82:83], v120 offset:512
    ds_read_b64_tr_b16 a[84:85], v121 offset:0
    v_mfma_f32_32x32x16_bf16 v[32:47], a[68:71], v[228:231], v[32:47]
    s_and_b32 s71, s71, 15
    s_lshl_b32 s72, s71, 10
    s_add_u32 s72, s72, s70
    s_add_u32 s71, s71, 4
    buffer_load_dwordx4 a[176:179], v4, s[12:15], s72 offen offset:0 sc1
    ds_read_b64_tr_b16 a[86:87], v121 offset:512
    ds_read_b64_tr_b16 a[88:89], v122 offset:0
    ds_read_b64_tr_b16 a[90:91], v122 offset:512
    v_mfma_f32_32x32x16_bf16 v[32:47], a[72:75], v[232:235], v[32:47]
    ds_read_b64_tr_b16 a[92:93], v123 offset:0
    ds_read_b64_tr_b16 a[94:95], v123 offset:512
    v_mfma_f32_32x32x16_bf16 v[48:63], a[72:75], a[96:99], v[48:63]
    buffer_load_dwordx4 a[180:183], v4, s[12:15], s72 offen offset:1024 sc1
    v_mfma_f32_32x32x16_bf16 v[32:47], a[76:79], v[236:239], v[32:47]
    s_waitcnt lgkmcnt(6)
    v_mfma_f32_32x32x16_bf16 v[32:47], a[80:83], v[240:243], v[32:47]
    v_mfma_f32_32x32x16_bf16 v[48:63], a[80:83], a[96:99], v[48:63]
    buffer_load_dwordx4 a[184:187], v4, s[12:15], s72 offen offset:2048 sc1
    s_waitcnt lgkmcnt(4)
    v_mfma_f32_32x32x16_bf16 v[32:47], a[84:87], v[244:247], v[32:47]
    s_waitcnt lgkmcnt(2)
    v_mfma_f32_32x32x16_bf16 v[32:47], a[88:91], v[248:251], v[32:47]
    v_mfma_f32_32x32x16_bf16 v[48:63], a[88:91], a[96:99], v[48:63]
    buffer_load_dwordx4 a[188:191], v4, s[12:15], s72 offen offset:3072 sc1
    s_waitcnt lgkmcnt(0)
    v_mfma_f32_32x32x16_bf16 v[32:47], a[92:95], v[252:255], v[32:47]
    s_lshl_b32 s56, s28, 7
    s_add_u32 s56, s56, 162816
    v_lshl_add_u32 v5, v3, 6, s56
    s_mov_b32 s56, 1
    s_mov_b32 s57, 1
    s_mov_b64 exec, s[56:57]
    s_nop 2
    ds_write_b128 v5, v[48:51] offset:0
    ds_write_b128 v5, v[52:55] offset:16
    ds_write_b128 v5, v[56:59] offset:32
    ds_write_b128 v5, v[60:63] offset:48
    s_mov_b64 exec, -1
    s_waitcnt lgkmcnt(0)
    s_barrier
    s_lshl_b32 s56, s26, 7
    s_add_u32 s56, s56, s31
    s_lshl_b32 s57, s63, 6
    s_add_u32 s89, s56, s57
    s_lshl_b32 s56, s62, 5
    v_add_u32 v5, s56, v2
    v_lshrrev_b32 v6, 1, v2
    v_and_b32 v6, 7, v6
    v_lshlrev_b32 v5, 7, v5
    v_lshl_add_u32 v5, v3, 3, v5
    v_add_u32 v5, 24576, v5
    s_lshl_b32 s56, s63, 2
    v_mov_b32 v7, 0
    v_add_u32 v7, s56, v7
    v_xor_b32 v7, v7, v6
    v_lshl_add_u32 v7, v7, 4, v5
    ds_read_b64 v[120:121], v7
    v_mov_b32 v7, 1
    v_add_u32 v7, s56, v7
    v_xor_b32 v7, v7, v6
    v_lshl_add_u32 v7, v7, 4, v5
    ds_read_b64 v[122:123], v7
    v_mov_b32 v7, 2
    v_add_u32 v7, s56, v7
    v_xor_b32 v7, v7, v6
    v_lshl_add_u32 v7, v7, 4, v5
    ds_read_b64 v[124:125], v7
    v_mov_b32 v7, 3
    v_add_u32 v7, s56, v7
    v_xor_b32 v7, v7, v6
    v_lshl_add_u32 v7, v7, 4, v5
    ds_read_b64 v[126:127], v7
    s_xor_b32 s56, s28, 1
    s_lshl_b32 s56, s56, 7
    s_add_u32 s56, s56, 162816
    v_lshl_add_u32 v6, v3, 6, s56
    ds_read_b128 v[64:67], v6 offset:0
    ds_read_b128 v[68:71], v6 offset:16
    ds_read_b128 v[72:75], v6 offset:32
    ds_read_b128 v[76:79], v6 offset:48
    s_waitcnt lgkmcnt(3)
    v_pk_add_f32 v[48:49], v[48:49], v[64:65]
    v_pk_add_f32 v[50:51], v[50:51], v[66:67]
    s_waitcnt lgkmcnt(2)
    v_pk_add_f32 v[52:53], v[52:53], v[68:69]
    v_pk_add_f32 v[54:55], v[54:55], v[70:71]
    s_waitcnt lgkmcnt(1)
    v_pk_add_f32 v[56:57], v[56:57], v[72:73]
    v_pk_add_f32 v[58:59], v[58:59], v[74:75]
    s_waitcnt lgkmcnt(0)
    v_pk_add_f32 v[60:61], v[60:61], v[76:77]
    v_pk_add_f32 v[62:63], v[62:63], v[78:79]
    v_pk_mul_f32 v[32:33], v[32:33], v[24:25] op_sel_hi:[1,0]
    v_pk_fma_f32 v[32:33], v[48:49], v[24:25], v[32:33] op_sel:[0,1,0] op_sel_hi:[1,1,1]
    v_pk_mul_f32 v[34:35], v[34:35], v[24:25] op_sel_hi:[1,0]
    v_pk_fma_f32 v[34:35], v[50:51], v[24:25], v[34:35] op_sel:[0,1,0] op_sel_hi:[1,1,1]
    v_pk_mul_f32 v[36:37], v[36:37], v[24:25] op_sel_hi:[1,0]
    v_pk_fma_f32 v[36:37], v[52:53], v[24:25], v[36:37] op_sel:[0,1,0] op_sel_hi:[1,1,1]
    v_pk_mul_f32 v[38:39], v[38:39], v[24:25] op_sel_hi:[1,0]
    v_pk_fma_f32 v[38:39], v[54:55], v[24:25], v[38:39] op_sel:[0,1,0] op_sel_hi:[1,1,1]
    v_pk_mul_f32 v[40:41], v[40:41], v[24:25] op_sel_hi:[1,0]
    v_pk_fma_f32 v[40:41], v[56:57], v[24:25], v[40:41] op_sel:[0,1,0] op_sel_hi:[1,1,1]
    v_pk_mul_f32 v[42:43], v[42:43], v[24:25] op_sel_hi:[1,0]
    v_pk_fma_f32 v[42:43], v[58:59], v[24:25], v[42:43] op_sel:[0,1,0] op_sel_hi:[1,1,1]
    v_pk_mul_f32 v[44:45], v[44:45], v[24:25] op_sel_hi:[1,0]
    v_pk_fma_f32 v[44:45], v[60:61], v[24:25], v[44:45] op_sel:[0,1,0] op_sel_hi:[1,1,1]
    v_pk_mul_f32 v[46:47], v[46:47], v[24:25] op_sel_hi:[1,0]
    v_pk_fma_f32 v[46:47], v[62:63], v[24:25], v[46:47] op_sel:[0,1,0] op_sel_hi:[1,1,1]
    s_lshl_b32 s56, s25, 6
    s_add_u32 s97, s56, 0xac9000
    v_and_b32 v26, 7, v1
    v_lshlrev_b32 v26, 3, v26
    buffer_load_dwordx2 v[28:29], v26, s[12:15], s97 offen sc1
    s_lshl_b32 s38, s25, 16
    s_lshl_b32 s56, s26, 2
    s_lshl_b32 s57, s63, 1
    s_add_u32 s56, s56, s57
    s_lshl_b32 s56, s56, 11
    s_add_u32 s32, s38, s56
    s_lshl_b32 s56, s63, 1
    s_lshl_b32 s57, s27, 3
    s_sub_u32 s56, s56, s57
    s_and_b32 s56, s56, 31
    s_lshl_b32 s33, s56, 11
    s_lshl_b32 s56, s25, 13
    s_lshl_b32 s57, s26, 1
    s_add_u32 s57, s57, s63
    s_lshl_b32 s57, s57, 9
    s_add_u32 s56, s56, s57
    s_lshl_b32 s57, s62, 8
    s_add_u32 s34, s56, s57
    s_lshl_b32 s56, s25, 10
    s_add_u32 s36, s56, 0xac0000
    s_lshl_b32 s57, s26, 3
    s_add_u32 s35, s36, s57
    s_lshl_b32 s37, s26, 3
    s_lshl_b32 s56, s27, 4
    s_add_u32 s37, s37, s56
    s_lshl_b32 s56, s28, 2
    s_add_u32 s37, s37, s56
    s_lshl_b32 s37, s37, 10
    s_and_b32 s37, s37, 0xffff
    s_lshl_b32 s39, s28, 12
    s_sub_u32 s40, 0, s27
    s_and_b32 s40, s40, 3
    s_cmp_lt_u32 s28, 2
    s_cselect_b32 s40, s40, 4
    s_lshl_b32 s56, s25, 13
    s_lshl_b32 s57, s28, 11
    s_add_u32 s41, s56, s57
    s_lshl_b32 s42, s28, 11
    v_mov_b32 v184, s24
    v_mov_b32 v185, s24
    v_mov_b32 v186, 0
    v_and_b32 v187, 7, v1
    v_lshlrev_b32 v187, 3, v187
    v_cvt_pk_bf16_f32 v8, v32, v33
    v_cvt_pk_bf16_f32 v9, v34, v35
    v_cvt_pk_bf16_f32 v10, v36, v37
    v_cvt_pk_bf16_f32 v11, v38, v39
    v_cvt_pk_bf16_f32 v12, v40, v41
    v_cvt_pk_bf16_f32 v13, v42, v43
    v_cvt_pk_bf16_f32 v14, v44, v45
    v_cvt_pk_bf16_f32 v15, v46, v47
    s_lshl_b32 s70, s26, 2
    s_add_u32 s70, s70, s28
    s_mul_i32 s70, s70, 16
    s_add_u32 s70, s70, 512
    s_lshl_b32 s70, s70, 10
    s_mul_i32 s71, s27, 4
    s_add_u32 s71, s71, 0
    s_and_b32 s71, s71, 15
    s_lshl_b32 s72, s71, 10
    s_add_u32 s72, s72, s70
    s_add_u32 s71, s71, 4
    buffer_load_dwordx4 a[192:195], v4, s[12:15], s72 offen offset:0 sc1
    v_mfma_f32_32x32x16_bf16 v[32:47], a[100:103], v[8:11], 0
    v_mfma_f32_32x32x16_bf16 v[48:63], a[104:107], v[12:15], 0
    s_nop 10
    v_max3_f32 v96, v32, v33, v34
    v_min3_f32 v97, v32, v33, v34
    v_max3_f32 v96, v96, v35, v36
    v_min3_f32 v97, v97, v35, v36
    v_max3_f32 v96, v96, v37, v38
    v_min3_f32 v97, v97, v37, v38
    v_max_f32 v96, v96, v39
    v_min_f32 v97, v97, v39
    v_mov_b32 v98, v96
    v_mov_b32 v99, v97
    v_nop
    v_permlane32_swap_b32 v96, v98
    v_permlane32_swap_b32 v97, v99
    buffer_load_dwordx4 a[196:199], v4, s[12:15], s72 offen offset:1024 sc1
    v_max_f32 v96, v96, v98
    v_min_f32 v97, v97, v99
    v_mul_f32 v100, s66, v96
    v_mul_f32 v102, s64, v97
    v_pk_fma_f32 v[104:105], v[32:33], s[64:65], v[100:101] op_sel_hi:[1,1,0]
    v_pk_fma_f32 v[112:113], v[32:33], s[66:67], v[102:103] op_sel_hi:[1,1,0]
    v_pk_fma_f32 v[106:107], v[34:35], s[64:65], v[100:101] op_sel_hi:[1,1,0]
    v_pk_fma_f32 v[114:115], v[34:35], s[66:67], v[102:103] op_sel_hi:[1,1,0]
    v_pk_fma_f32 v[108:109], v[36:37], s[64:65], v[100:101] op_sel_hi:[1,1,0]
    v_pk_fma_f32 v[116:117], v[36:37], s[66:67], v[102:103] op_sel_hi:[1,1,0]
    v_pk_fma_f32 v[110:111], v[38:39], s[64:65], v[100:101] op_sel_hi:[1,1,0]
    v_pk_fma_f32 v[118:119], v[38:39], s[66:67], v[102:103] op_sel_hi:[1,1,0]
    v_exp_f32 v104, v104
    v_exp_f32 v112, v112
    buffer_load_dwordx4 a[200:203], v4, s[12:15], s72 offen offset:2048 sc1
    v_exp_f32 v105, v105
    v_exp_f32 v113, v113
    v_exp_f32 v106, v106
    v_exp_f32 v114, v114
    v_exp_f32 v107, v107
    v_exp_f32 v115, v115
    v_exp_f32 v108, v108
    v_exp_f32 v116, v116
    v_exp_f32 v109, v109
    v_exp_f32 v117, v117
    v_exp_f32 v110, v110
    v_exp_f32 v118, v118
    v_exp_f32 v111, v111
    v_exp_f32 v119, v119
    v_pk_add_f32 v[32:33], v[104:105], v[106:107]
    buffer_load_dwordx4 a[204:207], v4, s[12:15], s72 offen offset:3072 sc1
    v_pk_add_f32 v[34:35], v[108:109], v[110:111]
    v_pk_add_f32 v[36:37], v[112:113], v[114:115]
    v_pk_add_f32 v[38:39], v[116:117], v[118:119]
    v_pk_add_f32 v[32:33], v[32:33], v[34:35]
    v_pk_add_f32 v[36:37], v[36:37], v[38:39]
    v_add_f32 v32, v32, v33
    v_add_f32 v36, v36, v37
    v_mov_b32 v98, v32
    v_mov_b32 v99, v36
    v_nop
    v_permlane32_swap_b32 v32, v98
    v_permlane32_swap_b32 v36, v99
    v_add_f32 v32, v32, v98
    v_add_f32 v36, v36, v99
    v_rcp_f32 v100, v32
    s_and_b32 s71, s71, 15
    s_lshl_b32 s72, s71, 10
    s_add_u32 s72, s72, s70
    s_add_u32 s71, s71, 4
    buffer_load_dwordx4 a[208:211], v4, s[12:15], s72 offen offset:0 sc1
    v_rcp_f32 v102, v36
    v_pk_mul_f32 v[104:105], v[104:105], v[100:101] op_sel_hi:[1,0]
    v_pk_mul_f32 v[106:107], v[106:107], v[100:101] op_sel_hi:[1,0]
    v_pk_mul_f32 v[108:109], v[108:109], v[100:101] op_sel_hi:[1,0]
    v_pk_mul_f32 v[110:111], v[110:111], v[100:101] op_sel_hi:[1,0]
    v_pk_mul_f32 v[112:113], v[112:113], v[102:103] op_sel_hi:[1,0]
    v_pk_mul_f32 v[114:115], v[114:115], v[102:103] op_sel_hi:[1,0]
    v_pk_mul_f32 v[116:117], v[116:117], v[102:103] op_sel_hi:[1,0]
    v_pk_mul_f32 v[118:119], v[118:119], v[102:103] op_sel_hi:[1,0]
    v_cvt_pk_bf16_f32 v8, v104, v105
    v_cvt_pk_bf16_f32 v9, v106, v107
    v_cvt_pk_bf16_f32 v10, v108, v109
    v_cvt_pk_bf16_f32 v11, v110, v111
    v_cvt_pk_bf16_f32 v12, v112, v113
    v_cvt_pk_bf16_f32 v13, v114, v115
    buffer_load_dwordx4 a[212:215], v4, s[12:15], s72 offen offset:1024 sc1
    v_cvt_pk_bf16_f32 v14, v116, v117
    v_cvt_pk_bf16_f32 v15, v118, v119
    v_max3_f32 v96, v48, v49, v50
    v_min3_f32 v97, v48, v49, v50
    v_max3_f32 v96, v96, v51, v52
    v_min3_f32 v97, v97, v51, v52
    v_max3_f32 v96, v96, v53, v54
    v_min3_f32 v97, v97, v53, v54
    v_max_f32 v96, v96, v55
    v_min_f32 v97, v97, v55
    v_mov_b32 v98, v96
    v_mov_b32 v99, v97
    v_nop
    v_permlane32_swap_b32 v96, v98
    buffer_load_dwordx4 a[216:219], v4, s[12:15], s72 offen offset:2048 sc1
    v_permlane32_swap_b32 v97, v99
    v_max_f32 v96, v96, v98
    v_min_f32 v97, v97, v99
    v_mul_f32 v100, s66, v96
    v_mul_f32 v102, s64, v97
    v_pk_fma_f32 v[104:105], v[48:49], s[64:65], v[100:101] op_sel_hi:[1,1,0]
    v_pk_fma_f32 v[112:113], v[48:49], s[66:67], v[102:103] op_sel_hi:[1,1,0]
    v_pk_fma_f32 v[106:107], v[50:51], s[64:65], v[100:101] op_sel_hi:[1,1,0]
    v_pk_fma_f32 v[114:115], v[50:51], s[66:67], v[102:103] op_sel_hi:[1,1,0]
    v_pk_fma_f32 v[108:109], v[52:53], s[64:65], v[100:101] op_sel_hi:[1,1,0]
    v_pk_fma_f32 v[116:117], v[52:53], s[66:67], v[102:103] op_sel_hi:[1,1,0]
    v_pk_fma_f32 v[110:111], v[54:55], s[64:65], v[100:101] op_sel_hi:[1,1,0]
    v_pk_fma_f32 v[118:119], v[54:55], s[66:67], v[102:103] op_sel_hi:[1,1,0]
    v_exp_f32 v104, v104
    v_exp_f32 v112, v112
    buffer_load_dwordx4 a[220:223], v4, s[12:15], s72 offen offset:3072 sc1
    v_exp_f32 v105, v105
    v_exp_f32 v113, v113
    v_exp_f32 v106, v106
    v_exp_f32 v114, v114
    v_exp_f32 v107, v107
    v_exp_f32 v115, v115
    v_exp_f32 v108, v108
    v_min_u32 v24, 16, v2
    v_mul_u32_u24 v7, 17, v3
    v_add_u32 v24, v24, v7
    s_lshl_b32 s56, s26, 2
    s_lshl_b32 s57, s62, 1
    s_add_u32 s56, s56, s57
    s_lshl_b32 s56, s56, 12
    s_add_u32 s86, s56, 0xa00000
    s_add_u32 s87, s86, 4096
    v_lshlrev_b32 v24, 4, v24
    buffer_load_dwordx4 v[64:67], v24, s[12:15], s86 offen offset:0 sc1
    buffer_load_dwordx4 v[68:71], v24, s[12:15], s86 offen offset:1024 sc1
    buffer_load_dwordx4 v[72:75], v24, s[12:15], s86 offen offset:2048 sc1
    buffer_load_dwordx4 v[76:79], v24, s[12:15], s86 offen offset:3072 sc1
    buffer_load_dwordx4 v[80:83], v24, s[12:15], s87 offen offset:0 sc1
    buffer_load_dwordx4 v[84:87], v24, s[12:15], s87 offen offset:1024 sc1
    buffer_load_dwordx4 v[88:91], v24, s[12:15], s87 offen offset:2048 sc1
    buffer_load_dwordx4 v[92:95], v24, s[12:15], s87 offen offset:3072 sc1
    v_exp_f32 v116, v116
    v_exp_f32 v109, v109
    v_exp_f32 v117, v117
    v_exp_f32 v110, v110
    v_exp_f32 v118, v118
    v_exp_f32 v111, v111
    v_exp_f32 v119, v119
    v_pk_add_f32 v[48:49], v[104:105], v[106:107]
    v_pk_add_f32 v[50:51], v[108:109], v[110:111]
    v_pk_add_f32 v[52:53], v[112:113], v[114:115]
    v_pk_add_f32 v[54:55], v[116:117], v[118:119]
    v_pk_add_f32 v[48:49], v[48:49], v[50:51]
    v_pk_add_f32 v[52:53], v[52:53], v[54:55]
    v_add_f32 v48, v48, v49
    v_add_f32 v52, v52, v53
    v_mov_b32 v98, v48
    v_mov_b32 v99, v52
    v_nop
    v_permlane32_swap_b32 v48, v98
    v_permlane32_swap_b32 v52, v99
    v_add_f32 v48, v48, v98
    v_add_f32 v52, v52, v99
    v_rcp_f32 v100, v48
    v_rcp_f32 v102, v52
    v_pk_mul_f32 v[104:105], v[104:105], v[100:101] op_sel_hi:[1,0]
    v_pk_mul_f32 v[106:107], v[106:107], v[100:101] op_sel_hi:[1,0]
    v_pk_mul_f32 v[108:109], v[108:109], v[100:101] op_sel_hi:[1,0]
    v_pk_mul_f32 v[110:111], v[110:111], v[100:101] op_sel_hi:[1,0]
    v_pk_mul_f32 v[112:113], v[112:113], v[102:103] op_sel_hi:[1,0]
    v_pk_mul_f32 v[114:115], v[114:115], v[102:103] op_sel_hi:[1,0]
    v_pk_mul_f32 v[116:117], v[116:117], v[102:103] op_sel_hi:[1,0]
    v_pk_mul_f32 v[118:119], v[118:119], v[102:103] op_sel_hi:[1,0]
    v_cvt_pk_bf16_f32 v16, v104, v105
    v_cvt_pk_bf16_f32 v17, v106, v107
    v_cvt_pk_bf16_f32 v18, v108, v109
    v_cvt_pk_bf16_f32 v19, v110, v111
    v_cvt_pk_bf16_f32 v20, v112, v113
    v_cvt_pk_bf16_f32 v21, v114, v115
    v_cvt_pk_bf16_f32 v22, v116, v117
    v_cvt_pk_bf16_f32 v23, v118, v119
    s_waitcnt vmcnt(16)
    v_cmp_ne_u32 vcc, s24, v29
    s_nop 4
    s_cbranch_vccz L_xid_9_ok
    s_mov_b32 s69, 0
L_xid_9:
    buffer_load_dwordx2 v[28:29], v26, s[12:15], s97 offen sc1
    s_add_u32 s69, s69, 1
    s_cmp_gt_u32 s69, 200000
    s_cbranch_scc1 L_end
    s_waitcnt vmcnt(0)
    v_cmp_ne_u32 vcc, s24, v29
    s_nop 4
    s_cbranch_vccnz L_xid_9
L_xid_9_ok:
    s_nop 1
    v_cmp_ne_u32 vcc, s68, v28
    s_nop 3
    s_cmp_lg_u64 vcc, 0
    s_cselect_b32 s29, 1, 0
    s_cmp_eq_u32 s29, 1
    s_cbranch_scc1 L_slow_tail
    s_waitcnt vmcnt(7)
    v_xor_b32 v5, s24, v65
    v_bitop3_b32 v5, v67, s24, v5 bitop3:0xbe
    s_waitcnt vmcnt(6)
    v_bitop3_b32 v5, v69, s24, v5 bitop3:0xbe
    v_bitop3_b32 v5, v71, s24, v5 bitop3:0xbe
    s_waitcnt vmcnt(5)
    v_bitop3_b32 v5, v73, s24, v5 bitop3:0xbe
    v_bitop3_b32 v5, v75, s24, v5 bitop3:0xbe
    s_waitcnt vmcnt(4)
    v_bitop3_b32 v5, v77, s24, v5 bitop3:0xbe
    v_bitop3_b32 v5, v79, s24, v5 bitop3:0xbe
    s_waitcnt vmcnt(3)
    v_bitop3_b32 v5, v81, s24, v5 bitop3:0xbe
    v_bitop3_b32 v5, v83, s24, v5 bitop3:0xbe
    s_waitcnt vmcnt(2)
    v_bitop3_b32 v5, v85, s24, v5 bitop3:0xbe
    v_bitop3_b32 v5, v87, s24, v5 bitop3:0xbe
    s_waitcnt vmcnt(1)
    v_bitop3_b32 v5, v89, s24, v5 bitop3:0xbe
    v_bitop3_b32 v5, v91, s24, v5 bitop3:0xbe
    s_waitcnt vmcnt(0)
    v_bitop3_b32 v5, v93, s24, v5 bitop3:0xbe
    v_bitop3_b32 v5, v95, s24, v5 bitop3:0xbe
    v_cmp_ne_u32 vcc, 0, v5
    s_nop 4
    s_cbranch_vccz L_fkv_10_ok
    s_mov_b32 s69, 0
L_fkv_10:
    buffer_load_dwordx4 v[64:67], v24, s[12:15], s86 offen offset:0 sc1
    buffer_load_dwordx4 v[68:71], v24, s[12:15], s86 offen offset:1024 sc1
    buffer_load_dwordx4 v[72:75], v24, s[12:15], s86 offen offset:2048 sc1
    buffer_load_dwordx4 v[76:79], v24, s[12:15], s86 offen offset:3072 sc1
    buffer_load_dwordx4 v[80:83], v24, s[12:15], s87 offen offset:0 sc1
    buffer_load_dwordx4 v[84:87], v24, s[12:15], s87 offen offset:1024 sc1
    buffer_load_dwordx4 v[88:91], v24, s[12:15], s87 offen offset:2048 sc1
    buffer_load_dwordx4 v[92:95], v24, s[12:15], s87 offen offset:3072 sc1
    s_add_u32 s69, s69, 1
    s_cmp_gt_u32 s69, 200000
    s_cbranch_scc1 L_end
    s_waitcnt vmcnt(0)
    v_xor_b32 v5, s24, v65
    v_bitop3_b32 v5, v67, s24, v5 bitop3:0xbe
    v_bitop3_b32 v5, v69, s24, v5 bitop3:0xbe
    v_bitop3_b32 v5, v71, s24, v5 bitop3:0xbe
    v_bitop3_b32 v5, v73, s24, v5 bitop3:0xbe
    v_bitop3_b32 v5, v75, s24, v5 bitop3:0xbe
    v_bitop3_b32 v5, v77, s24, v5 bitop3:0xbe
    v_bitop3_b32 v5, v79, s24, v5 bitop3:0xbe
    v_bitop3_b32 v5, v81, s24, v5 bitop3:0xbe
    v_bitop3_b32 v5, v83, s24, v5 bitop3:0xbe
    v_bitop3_b32 v5, v85, s24, v5 bitop3:0xbe
    v_bitop3_b32 v5, v87, s24, v5 bitop3:0xbe
    v_bitop3_b32 v5, v89, s24, v5 bitop3:0xbe
    v_bitop3_b32 v5, v91, s24, v5 bitop3:0xbe
    v_bitop3_b32 v5, v93, s24, v5 bitop3:0xbe
    v_bitop3_b32 v5, v95, s24, v5 bitop3:0xbe
    v_cmp_ne_u32 vcc, 0, v5
    s_nop 4
    s_cbranch_vccnz L_fkv_10
L_fkv_10_ok:
    s_nop 1
    v_mov_b32 v96, v64
    v_mov_b32 v97, v66
    v_mov_b32 v98, v68
    v_mov_b32 v99, v70
    v_mov_b32 v100, v72
    v_mov_b32 v101, v74
    v_mov_b32 v102, v76
    v_mov_b32 v103, v78
    v_mov_b32 v104, v80
    v_mov_b32 v105, v82
    v_mov_b32 v106, v84
    v_mov_b32 v107, v86
    v_mov_b32 v108, v88
    v_mov_b32 v109, v90
    v_mov_b32 v110, v92
    v_mov_b32 v111, v94
    v_mfma_f32_32x32x16_bf16 v[32:47], v[96:99], v[8:11], 0
    v_mfma_f32_32x32x16_bf16 v[32:47], v[100:103], v[12:15], v[32:47]
    v_mfma_f32_32x32x16_bf16 v[48:63], v[104:107], v[16:19], 0
    v_mfma_f32_32x32x16_bf16 v[48:63], v[108:111], v[20:23], v[48:63]
    s_lshl_b32 s56, s63, 5
    v_add_u32 v5, s56, v2
    v_lshlrev_b32 v5, 4, v5
    v_lshl_add_u32 v6, v3, 10, v5
    s_lshl_b32 s56, s26, 2
    s_lshl_b32 s57, s62, 1
    s_add_u32 s56, s56, s57
    s_lshl_b32 s56, s56, 11
    s_add_u32 s56, s56, s38
    s_add_u32 s91, s56, 0xc00000
    v_add_f32 v40, 0x358637bd, v40
    v_rcp_f32 v40, v40
    v_add_f32 v56, 0x358637bd, v56
    v_rcp_f32 v56, v56
    v_pk_mul_f32 v[32:33], v[32:33], v[40:41] op_sel_hi:[1,0]
    v_pk_mul_f32 v[34:35], v[34:35], v[40:41] op_sel_hi:[1,0]
    v_pk_mul_f32 v[36:37], v[36:37], v[40:41] op_sel_hi:[1,0]
    v_pk_mul_f32 v[38:39], v[38:39], v[40:41] op_sel_hi:[1,0]
    v_cvt_pk_bf16_f32 v64, v32, v33
    v_cvt_pk_bf16_f32 v65, v34, v35
    v_cvt_pk_bf16_f32 v66, v36, v37
    v_cvt_pk_bf16_f32 v67, v38, v39
    v_pk_mul_f32 v[48:49], v[48:49], v[56:57] op_sel_hi:[1,0]
    v_pk_mul_f32 v[50:51], v[50:51], v[56:57] op_sel_hi:[1,0]
    v_pk_mul_f32 v[52:53], v[52:53], v[56:57] op_sel_hi:[1,0]
    v_pk_mul_f32 v[54:55], v[54:55], v[56:57] op_sel_hi:[1,0]
    v_cvt_pk_bf16_f32 v68, v48, v49
    v_cvt_pk_bf16_f32 v69, v50, v51
    v_cvt_pk_bf16_f32 v70, v52, v53
    v_cvt_pk_bf16_f32 v71, v54, v55
    buffer_store_dwordx4 v[64:67], v6, s[12:15], s91 offen
    buffer_store_dwordx4 v[68:71], v6, s[12:15], s91 offen offset:2048
    s_lshl_b32 s56, s62, 1
    s_lshl_b32 s57, s27, 3
    s_sub_u32 s56, s56, s57
    s_and_b32 s56, s56, 31
    s_lshl_b32 s56, s56, 11
    v_add_u32 v5, s56, v6
    ds_write_b128 v5, v[64:67]
    ds_write_b128 v5, v[68:71] offset:2048
    s_and_b32 s71, s71, 15
    s_lshl_b32 s72, s71, 10
    s_add_u32 s72, s72, s70
    s_add_u32 s71, s71, 4
    buffer_load_dwordx4 a[224:227], v4, s[12:15], s72 offen offset:0 sc1
    buffer_load_dwordx4 a[228:231], v4, s[12:15], s72 offen offset:1024 sc1
    buffer_load_dwordx4 a[232:235], v4, s[12:15], s72 offen offset:2048 sc1
    buffer_load_dwordx4 a[236:239], v4, s[12:15], s72 offen offset:3072 sc1
    s_and_b32 s71, s71, 15
    s_lshl_b32 s72, s71, 10
    s_add_u32 s72, s72, s70
    s_add_u32 s71, s71, 4
    buffer_load_dwordx4 a[240:243], v4, s[12:15], s72 offen offset:0 sc1
    buffer_load_dwordx4 a[244:247], v4, s[12:15], s72 offen offset:1024 sc1
    buffer_load_dwordx4 a[248:251], v4, s[12:15], s72 offen offset:2048 sc1
    buffer_load_dwordx4 a[252:255], v4, s[12:15], s72 offen offset:3072 sc1
    v_mov_b32 v96, v120
    v_mov_b32 v97, v121
    v_mov_b32 v98, v122
    v_mov_b32 v99, v123
    v_mov_b32 v100, v124
    v_mov_b32 v101, v125
    v_mov_b32 v102, v126
    v_mov_b32 v103, v127
    s_lshl_b32 s56, s62, 5
    v_add_u32 v5, s56, v2
    v_lshlrev_b32 v6, 4, v5
    v_lshl_add_u32 v112, v3, 10, v6
    v_lshlrev_b32 v6, 4, v2
    v_lshl_add_u32 v6, v3, 10, v6
    s_lshl_b32 s56, s62, 11
    v_add_u32 v6, s56, v6
    s_lshl_b32 s56, s62, 9
    v_add_u32 v113, s56, v6
    s_xor_b32 s56, s56, 512
    v_add_u32 v114, s56, v6
    s_lshl_b32 s56, s28, 12
    s_add_u32 s56, s56, 139264
    v_add_u32 v115, s56, v4
    s_xor_b32 s57, s28, 2
    s_lshl_b32 s57, s57, 12
    s_add_u32 s57, s57, 139264
    v_add_u32 v116, s57, v4
    v_lshlrev_b32 v6, 3, v5
    v_lshl_add_u32 v6, v3, 12, v6
    v_add_u32 v117, 131072, v6
    s_mov_b32 s88, s89
    v_lshlrev_b32 v188, 3, v2
    v_lshlrev_b32 v5, 2, v3
    v_sub_u32 v5, v2, v5
    v_mov_b32 v6, 0x3f80
    v_mov_b32 v7, 0x3f800000
    v_cmp_eq_u32 vcc, 0, v5
    s_nop 1
    v_cndmask_b32 v176, 0, v6, vcc
    v_cmp_eq_u32 vcc, 1, v5
    s_nop 1
    v_cndmask_b32 v176, v176, v7, vcc
    v_cmp_eq_u32 vcc, 2, v5
    s_nop 1
    v_cndmask_b32 v177, 0, v6, vcc
    v_cmp_eq_u32 vcc, 3, v5
    s_nop 1
    v_cndmask_b32 v177, v177, v7, vcc
    v_cmp_eq_u32 vcc, 8, v5
    s_nop 1
    v_cndmask_b32 v178, 0, v6, vcc
    v_cmp_eq_u32 vcc, 9, v5
    s_nop 1
    v_cndmask_b32 v178, v178, v7, vcc
    v_cmp_eq_u32 vcc, 10, v5
    s_nop 1
    v_cndmask_b32 v179, 0, v6, vcc
    v_cmp_eq_u32 vcc, 11, v5
    s_nop 1
    v_cndmask_b32 v179, v179, v7, vcc
    v_cmp_eq_u32 vcc, 16, v5
    s_nop 1
    v_cndmask_b32 v180, 0, v6, vcc
    v_cmp_eq_u32 vcc, 17, v5
    s_nop 1
    v_cndmask_b32 v180, v180, v7, vcc
    v_cmp_eq_u32 vcc, 18, v5
    s_nop 1
    v_cndmask_b32 v181, 0, v6, vcc
    v_cmp_eq_u32 vcc, 19, v5
    s_nop 1
    v_cndmask_b32 v181, v181, v7, vcc
    v_cmp_eq_u32 vcc, 24, v5
    s_nop 1
    v_cndmask_b32 v182, 0, v6, vcc
    v_cmp_eq_u32 vcc, 25, v5
    s_nop 1
    v_cndmask_b32 v182, v182, v7, vcc
    v_cmp_eq_u32 vcc, 26, v5
    s_nop 1
    v_cndmask_b32 v183, 0, v6, vcc
    v_cmp_eq_u32 vcc, 27, v5
    s_nop 1
    v_cndmask_b32 v183, v183, v7, vcc
    s_waitcnt vmcnt(8)
    s_waitcnt lgkmcnt(0)
    s_barrier
    s_cmp_eq_u32 s28, 0
    s_cbranch_scc0 L_fl_11
    s_add_u32 s56, s35, 0
    s_mov_b64 exec, 1
    buffer_store_dwordx2 v[184:185], v186, s[12:15], s56 offen
    s_mov_b64 exec, -1
L_fl_11:
    s_lshl_b32 s70, s26, 2
    s_add_u32 s70, s70, s28
    s_mul_i32 s70, s70, 16
    s_add_u32 s70, s70, 1024
    s_lshl_b32 s70, s70, 10
    s_mul_i32 s71, s27, 4
    s_add_u32 s71, s71, 0
    s_and_b32 s71, s71, 15
    s_lshl_b32 s72, s71, 10
    s_add_u32 s72, s72, s70
    s_add_u32 s71, s71, 4
    buffer_load_dwordx4 a[0:3], v4, s[12:15], s72 offen offset:0 sc1
    buffer_load_dwordx4 a[4:7], v4, s[12:15], s72 offen offset:1024 sc1
    buffer_load_dwordx4 a[8:11], v4, s[12:15], s72 offen offset:2048 sc1
    buffer_load_dwordx4 a[12:15], v4, s[12:15], s72 offen offset:3072 sc1
    s_add_u32 s90, s38, 0xc00000
    s_mov_b32 s91, s37
    s_add_u32 s92, s39, 0
    v_mfma_f32_32x32x16_bf16 v[32:47], v[176:179], v[96:99], 0
    v_mfma_f32_32x32x16_bf16 v[32:47], v[180:183], v[100:103], v[32:47]
    v_mov_b32 v172, 0x3f803f80
    v_mov_b32 v173, 0x3f803f80
    v_mov_b32 v174, 0x3f803f80
    v_mov_b32 v175, 0x3f803f80
    s_nop 0
    s_nop 0
    v_mfma_f32_32x32x16_bf16 v[96:111], a[192:195], v[172:175], 0
    v_mfma_f32_32x32x16_bf16 v[96:111], a[196:199], v[172:175], v[96:111]
    v_mfma_f32_32x32x16_bf16 v[96:111], a[200:203], v[172:175], v[96:111]
    v_mfma_f32_32x32x16_bf16 v[96:111], a[204:207], v[172:175], v[96:111]
    v_mfma_f32_32x32x16_bf16 v[96:111], a[208:211], v[172:175], v[96:111]
    v_mfma_f32_32x32x16_bf16 v[96:111], a[212:215], v[172:175], v[96:111]
    v_mfma_f32_32x32x16_bf16 v[96:111], a[216:219], v[172:175], v[96:111]
    v_mfma_f32_32x32x16_bf16 v[96:111], a[220:223], v[172:175], v[96:111]
    s_waitcnt vmcnt(11)
    v_mfma_f32_32x32x16_bf16 v[96:111], a[224:227], v[172:175], v[96:111]
    s_waitcnt vmcnt(10)
    v_mfma_f32_32x32x16_bf16 v[96:111], a[228:231], v[172:175], v[96:111]
    s_waitcnt vmcnt(9)
    v_mfma_f32_32x32x16_bf16 v[96:111], a[232:235], v[172:175], v[96:111]
    s_waitcnt vmcnt(8)
    v_mfma_f32_32x32x16_bf16 v[96:111], a[236:239], v[172:175], v[96:111]
    s_waitcnt vmcnt(7)
    v_mfma_f32_32x32x16_bf16 v[96:111], a[240:243], v[172:175], v[96:111]
    s_waitcnt vmcnt(6)
    v_mfma_f32_32x32x16_bf16 v[96:111], a[244:247], v[172:175], v[96:111]
    s_waitcnt vmcnt(5)
    v_mfma_f32_32x32x16_bf16 v[96:111], a[248:251], v[172:175], v[96:111]
    s_waitcnt vmcnt(4)
    v_mfma_f32_32x32x16_bf16 v[96:111], a[252:255], v[172:175], v[96:111]
    s_lshl_b32 s56, s28, 7
    s_add_u32 s56, s56, 155648
    v_lshl_add_u32 v5, v3, 6, s56
    s_mov_b32 s56, 1
    s_mov_b32 s57, 1
    s_mov_b64 exec, s[56:57]
    s_nop 5
    ds_write_b128 v5, v[96:99] offset:0
    ds_write_b128 v5, v[100:103] offset:16
    ds_write_b128 v5, v[104:107] offset:32
    ds_write_b128 v5, v[108:111] offset:48
    s_mov_b64 exec, -1
    s_add_u32 s56, s36, 0
    s_nop 0
    s_mov_b32 s69, 0
L_fw_12:
    buffer_load_dwordx2 v[6:7], v187, s[12:15], s56 offen sc1
    s_add_u32 s69, s69, 1
    s_cmp_gt_u32 s69, 200000
    s_cbranch_scc1 L_end
    s_waitcnt vmcnt(0)
    v_xor_b32 v6, s24, v6
    v_bitop3_b32 v6, v7, s24, v6 bitop3:0xbe
    v_cmp_ne_u32 vcc, 0, v6
    s_nop 4
    s_cbranch_vccnz L_fw_12
    s_nop 0
    s_add_u32 s56, s90, s91
    s_cmp_eq_u32 s40, 0
    s_cselect_b64 exec, 0, -1
    s_mov_b32 m0, s92
    s_nop 0
    buffer_load_dwordx4 v4, s[12:15], s56 offen offset:0 sc1 lds
    buffer_load_dwordx4 v4, s[12:15], s56 offen offset:1024 sc1 lds
    buffer_load_dwordx4 v4, s[12:15], s56 offen offset:2048 sc1 lds
    buffer_load_dwordx4 v4, s[12:15], s56 offen offset:3072 sc1 lds
    s_mov_b64 exec, -1
    s_add_u32 s91, s91, 16384
    s_and_b32 s91, s91, 0xffff
    s_add_u32 s92, s92, 16384
    s_add_u32 s56, s90, s91
    s_cmp_eq_u32 s40, 1
    s_cselect_b64 exec, 0, -1
    s_mov_b32 m0, s92
    s_nop 0
    buffer_load_dwordx4 v4, s[12:15], s56 offen offset:0 sc1 lds
    buffer_load_dwordx4 v4, s[12:15], s56 offen offset:1024 sc1 lds
    buffer_load_dwordx4 v4, s[12:15], s56 offen offset:2048 sc1 lds
    buffer_load_dwordx4 v4, s[12:15], s56 offen offset:3072 sc1 lds
    s_mov_b64 exec, -1
    s_add_u32 s91, s91, 16384
    s_and_b32 s91, s91, 0xffff
    s_add_u32 s92, s92, 16384
    s_add_u32 s56, s90, s91
    s_cmp_eq_u32 s40, 2
    s_cselect_b64 exec, 0, -1
    s_mov_b32 m0, s92
    s_nop 0
    buffer_load_dwordx4 v4, s[12:15], s56 offen offset:0 sc1 lds
    buffer_load_dwordx4 v4, s[12:15], s56 offen offset:1024 sc1 lds
    buffer_load_dwordx4 v4, s[12:15], s56 offen offset:2048 sc1 lds
    buffer_load_dwordx4 v4, s[12:15], s56 offen offset:3072 sc1 lds
    s_mov_b64 exec, -1
    s_add_u32 s91, s91, 16384
    s_and_b32 s91, s91, 0xffff
    s_add_u32 s92, s92, 16384
    s_add_u32 s56, s90, s91
    s_cmp_eq_u32 s40, 3
    s_cselect_b64 exec, 0, -1
    s_mov_b32 m0, s92
    s_nop 0
    buffer_load_dwordx4 v4, s[12:15], s56 offen offset:0 sc1 lds
    buffer_load_dwordx4 v4, s[12:15], s56 offen offset:1024 sc1 lds
    buffer_load_dwordx4 v4, s[12:15], s56 offen offset:2048 sc1 lds
    buffer_load_dwordx4 v4, s[12:15], s56 offen offset:3072 sc1 lds
    s_mov_b64 exec, -1
    s_waitcnt vmcnt(12)
    s_waitcnt lgkmcnt(0)
    s_barrier
    s_xor_b32 s56, s28, 2
    s_lshl_b32 s56, s56, 7
    s_add_u32 s56, s56, 155648
    v_lshl_add_u32 v5, v3, 6, s56
    ds_read_b128 v[160:163], v5 offset:0
    ds_read_b128 v[164:167], v5 offset:16
    ds_read_b128 v[168:171], v5 offset:32
    ds_read_b128 v[172:175], v5 offset:48
    s_waitcnt lgkmcnt(3)
    v_add_f32 v96, v96, v160
    v_add_f32 v97, v97, v161
    v_add_f32 v98, v98, v162
    v_add_f32 v99, v99, v163
    s_waitcnt lgkmcnt(2)
    v_add_f32 v100, v100, v164
    v_add_f32 v101, v101, v165
    v_add_f32 v102, v102, v166
    v_add_f32 v103, v103, v167
    s_waitcnt lgkmcnt(1)
    v_add_f32 v104, v104, v168
    v_add_f32 v105, v105, v169
    v_add_f32 v106, v106, v170
    v_add_f32 v107, v107, v171
    s_waitcnt lgkmcnt(0)
    v_add_f32 v108, v108, v172
    v_add_f32 v109, v109, v173
    v_add_f32 v110, v110, v174
    v_add_f32 v111, v111, v175
    ds_read_b128 v[68:71], v114 offset:0
    ds_read_b128 v[64:67], v113 offset:0
    ds_read_b128 v[76:79], v114 offset:4096
    ds_read_b128 v[72:75], v113 offset:4096
    ds_read_b128 v[84:87], v114 offset:8192
    ds_read_b128 v[80:83], v113 offset:8192
    ds_read_b128 v[92:95], v114 offset:12288
    ds_read_b128 v[88:91], v113 offset:12288
    s_waitcnt vmcnt(8)
    s_barrier
    s_waitcnt lgkmcnt(7)
    v_mfma_f32_32x32x16_bf16 v[48:63], a[128:131], v[68:71], 0
    s_and_b32 s71, s71, 15
    s_lshl_b32 s72, s71, 10
    s_add_u32 s72, s72, s70
    s_add_u32 s71, s71, 4
    buffer_load_dwordx4 a[16:19], v4, s[12:15], s72 offen offset:0 sc1
    ds_read_b128 v[132:135], v114 offset:16384
    s_waitcnt lgkmcnt(7)
    v_mfma_f32_32x32x16_bf16 v[32:47], a[128:131], v[64:67], v[32:47]
    ds_read_b128 v[128:131], v113 offset:16384
    ds_read_b128 v[140:143], v114 offset:20480
    s_waitcnt lgkmcnt(8)
    v_mfma_f32_32x32x16_bf16 v[48:63], a[132:135], v[76:79], v[48:63]
    buffer_load_dwordx4 a[20:23], v4, s[12:15], s72 offen offset:1024 sc1
    ds_read_b128 v[136:139], v113 offset:20480
    ds_read_b128 v[148:151], v114 offset:24576
    s_waitcnt lgkmcnt(9)
    v_mfma_f32_32x32x16_bf16 v[32:47], a[132:135], v[72:75], v[32:47]
    ds_read_b128 v[144:147], v113 offset:24576
    ds_read_b128 v[156:159], v114 offset:28672
    s_waitcnt lgkmcnt(10)
    v_mfma_f32_32x32x16_bf16 v[48:63], a[136:139], v[84:87], v[48:63]
    buffer_load_dwordx4 a[24:27], v4, s[12:15], s72 offen offset:2048 sc1
    ds_read_b128 v[152:155], v113 offset:28672
    s_waitcnt lgkmcnt(10)
    v_mfma_f32_32x32x16_bf16 v[32:47], a[136:139], v[80:83], v[32:47]
    s_waitcnt lgkmcnt(9)
    v_mfma_f32_32x32x16_bf16 v[48:63], a[140:143], v[92:95], v[48:63]
    buffer_load_dwordx4 a[28:31], v4, s[12:15], s72 offen offset:3072 sc1
    s_waitcnt lgkmcnt(8)
    v_mfma_f32_32x32x16_bf16 v[32:47], a[140:143], v[88:91], v[32:47]
    s_waitcnt vmcnt(8)
    s_barrier
    s_waitcnt lgkmcnt(7)
    v_mfma_f32_32x32x16_bf16 v[48:63], a[144:147], v[132:135], v[48:63]
    s_and_b32 s71, s71, 15
    s_lshl_b32 s72, s71, 10
    s_add_u32 s72, s72, s70
    s_add_u32 s71, s71, 4
    buffer_load_dwordx4 a[32:35], v4, s[12:15], s72 offen offset:0 sc1
    ds_read_b128 v[68:71], v114 offset:32768
    s_waitcnt lgkmcnt(7)
    v_mfma_f32_32x32x16_bf16 v[32:47], a[144:147], v[128:131], v[32:47]
    ds_read_b128 v[64:67], v113 offset:32768
    ds_read_b128 v[76:79], v114 offset:36864
    s_waitcnt lgkmcnt(8)
    v_mfma_f32_32x32x16_bf16 v[48:63], a[148:151], v[140:143], v[48:63]
    buffer_load_dwordx4 a[36:39], v4, s[12:15], s72 offen offset:1024 sc1
    ds_read_b128 v[72:75], v113 offset:36864
    ds_read_b128 v[84:87], v114 offset:40960
    s_waitcnt lgkmcnt(9)
    v_mfma_f32_32x32x16_bf16 v[32:47], a[148:151], v[136:139], v[32:47]
    ds_read_b128 v[80:83], v113 offset:40960
    ds_read_b128 v[92:95], v114 offset:45056
    s_waitcnt lgkmcnt(10)
    v_mfma_f32_32x32x16_bf16 v[48:63], a[152:155], v[148:151], v[48:63]
    buffer_load_dwordx4 a[40:43], v4, s[12:15], s72 offen offset:2048 sc1
    ds_read_b128 v[88:91], v113 offset:45056
    s_waitcnt lgkmcnt(10)
    v_mfma_f32_32x32x16_bf16 v[32:47], a[152:155], v[144:147], v[32:47]
    s_waitcnt lgkmcnt(9)
    v_mfma_f32_32x32x16_bf16 v[48:63], a[156:159], v[156:159], v[48:63]
    buffer_load_dwordx4 a[44:47], v4, s[12:15], s72 offen offset:3072 sc1
    s_waitcnt lgkmcnt(8)
    v_mfma_f32_32x32x16_bf16 v[32:47], a[156:159], v[152:155], v[32:47]
    s_waitcnt vmcnt(8)
    s_barrier
    s_waitcnt lgkmcnt(7)
    v_mfma_f32_32x32x16_bf16 v[48:63], a[160:163], v[68:71], v[48:63]
    s_and_b32 s71, s71, 15
    s_lshl_b32 s72, s71, 10
    s_add_u32 s72, s72, s70
    s_add_u32 s71, s71, 4
    buffer_load_dwordx4 a[48:51], v4, s[12:15], s72 offen offset:0 sc1
    ds_read_b128 v[132:135], v114 offset:49152
    s_waitcnt lgkmcnt(7)
    v_mfma_f32_32x32x16_bf16 v[32:47], a[160:163], v[64:67], v[32:47]
    ds_read_b128 v[128:131], v113 offset:49152
    ds_read_b128 v[140:143], v114 offset:53248
    s_waitcnt lgkmcnt(8)
    v_mfma_f32_32x32x16_bf16 v[48:63], a[164:167], v[76:79], v[48:63]
    buffer_load_dwordx4 a[52:55], v4, s[12:15], s72 offen offset:1024 sc1
    ds_read_b128 v[136:139], v113 offset:53248
    ds_read_b128 v[148:151], v114 offset:57344
    s_waitcnt lgkmcnt(9)
    v_mfma_f32_32x32x16_bf16 v[32:47], a[164:167], v[72:75], v[32:47]
    ds_read_b128 v[144:147], v113 offset:57344
    ds_read_b128 v[156:159], v114 offset:61440
    s_waitcnt lgkmcnt(10)
    v_mfma_f32_32x32x16_bf16 v[48:63], a[168:171], v[84:87], v[48:63]
    buffer_load_dwordx4 a[56:59], v4, s[12:15], s72 offen offset:2048 sc1
    ds_read_b128 v[152:155], v113 offset:61440
    s_waitcnt lgkmcnt(10)
    v_mfma_f32_32x32x16_bf16 v[32:47], a[168:171], v[80:83], v[32:47]
    s_waitcnt lgkmcnt(9)
    v_mfma_f32_32x32x16_bf16 v[48:63], a[172:175], v[92:95], v[48:63]
    buffer_load_dwordx4 a[60:63], v4, s[12:15], s72 offen offset:3072 sc1
    s_waitcnt lgkmcnt(8)
    v_mfma_f32_32x32x16_bf16 v[32:47], a[172:175], v[88:91], v[32:47]
    s_waitcnt lgkmcnt(7)
    v_mfma_f32_32x32x16_bf16 v[48:63], a[176:179], v[132:135], v[48:63]
    s_lshl_b32 s70, s26, 2
    s_add_u32 s70, s70, s28
    s_mul_i32 s70, s70, 48
    s_add_u32 s70, s70, 1536
    s_lshl_b32 s70, s70, 10
    s_mul_i32 s71, s27, 4
    s_add_u32 s71, s71, 0
    s_and_b32 s71, s71, 15
    s_lshl_b32 s72, s71, 10
    s_add_u32 s72, s72, s70
    s_add_u32 s71, s71, 4
    buffer_load_dwordx4 a[64:67], v4, s[12:15], s72 offen offset:0 sc1
    s_waitcnt lgkmcnt(5)
    v_mfma_f32_32x32x16_bf16 v[48:63], a[180:183], v[140:143], v[48:63]
    s_waitcnt lgkmcnt(3)
    v_mfma_f32_32x32x16_bf16 v[48:63], a[184:187], v[148:151], v[48:63]
    buffer_load_dwordx4 a[68:71], v4, s[12:15], s72 offen offset:1024 sc1
    s_waitcnt lgkmcnt(1)
    v_mfma_f32_32x32x16_bf16 v[48:63], a[188:191], v[156:159], v[48:63]
    v_mfma_f32_32x32x16_bf16 v[32:47], a[176:179], v[128:131], v[32:47]
    buffer_load_dwordx4 a[72:75], v4, s[12:15], s72 offen offset:2048 sc1
    v_mfma_f32_32x32x16_bf16 v[32:47], a[180:183], v[136:139], v[32:47]
    v_mfma_f32_32x32x16_bf16 v[32:47], a[184:187], v[144:147], v[32:47]
    buffer_load_dwordx4 a[76:79], v4, s[12:15], s72 offen offset:3072 sc1
    s_waitcnt lgkmcnt(0)
    v_mfma_f32_32x32x16_bf16 v[32:47], a[188:191], v[152:155], v[32:47]
    s_nop 4
    ds_write_b128 v115, v[48:51] offset:0
    ds_write_b128 v115, v[52:55] offset:1024
    ds_write_b128 v115, v[56:59] offset:2048
    ds_write_b128 v115, v[60:63] offset:3072
    s_waitcnt lgkmcnt(0)
    s_barrier
    ds_read_b128 v[48:51], v116 offset:0
    ds_read_b128 v[52:55], v116 offset:1024
    ds_read_b128 v[56:59], v116 offset:2048
    ds_read_b128 v[60:63], v116 offset:3072
    s_waitcnt lgkmcnt(3)
    v_pk_add_f32 v[32:33], v[32:33], v[48:49]
    v_pk_add_f32 v[34:35], v[34:35], v[50:51]
    s_waitcnt lgkmcnt(2)
    v_pk_add_f32 v[36:37], v[36:37], v[52:53]
    v_pk_add_f32 v[38:39], v[38:39], v[54:55]
    s_waitcnt lgkmcnt(1)
    v_pk_add_f32 v[40:41], v[40:41], v[56:57]
    v_pk_add_f32 v[42:43], v[42:43], v[58:59]
    s_waitcnt lgkmcnt(0)
    v_pk_add_f32 v[44:45], v[44:45], v[60:61]
    v_pk_add_f32 v[46:47], v[46:47], v[62:63]
    v_cvt_pk_bf16_f32 v16, v32, v33
    v_cvt_pk_bf16_f32 v17, v34, v35
    v_cvt_pk_bf16_f32 v18, v36, v37
    v_cvt_pk_bf16_f32 v19, v38, v39
    v_cvt_pk_bf16_f32 v20, v40, v41
    v_cvt_pk_bf16_f32 v21, v42, v43
    v_cvt_pk_bf16_f32 v22, v44, v45
    v_cvt_pk_bf16_f32 v23, v46, v47
    s_add_u32 s91, s32, 0xe00000
    buffer_store_dwordx4 v[16:19], v112, s[12:15], s91 offen
    buffer_store_dwordx4 v[20:23], v112, s[12:15], s91 offen offset:2048
    s_add_u32 s56, s33, 65536
    v_add_u32 v5, s56, v112
    ds_write_b128 v5, v[16:19]
    ds_write_b128 v5, v[20:23] offset:2048
    v_pk_add_f32 v[68:69], v[32:33], v[34:35]
    v_pk_mul_f32 v[70:71], v[32:33], v[32:33]
    v_pk_add_f32 v[72:73], v[36:37], v[38:39]
    v_pk_mul_f32 v[74:75], v[34:35], v[34:35]
    v_pk_fma_f32 v[70:71], v[36:37], v[36:37], v[70:71]
    v_pk_fma_f32 v[74:75], v[38:39], v[38:39], v[74:75]
    v_pk_add_f32 v[72:73], v[72:73], v[42:43]
    v_pk_fma_f32 v[70:71], v[40:41], v[40:41], v[70:71]
    v_pk_add_f32 v[68:69], v[68:69], v[40:41]
    v_pk_fma_f32 v[74:75], v[42:43], v[42:43], v[74:75]
    v_pk_add_f32 v[72:73], v[72:73], v[46:47]
    v_pk_fma_f32 v[70:71], v[44:45], v[44:45], v[70:71]
    v_pk_add_f32 v[68:69], v[68:69], v[44:45]
    v_pk_fma_f32 v[74:75], v[46:47], v[46:47], v[74:75]
    v_pk_add_f32 v[68:69], v[68:69], v[72:73]
    v_pk_add_f32 v[70:71], v[70:71], v[74:75]
    v_add_f32 v68, v68, v69
    v_add_f32 v69, v70, v71
    v_mov_b32 v70, v68
    v_mov_b32 v71, v69
    s_add_u32 s91, s34, 0xa20000
    s_mov_b32 s56, -1
    s_mov_b32 s57, 0
    v_permlane32_swap_b32 v68, v70
    v_permlane32_swap_b32 v69, v71
    v_pk_add_f32 v[68:69], v[68:69], v[70:71]
    s_mov_b64 exec, s[56:57]
    buffer_store_dwordx2 v[68:69], v188, s[12:15], s91 offen
    s_mov_b64 exec, -1
    s_waitcnt vmcnt(0)
    s_waitcnt lgkmcnt(0)
    s_barrier
    s_cmp_eq_u32 s28, 0
    s_cbranch_scc0 L_fl_13
    s_add_u32 s56, s35, 128
    s_mov_b64 exec, 1
    buffer_store_dwordx2 v[184:185], v186, s[12:15], s56 offen
    s_mov_b64 exec, -1
L_fl_13:
    s_mov_b32 s94, 0xbdd2d3e8
    s_mov_b32 s95, 0xbdd2d3e8
    v_mov_b32 v126, 0xc0135761
    v_mov_b32 v127, 0xc0135761
    s_lshr_b32 s98, s26, 1
    s_lshr_b32 s97, s98, 1
    s_add_u32 s97, s97, 1
    s_sub_u32 s96, 0, s97
    s_bitcmp1_b32 s98, 0
    s_cselect_b32 s96, s96, s97
    s_lshl_b32 s56, s62, 5
    v_add_u32 v5, s56, v2
    v_add_u32 v6, s96, v5
    v_lshlrev_b32 v7, 4, v6
    v_lshl_add_u32 v125, v3, 10, v7
    v_cmp_gt_u32 vcc, 64, v6
    s_nop 3
    s_mov_b64 s[58:59], vcc
    s_not_b64 s[46:47], vcc
    s_add_u32 s44, s32, 0xc00000
    s_add_u32 s56, s25, 1
    s_sub_u32 s57, s25, 1
    s_bitcmp1_b32 s98, 0
    s_cselect_b32 s56, s57, s56
    s_cmp_ge_u32 s56, 32
    s_cselect_b64 s[46:47], 0, s[46:47]
    s_cselect_b32 s56, 0, s56
    s_lshl_b32 s56, s56, 12
    s_add_u32 s45, s56, 0xaa0000
    v_subrev_u32 v7, 64, v6
    s_bitcmp1_b32 s98, 0
    s_cselect_b64 s[56:57], -1, 0
    v_cndmask_b32 v7, v7, v5, s[56:57]
    s_lshl_b32 s56, s26, 2
    s_lshl_b32 s57, s63, 1
    s_add_u32 s99, s56, s57
    s_lshl_b32 s56, s98, 4
    s_cmp_eq_u32 s98, 3
    s_cselect_b32 s56, 64, s56
    s_lshl_b32 s57, s98, 3
    s_sub_u32 s57, s99, s57
    s_lshl_b32 s57, s57, 1
    v_add_u32 v189, s57, v3
    v_mul_lo_u32 v189, v189, s97
    v_add_u32 v189, v189, v7
    v_add_u32 v189, s56, v189
    v_lshlrev_b32 v189, 5, v189
    s_lshl_b32 s57, s97, 6
    v_add_u32 v190, s57, v189
    v_lshrrev_b32 v64, 3, v1
    v_cmp_gt_u32 vcc, 16, v1
    v_lshrrev_b32 v65, 4, v1
    v_add_u32 v65, 1, v65
    v_cndmask_b32 v66, v65, v64, vcc
    v_and_b32 v64, 7, v1
    v_and_b32 v65, 15, v1
    v_lshrrev_b32 v67, 1, v64
    v_lshrrev_b32 v68, 2, v65
    v_cndmask_b32 v67, v68, v67, vcc
    v_and_b32 v68, 1, v64
    v_bfe_u32 v69, v65, 1, 1
    v_cndmask_b32 v68, v69, v68, vcc
    v_and_b32 v69, 1, v65
    v_mov_b32 v70, 0
    v_cndmask_b32 v69, v69, v70, vcc
    v_lshlrev_b32 v70, 1, v67
    v_add_u32 v70, s62, v70
    v_lshlrev_b32 v71, 1, v70
    v_add_u32 v71, v71, v68
    v_mov_b32 v72, 1
    v_mov_b32 v73, 2
    v_cndmask_b32 v72, v73, v72, vcc
    v_mul_lo_u32 v71, v71, v72
    v_add_u32 v71, v71, v69
    v_lshlrev_b32 v72, 4, v66
    v_mov_b32 v73, 64
    v_cmp_eq_u32 s[56:57], 3, v66
    s_nop 1
    v_cndmask_b32 v72, v72, v73, s[56:57]
    v_add_u32 v71, v71, v72
    v_lshlrev_b32 v195, 5, v71
    v_lshl_add_u32 v70, v66, 3, v70
    s_lshl_b32 s56, s26, 2
    s_lshl_b32 s57, s27, 3
    s_add_u32 s56, s56, s57
    v_subrev_u32 v70, s56, v70
    v_and_b32 v70, 31, v70
    v_lshrrev_b32 v197, 3, v70
    v_lshlrev_b32 v70, 11, v70
    v_lshl_add_u32 v70, v68, 10, v70
    v_and_b32 v72, 1, v66
    v_sub_u32 v73, 63, v69
    v_add_u32 v74, 62, v69
    v_cndmask_b32 v73, v74, v73, vcc
    v_cmp_eq_u32 s[56:57], 1, v72
    s_nop 1
    v_cndmask_b32 v73, v69, v73, s[56:57]
    v_lshl_add_u32 v70, v73, 4, v70
    v_add_u32 v196, 0, v70
    s_cmp_lt_u32 s25, 31
    s_cselect_b32 s90, 1, 0
    s_cmp_gt_u32 s25, 0
    s_cselect_b32 s91, 1, 0
    v_mov_b32 v73, s91
    v_mov_b32 v74, s90
    v_cndmask_b32 v73, v73, v74, s[56:57]
    v_cmp_eq_u32 vcc, 1, v73
    v_cmp_gt_u32 s[56:57], 48, v1
    s_nop 2
    s_nop 0
    s_and_b64 s[96:97], vcc, s[56:57]
    s_mov_b64 s[98:99], s[56:57]
    s_lshl_b32 s56, s25, 12
    s_add_u32 s85, s56, 0xaa0000
    v_add_u32 v123, 0x10000, v113
    v_add_u32 v124, 0x10000, v114
    s_add_u32 s90, s38, 0xe00000
    s_mov_b32 s91, s37
    s_add_u32 s92, s39, 65536
    s_add_u32 s56, s36, 128
    s_nop 0
    s_mov_b32 s69, 0
L_fw_14:
    buffer_load_dwordx2 v[6:7], v187, s[12:15], s56 offen sc1
    s_add_u32 s69, s69, 1
    s_cmp_gt_u32 s69, 200000
    s_cbranch_scc1 L_end
    s_waitcnt vmcnt(0)
    v_xor_b32 v6, s24, v6
    v_bitop3_b32 v6, v7, s24, v6 bitop3:0xbe
    v_cmp_ne_u32 vcc, 0, v6
    s_nop 4
    s_cbranch_vccnz L_fw_14
    s_nop 0
    s_add_u32 s56, s90, s91
    s_cmp_eq_u32 s40, 0
    s_cselect_b64 exec, 0, -1
    s_mov_b32 m0, s92
    s_nop 0
    buffer_load_dwordx4 v4, s[12:15], s56 offen offset:0 sc1 lds
    buffer_load_dwordx4 v4, s[12:15], s56 offen offset:1024 sc1 lds
    buffer_load_dwordx4 v4, s[12:15], s56 offen offset:2048 sc1 lds
    buffer_load_dwordx4 v4, s[12:15], s56 offen offset:3072 sc1 lds
    s_mov_b64 exec, -1
    s_add_u32 s91, s91, 16384
    s_and_b32 s91, s91, 0xffff
    s_add_u32 s92, s92, 16384
    s_add_u32 s56, s90, s91
    s_cmp_eq_u32 s40, 1
    s_cselect_b64 exec, 0, -1
    s_mov_b32 m0, s92
    s_nop 0
    buffer_load_dwordx4 v4, s[12:15], s56 offen offset:0 sc1 lds
    buffer_load_dwordx4 v4, s[12:15], s56 offen offset:1024 sc1 lds
    buffer_load_dwordx4 v4, s[12:15], s56 offen offset:2048 sc1 lds
    buffer_load_dwordx4 v4, s[12:15], s56 offen offset:3072 sc1 lds
    s_mov_b64 exec, -1
    s_add_u32 s91, s91, 16384
    s_and_b32 s91, s91, 0xffff
    s_add_u32 s92, s92, 16384
    s_add_u32 s56, s41, 0xa20000
    s_add_u32 m0, s42, 131072
    s_nop 0
    buffer_load_dwordx4 v4, s[12:15], s56 offen sc1 lds
    buffer_load_dwordx4 v4, s[12:15], s56 offen offset:1024 sc1 lds
    s_add_u32 s56, s90, s91
    s_cmp_eq_u32 s40, 2
    s_cselect_b64 exec, 0, -1
    s_mov_b32 m0, s92
    s_nop 0
    buffer_load_dwordx4 v4, s[12:15], s56 offen offset:0 sc1 lds
    buffer_load_dwordx4 v4, s[12:15], s56 offen offset:1024 sc1 lds
    buffer_load_dwordx4 v4, s[12:15], s56 offen offset:2048 sc1 lds
    buffer_load_dwordx4 v4, s[12:15], s56 offen offset:3072 sc1 lds
    s_mov_b64 exec, -1
    s_add_u32 s91, s91, 16384
    s_and_b32 s91, s91, 0xffff
    s_add_u32 s92, s92, 16384
    s_add_u32 s56, s90, s91
    s_cmp_eq_u32 s40, 3
    s_cselect_b64 exec, 0, -1
    s_mov_b32 m0, s92
    s_nop 0
    buffer_load_dwordx4 v4, s[12:15], s56 offen offset:0 sc1 lds
    buffer_load_dwordx4 v4, s[12:15], s56 offen offset:1024 sc1 lds
    buffer_load_dwordx4 v4, s[12:15], s56 offen offset:2048 sc1 lds
    buffer_load_dwordx4 v4, s[12:15], s56 offen offset:3072 sc1 lds
    s_mov_b64 exec, -1
    s_waitcnt vmcnt(14)
    s_barrier
    ds_read_b128 v[68:71], v124 offset:0
    ds_read_b128 v[64:67], v123 offset:0
    ds_read_b128 v[76:79], v124 offset:4096
    ds_read_b128 v[72:75], v123 offset:4096
    ds_read_b128 v[84:87], v124 offset:8192
    ds_read_b128 v[80:83], v123 offset:8192
    ds_read_b128 v[92:95], v124 offset:12288
    ds_read_b128 v[88:91], v123 offset:12288
    s_waitcnt vmcnt(10)
    s_barrier
    s_waitcnt lgkmcnt(7)
    v_mfma_f32_32x32x16_bf16 v[48:63], a[192:195], v[68:71], 0
    s_and_b32 s71, s71, 15
    s_lshl_b32 s72, s71, 10
    s_add_u32 s72, s72, s70
    s_add_u32 s71, s71, 4
    buffer_load_dwordx4 a[80:83], v4, s[12:15], s72 offen offset:0 sc1
    ds_read_b128 v[132:135], v124 offset:16384
    s_waitcnt lgkmcnt(7)
    v_mfma_f32_32x32x16_bf16 v[32:47], a[192:195], v[64:67], 0
    ds_read_b128 v[128:131], v123 offset:16384
    ds_read_b128 v[140:143], v124 offset:20480
    s_waitcnt lgkmcnt(8)
    v_mfma_f32_32x32x16_bf16 v[48:63], a[196:199], v[76:79], v[48:63]
    buffer_load_dwordx4 a[84:87], v4, s[12:15], s72 offen offset:1024 sc1
    ds_read_b128 v[136:139], v123 offset:20480
    ds_read_b128 v[148:151], v124 offset:24576
    s_waitcnt lgkmcnt(9)
    v_mfma_f32_32x32x16_bf16 v[32:47], a[196:199], v[72:75], v[32:47]
    ds_read_b128 v[144:147], v123 offset:24576
    ds_read_b128 v[156:159], v124 offset:28672
    s_waitcnt lgkmcnt(10)
    v_mfma_f32_32x32x16_bf16 v[48:63], a[200:203], v[84:87], v[48:63]
    buffer_load_dwordx4 a[88:91], v4, s[12:15], s72 offen offset:2048 sc1
    ds_read_b128 v[152:155], v123 offset:28672
    s_waitcnt lgkmcnt(10)
    v_mfma_f32_32x32x16_bf16 v[32:47], a[200:203], v[80:83], v[32:47]
    s_waitcnt lgkmcnt(9)
    v_mfma_f32_32x32x16_bf16 v[48:63], a[204:207], v[92:95], v[48:63]
    buffer_load_dwordx4 a[92:95], v4, s[12:15], s72 offen offset:3072 sc1
    s_waitcnt lgkmcnt(8)
    v_mfma_f32_32x32x16_bf16 v[32:47], a[204:207], v[88:91], v[32:47]
    s_waitcnt vmcnt(8)
    s_barrier
    s_waitcnt lgkmcnt(7)
    v_mfma_f32_32x32x16_bf16 v[48:63], a[208:211], v[132:135], v[48:63]
    s_and_b32 s71, s71, 15
    s_lshl_b32 s72, s71, 10
    s_add_u32 s72, s72, s70
    s_add_u32 s71, s71, 4
    buffer_load_dwordx4 a[96:99], v4, s[12:15], s72 offen offset:0 sc1
    ds_read_b128 v[68:71], v124 offset:32768
    s_waitcnt lgkmcnt(7)
    v_mfma_f32_32x32x16_bf16 v[32:47], a[208:211], v[128:131], v[32:47]
    ds_read_b128 v[64:67], v123 offset:32768
    ds_read_b128 v[76:79], v124 offset:36864
    s_waitcnt lgkmcnt(8)
    v_mfma_f32_32x32x16_bf16 v[48:63], a[212:215], v[140:143], v[48:63]
    buffer_load_dwordx4 a[100:103], v4, s[12:15], s72 offen offset:1024 sc1
    ds_read_b128 v[72:75], v123 offset:36864
    ds_read_b128 v[84:87], v124 offset:40960
    s_waitcnt lgkmcnt(9)
    v_mfma_f32_32x32x16_bf16 v[32:47], a[212:215], v[136:139], v[32:47]
    ds_read_b128 v[80:83], v123 offset:40960
    ds_read_b128 v[92:95], v124 offset:45056
    s_waitcnt lgkmcnt(10)
    v_mfma_f32_32x32x16_bf16 v[48:63], a[216:219], v[148:151], v[48:63]
    buffer_load_dwordx4 a[104:107], v4, s[12:15], s72 offen offset:2048 sc1
    ds_read_b128 v[88:91], v123 offset:45056
    s_waitcnt lgkmcnt(10)
    v_mfma_f32_32x32x16_bf16 v[32:47], a[216:219], v[144:147], v[32:47]
    s_waitcnt lgkmcnt(9)
    v_mfma_f32_32x32x16_bf16 v[48:63], a[220:223], v[156:159], v[48:63]
    buffer_load_dwordx4 a[108:111], v4, s[12:15], s72 offen offset:3072 sc1
    s_waitcnt lgkmcnt(8)
    v_mfma_f32_32x32x16_bf16 v[32:47], a[220:223], v[152:155], v[32:47]
    s_waitcnt vmcnt(8)
    s_barrier
    s_waitcnt lgkmcnt(7)
    v_mfma_f32_32x32x16_bf16 v[48:63], a[224:227], v[68:71], v[48:63]
    s_and_b32 s71, s71, 15
    s_lshl_b32 s72, s71, 10
    s_add_u32 s72, s72, s70
    s_add_u32 s71, s71, 4
    buffer_load_dwordx4 a[112:115], v4, s[12:15], s72 offen offset:0 sc1
    ds_read_b128 v[132:135], v124 offset:49152
    s_waitcnt lgkmcnt(7)
    v_mfma_f32_32x32x16_bf16 v[32:47], a[224:227], v[64:67], v[32:47]
    ds_read_b128 v[128:131], v123 offset:49152
    ds_read_b128 v[140:143], v124 offset:53248
    s_waitcnt lgkmcnt(8)
    v_mfma_f32_32x32x16_bf16 v[48:63], a[228:231], v[76:79], v[48:63]
    buffer_load_dwordx4 a[116:119], v4, s[12:15], s72 offen offset:1024 sc1
    ds_read_b128 v[136:139], v123 offset:53248
    ds_read_b128 v[148:151], v124 offset:57344
    s_waitcnt lgkmcnt(9)
    v_mfma_f32_32x32x16_bf16 v[32:47], a[228:231], v[72:75], v[32:47]
    ds_read_b128 v[144:147], v123 offset:57344
    ds_read_b128 v[156:159], v124 offset:61440
    s_waitcnt lgkmcnt(10)
    v_mfma_f32_32x32x16_bf16 v[48:63], a[232:235], v[84:87], v[48:63]
    buffer_load_dwordx4 a[120:123], v4, s[12:15], s72 offen offset:2048 sc1
    ds_read_b128 v[152:155], v123 offset:61440
    s_waitcnt lgkmcnt(10)
    v_mfma_f32_32x32x16_bf16 v[32:47], a[232:235], v[80:83], v[32:47]
    s_waitcnt lgkmcnt(9)
    v_mfma_f32_32x32x16_bf16 v[48:63], a[236:239], v[92:95], v[48:63]
    buffer_load_dwordx4 a[124:127], v4, s[12:15], s72 offen offset:3072 sc1
    s_waitcnt lgkmcnt(8)
    v_mfma_f32_32x32x16_bf16 v[32:47], a[236:239], v[88:91], v[32:47]
    s_waitcnt lgkmcnt(7)
    v_mfma_f32_32x32x16_bf16 v[48:63], a[240:243], v[132:135], v[48:63]
    s_lshl_b32 s70, s26, 2
    s_add_u32 s70, s70, s28
    s_mul_i32 s70, s70, 48
    s_add_u32 s70, s70, 1552
    s_lshl_b32 s70, s70, 10
    s_mul_i32 s71, s27, 8
    s_add_u32 s71, s71, 0
    s_and_b32 s71, s71, 31
    s_lshl_b32 s72, s71, 10
    s_add_u32 s72, s72, s70
    s_add_u32 s71, s71, 4
    buffer_load_dwordx4 a[128:131], v4, s[12:15], s72 offen offset:0 sc1
    s_waitcnt lgkmcnt(5)
    v_mfma_f32_32x32x16_bf16 v[48:63], a[244:247], v[140:143], v[48:63]
    s_waitcnt lgkmcnt(3)
    v_mfma_f32_32x32x16_bf16 v[48:63], a[248:251], v[148:151], v[48:63]
    buffer_load_dwordx4 a[132:135], v4, s[12:15], s72 offen offset:1024 sc1
    s_waitcnt lgkmcnt(1)
    v_mfma_f32_32x32x16_bf16 v[48:63], a[252:255], v[156:159], v[48:63]
    v_mfma_f32_32x32x16_bf16 v[32:47], a[240:243], v[128:131], v[32:47]
    ds_read_b64 v[160:161], v117 offset:0
    ds_read_b64 v[162:163], v117 offset:512
    ds_read_b64 v[164:165], v117 offset:1024
    ds_read_b64 v[166:167], v117 offset:1536
    ds_read_b64 v[168:169], v117 offset:2048
    ds_read_b64 v[170:171], v117 offset:2560
    ds_read_b64 v[172:173], v117 offset:3072
    ds_read_b64 v[174:175], v117 offset:3584
    s_waitcnt lgkmcnt(6)
    v_add_f32 v160, v160, v162
    v_add_f32 v161, v161, v163
    buffer_load_dwordx4 a[136:139], v4, s[12:15], s72 offen offset:2048 sc1
    v_mfma_f32_32x32x16_bf16 v[32:47], a[244:247], v[136:139], v[32:47]
    s_waitcnt lgkmcnt(4)
    v_add_f32 v164, v164, v166
    v_add_f32 v165, v165, v167
    s_waitcnt lgkmcnt(2)
    v_add_f32 v168, v168, v170
    v_add_f32 v169, v169, v171
    s_waitcnt lgkmcnt(0)
    v_add_f32 v172, v172, v174
    v_add_f32 v173, v173, v175
    v_add_f32 v160, v160, v164
    v_add_f32 v161, v161, v165
    v_add_f32 v168, v168, v172
    v_add_f32 v169, v169, v173
    v_mfma_f32_32x32x16_bf16 v[32:47], a[248:251], v[144:147], v[32:47]
    v_add_f32 v160, v160, v168
    v_add_f32 v161, v161, v169
    v_mov_b32 v162, v160
    v_mov_b32 v163, v161
    v_nop
    v_permlane32_swap_b32 v160, v162
    v_permlane32_swap_b32 v161, v163
    v_add_f32 v160, v160, v162
    v_add_f32 v161, v161, v163
    v_mul_f32 v118, 0x3b000000, v160
    buffer_load_dwordx4 a[140:143], v4, s[12:15], s72 offen offset:3072 sc1
    v_mfma_f32_32x32x16_bf16 v[32:47], a[252:255], v[152:155], v[32:47]
    v_mul_f32 v119, 0x3b000000, v161
    v_fma_f32 v119, -v118, v118, v119
    v_max_f32 v119, 0, v119
    v_add_f32 v160, 0x3727c5ac, v119
    v_rsq_f32 v120, v160
    s_nop 0
    v_mul_f32 v160, v120, v120
    v_mul_f32 v160, v160, v119
    v_add_f32 v160, 0x3727c5ac, v160
    v_rsq_f32 v160, v160
    s_nop 0
    v_mul_f32 v121, v120, v160
    v_sub_f32 v119, 0, v118
    ds_write_b128 v115, v[48:51] offset:0
    ds_write_b128 v115, v[52:55] offset:1024
    ds_write_b128 v115, v[56:59] offset:2048
    ds_write_b128 v115, v[60:63] offset:3072
    s_waitcnt lgkmcnt(0)
    s_barrier
    ds_read_b128 v[48:51], v116 offset:0
    ds_read_b128 v[52:55], v116 offset:1024
    ds_read_b128 v[56:59], v116 offset:2048
    ds_read_b128 v[60:63], v116 offset:3072
    s_waitcnt lgkmcnt(3)
    v_pk_add_f32 v[32:33], v[32:33], v[48:49]
    v_pk_add_f32 v[34:35], v[34:35], v[50:51]
    s_waitcnt lgkmcnt(2)
    v_pk_add_f32 v[36:37], v[36:37], v[52:53]
    v_pk_add_f32 v[38:39], v[38:39], v[54:55]
    s_waitcnt lgkmcnt(1)
    v_pk_add_f32 v[40:41], v[40:41], v[56:57]
    v_pk_add_f32 v[42:43], v[42:43], v[58:59]
    s_waitcnt lgkmcnt(0)
    v_pk_add_f32 v[44:45], v[44:45], v[60:61]
    v_pk_add_f32 v[46:47], v[46:47], v[62:63]
    v_pk_fma_f32 v[32:33], v[96:97], v[118:119], v[32:33] op_sel:[0,1,0] op_sel_hi:[1,1,1]
    v_pk_fma_f32 v[34:35], v[98:99], v[118:119], v[34:35] op_sel:[0,1,0] op_sel_hi:[1,1,1]
    v_pk_fma_f32 v[36:37], v[100:101], v[118:119], v[36:37] op_sel:[0,1,0] op_sel_hi:[1,1,1]
    v_pk_fma_f32 v[38:39], v[102:103], v[118:119], v[38:39] op_sel:[0,1,0] op_sel_hi:[1,1,1]
    v_pk_fma_f32 v[40:41], v[104:105], v[118:119], v[40:41] op_sel:[0,1,0] op_sel_hi:[1,1,1]
    v_pk_fma_f32 v[42:43], v[106:107], v[118:119], v[42:43] op_sel:[0,1,0] op_sel_hi:[1,1,1]
    v_pk_fma_f32 v[44:45], v[108:109], v[118:119], v[44:45] op_sel:[0,1,0] op_sel_hi:[1,1,1]
    v_pk_fma_f32 v[46:47], v[110:111], v[118:119], v[46:47] op_sel:[0,1,0] op_sel_hi:[1,1,1]
    v_pk_mul_f32 v[32:33], v[32:33], v[120:121] op_sel:[0,1] op_sel_hi:[1,1]
    v_pk_mul_f32 v[34:35], v[34:35], v[120:121] op_sel:[0,1] op_sel_hi:[1,1]
    v_pk_mul_f32 v[36:37], v[36:37], v[120:121] op_sel:[0,1] op_sel_hi:[1,1]
    v_pk_mul_f32 v[38:39], v[38:39], v[120:121] op_sel:[0,1] op_sel_hi:[1,1]
    v_pk_mul_f32 v[40:41], v[40:41], v[120:121] op_sel:[0,1] op_sel_hi:[1,1]
    v_pk_mul_f32 v[42:43], v[42:43], v[120:121] op_sel:[0,1] op_sel_hi:[1,1]
    v_pk_mul_f32 v[44:45], v[44:45], v[120:121] op_sel:[0,1] op_sel_hi:[1,1]
    v_pk_mul_f32 v[46:47], v[46:47], v[120:121] op_sel:[0,1] op_sel_hi:[1,1]
    v_pk_mul_f32 v[64:65], v[32:33], v[32:33]
    v_pk_mul_f32 v[66:67], v[34:35], v[34:35]
    v_pk_mul_f32 v[68:69], v[36:37], v[36:37]
    v_pk_mul_f32 v[70:71], v[38:39], v[38:39]
    v_pk_mul_f32 v[72:73], v[40:41], v[40:41]
    v_pk_mul_f32 v[74:75], v[42:43], v[42:43]
    v_pk_mul_f32 v[76:77], v[44:45], v[44:45]
    v_pk_mul_f32 v[78:79], v[46:47], v[46:47]
    v_pk_fma_f32 v[64:65], v[64:65], s[94:95], v[126:127]
    v_pk_fma_f32 v[66:67], v[66:67], s[94:95], v[126:127]
    v_pk_fma_f32 v[68:69], v[68:69], s[94:95], v[126:127]
    v_pk_fma_f32 v[70:71], v[70:71], s[94:95], v[126:127]
    v_pk_fma_f32 v[72:73], v[72:73], s[94:95], v[126:127]
    v_pk_fma_f32 v[74:75], v[74:75], s[94:95], v[126:127]
    v_pk_fma_f32 v[76:77], v[76:77], s[94:95], v[126:127]
    v_pk_fma_f32 v[78:79], v[78:79], s[94:95], v[126:127]
    v_pk_mul_f32 v[64:65], v[64:65], v[32:33]
    v_pk_mul_f32 v[66:67], v[66:67], v[34:35]
    v_pk_mul_f32 v[68:69], v[68:69], v[36:37]
    v_pk_mul_f32 v[70:71], v[70:71], v[38:39]
    v_pk_mul_f32 v[72:73], v[72:73], v[40:41]
    v_pk_mul_f32 v[74:75], v[74:75], v[42:43]
    v_pk_mul_f32 v[76:77], v[76:77], v[44:45]
    v_pk_mul_f32 v[78:79], v[78:79], v[46:47]
    v_exp_f32 v64, v64
    v_exp_f32 v65, v65
    v_exp_f32 v66, v66
    v_exp_f32 v67, v67
    v_exp_f32 v68, v68
    v_exp_f32 v69, v69
    v_exp_f32 v70, v70
    v_exp_f32 v71, v71
    v_exp_f32 v72, v72
    v_exp_f32 v73, v73
    v_exp_f32 v74, v74
    v_exp_f32 v75, v75
    v_exp_f32 v76, v76
    v_exp_f32 v77, v77
    v_exp_f32 v78, v78
    v_exp_f32 v79, v79
    v_pk_add_f32 v[64:65], v[64:65], 1.0 op_sel_hi:[1,0]
    v_pk_add_f32 v[66:67], v[66:67], 1.0 op_sel_hi:[1,0]
    v_pk_add_f32 v[68:69], v[68:69], 1.0 op_sel_hi:[1,0]
    v_pk_add_f32 v[70:71], v[70:71], 1.0 op_sel_hi:[1,0]
    v_pk_add_f32 v[72:73], v[72:73], 1.0 op_sel_hi:[1,0]
    v_pk_add_f32 v[74:75], v[74:75], 1.0 op_sel_hi:[1,0]
    v_pk_add_f32 v[76:77], v[76:77], 1.0 op_sel_hi:[1,0]
    v_pk_add_f32 v[78:79], v[78:79], 1.0 op_sel_hi:[1,0]
    v_rcp_f32 v64, v64
    v_rcp_f32 v65, v65
    v_rcp_f32 v66, v66
    v_rcp_f32 v67, v67
    v_rcp_f32 v68, v68
    v_rcp_f32 v69, v69
    v_rcp_f32 v70, v70
    v_rcp_f32 v71, v71
    v_rcp_f32 v72, v72
    v_rcp_f32 v73, v73
    v_rcp_f32 v74, v74
    v_rcp_f32 v75, v75
    v_rcp_f32 v76, v76
    v_rcp_f32 v77, v77
    v_rcp_f32 v78, v78
    v_rcp_f32 v79, v79
    v_pk_mul_f32 v[32:33], v[32:33], v[64:65]
    v_pk_mul_f32 v[34:35], v[34:35], v[66:67]
    v_pk_mul_f32 v[36:37], v[36:37], v[68:69]
    v_pk_mul_f32 v[38:39], v[38:39], v[70:71]
    v_pk_mul_f32 v[40:41], v[40:41], v[72:73]
    v_pk_mul_f32 v[42:43], v[42:43], v[74:75]
    v_pk_mul_f32 v[44:45], v[44:45], v[76:77]
    v_pk_mul_f32 v[46:47], v[46:47], v[78:79]
    v_cvt_pk_bf16_f32 v80, v32, v33
    v_cvt_pk_bf16_f32 v81, v34, v35
    v_cvt_pk_bf16_f32 v82, v36, v37
    v_cvt_pk_bf16_f32 v83, v38, v39
    v_cvt_pk_bf16_f32 v84, v40, v41
    v_cvt_pk_bf16_f32 v85, v42, v43
    v_cvt_pk_bf16_f32 v86, v44, v45
    v_cvt_pk_bf16_f32 v87, v46, v47
    s_mov_b64 exec, s[58:59]
    buffer_store_dwordx4 v[80:83], v125, s[12:15], s44 offen
    buffer_store_dwordx4 v[84:87], v125, s[12:15], s44 offen offset:2048
    s_add_u32 s56, s33, 0
    v_add_u32 v5, s56, v125
    ds_write_b128 v5, v[80:83]
    ds_write_b128 v5, v[84:87] offset:2048
    s_mov_b64 exec, s[46:47]
    v_mov_b32 v64, v80
    v_mov_b32 v65, s24
    v_mov_b32 v66, v81
    v_mov_b32 v67, s24
    v_mov_b32 v68, v82
    v_mov_b32 v69, s24
    v_mov_b32 v70, v83
    v_mov_b32 v71, s24
    buffer_store_dwordx4 v[64:67], v189, s[12:15], s45 offen sc1
    buffer_store_dwordx4 v[68:71], v189, s[12:15], s45 offen offset:16 sc1
    v_mov_b32 v72, v84
    v_mov_b32 v73, s24
    v_mov_b32 v74, v85
    v_mov_b32 v75, s24
    v_mov_b32 v76, v86
    v_mov_b32 v77, s24
    v_mov_b32 v78, v87
    v_mov_b32 v79, s24
    buffer_store_dwordx4 v[72:75], v190, s[12:15], s45 offen sc1
    buffer_store_dwordx4 v[76:79], v190, s[12:15], s45 offen offset:16 sc1
    s_mov_b64 exec, -1
    v_lshlrev_b32 v64, 16, v16
    v_and_b32 v65, 0xffff0000, v16
    v_pk_add_f32 v[64:65], v[64:65], v[118:119] op_sel:[0,1] op_sel_hi:[1,1]
    v_pk_mul_f32 v[64:65], v[64:65], v[120:121] op_sel_hi:[1,0]
    v_cvt_pk_bf16_f32 v24, v64, v65
    v_lshlrev_b32 v66, 16, v17
    v_and_b32 v67, 0xffff0000, v17
    v_pk_add_f32 v[66:67], v[66:67], v[118:119] op_sel:[0,1] op_sel_hi:[1,1]
    v_pk_mul_f32 v[66:67], v[66:67], v[120:121] op_sel_hi:[1,0]
    v_cvt_pk_bf16_f32 v25, v66, v67
    v_lshlrev_b32 v68, 16, v18
    v_and_b32 v69, 0xffff0000, v18
    v_pk_add_f32 v[68:69], v[68:69], v[118:119] op_sel:[0,1] op_sel_hi:[1,1]
    v_pk_mul_f32 v[68:69], v[68:69], v[120:121] op_sel_hi:[1,0]
    v_cvt_pk_bf16_f32 v26, v68, v69
    v_lshlrev_b32 v70, 16, v19
    v_and_b32 v71, 0xffff0000, v19
    v_pk_add_f32 v[70:71], v[70:71], v[118:119] op_sel:[0,1] op_sel_hi:[1,1]
    v_pk_mul_f32 v[70:71], v[70:71], v[120:121] op_sel_hi:[1,0]
    v_cvt_pk_bf16_f32 v27, v70, v71
    v_lshlrev_b32 v64, 16, v20
    v_and_b32 v65, 0xffff0000, v20
    v_pk_add_f32 v[64:65], v[64:65], v[118:119] op_sel:[0,1] op_sel_hi:[1,1]
    v_pk_mul_f32 v[64:65], v[64:65], v[120:121] op_sel_hi:[1,0]
    v_cvt_pk_bf16_f32 v28, v64, v65
    v_lshlrev_b32 v66, 16, v21
    v_and_b32 v67, 0xffff0000, v21
    v_pk_add_f32 v[66:67], v[66:67], v[118:119] op_sel:[0,1] op_sel_hi:[1,1]
    v_pk_mul_f32 v[66:67], v[66:67], v[120:121] op_sel_hi:[1,0]
    v_cvt_pk_bf16_f32 v29, v66, v67
    v_lshlrev_b32 v68, 16, v22
    v_and_b32 v69, 0xffff0000, v22
    v_pk_add_f32 v[68:69], v[68:69], v[118:119] op_sel:[0,1] op_sel_hi:[1,1]
    v_pk_mul_f32 v[68:69], v[68:69], v[120:121] op_sel_hi:[1,0]
    v_cvt_pk_bf16_f32 v30, v68, v69
    v_lshlrev_b32 v70, 16, v23
    v_and_b32 v71, 0xffff0000, v23
    v_pk_add_f32 v[70:71], v[70:71], v[118:119] op_sel:[0,1] op_sel_hi:[1,1]
    v_pk_mul_f32 v[70:71], v[70:71], v[120:121] op_sel_hi:[1,0]
    v_cvt_pk_bf16_f32 v31, v70, v71
    s_waitcnt vmcnt(4)
    s_waitcnt lgkmcnt(0)
    s_barrier
    s_cmp_eq_u32 s28, 0
    s_cbranch_scc0 L_fl_15
    s_add_u32 s56, s35, 256
    s_mov_b64 exec, 1
    buffer_store_dwordx2 v[184:185], v186, s[12:15], s56 offen
    s_mov_b64 exec, -1
L_fl_15:
    s_add_u32 s90, s38, 0xc00000
    s_mov_b32 s91, s37
    s_add_u32 s92, s39, 0
    v_mfma_f32_32x32x16_bf16 v[32:47], v[176:179], v[24:27], 0
    v_mfma_f32_32x32x16_bf16 v[32:47], v[180:183], v[28:31], v[32:47]
    v_mov_b32 v172, 0x3f803f80
    v_mov_b32 v173, 0x3f803f80
    v_mov_b32 v174, 0x3f803f80
    v_mov_b32 v175, 0x3f803f80
    s_nop 0
    s_nop 0
    v_mfma_f32_32x32x16_bf16 v[204:219], a[64:67], v[172:175], 0
    v_mfma_f32_32x32x16_bf16 v[204:219], a[68:71], v[172:175], v[204:219]
    v_mfma_f32_32x32x16_bf16 v[204:219], a[72:75], v[172:175], v[204:219]
    v_mfma_f32_32x32x16_bf16 v[204:219], a[76:79], v[172:175], v[204:219]
    v_mfma_f32_32x32x16_bf16 v[204:219], a[80:83], v[172:175], v[204:219]
    v_mfma_f32_32x32x16_bf16 v[204:219], a[84:87], v[172:175], v[204:219]
    v_mfma_f32_32x32x16_bf16 v[204:219], a[88:91], v[172:175], v[204:219]
    v_mfma_f32_32x32x16_bf16 v[204:219], a[92:95], v[172:175], v[204:219]
    v_mfma_f32_32x32x16_bf16 v[204:219], a[96:99], v[172:175], v[204:219]
    v_mfma_f32_32x32x16_bf16 v[204:219], a[100:103], v[172:175], v[204:219]
    v_mfma_f32_32x32x16_bf16 v[204:219], a[104:107], v[172:175], v[204:219]
    v_mfma_f32_32x32x16_bf16 v[204:219], a[108:111], v[172:175], v[204:219]
    v_mfma_f32_32x32x16_bf16 v[204:219], a[112:115], v[172:175], v[204:219]
    v_mfma_f32_32x32x16_bf16 v[204:219], a[116:119], v[172:175], v[204:219]
    v_mfma_f32_32x32x16_bf16 v[204:219], a[120:123], v[172:175], v[204:219]
    v_mfma_f32_32x32x16_bf16 v[204:219], a[124:127], v[172:175], v[204:219]
    s_lshl_b32 s56, s28, 7
    s_add_u32 s56, s56, 155648
    v_lshl_add_u32 v5, v3, 6, s56
    s_mov_b32 s56, 1
    s_mov_b32 s57, 1
    s_mov_b64 exec, s[56:57]
    s_nop 5
    ds_write_b128 v5, v[204:207] offset:0
    ds_write_b128 v5, v[208:211] offset:16
    ds_write_b128 v5, v[212:215] offset:32
    ds_write_b128 v5, v[216:219] offset:48
    s_mov_b64 exec, -1
    s_add_u32 s56, s36, 256
    s_nop 0
    s_mov_b32 s69, 0
L_fw_16:
    buffer_load_dwordx2 v[6:7], v187, s[12:15], s56 offen sc1
    s_add_u32 s69, s69, 1
    s_cmp_gt_u32 s69, 200000
    s_cbranch_scc1 L_end
    s_waitcnt vmcnt(0)
    v_xor_b32 v6, s24, v6
    v_bitop3_b32 v6, v7, s24, v6 bitop3:0xbe
    v_cmp_ne_u32 vcc, 0, v6
    s_nop 4
    s_cbranch_vccnz L_fw_16
    s_nop 0
    s_add_u32 s56, s90, s91
    s_cmp_eq_u32 s40, 0
    s_cselect_b64 exec, 0, -1
    s_mov_b32 m0, s92
    s_nop 0
    buffer_load_dwordx4 v4, s[12:15], s56 offen offset:0 sc1 lds
    buffer_load_dwordx4 v4, s[12:15], s56 offen offset:1024 sc1 lds
    buffer_load_dwordx4 v4, s[12:15], s56 offen offset:2048 sc1 lds
    buffer_load_dwordx4 v4, s[12:15], s56 offen offset:3072 sc1 lds
    s_mov_b64 exec, -1
    s_add_u32 s91, s91, 16384
    s_and_b32 s91, s91, 0xffff
    s_add_u32 s92, s92, 16384
    s_add_u32 s56, s90, s91
    s_cmp_eq_u32 s40, 1
    s_cselect_b64 exec, 0, -1
    s_mov_b32 m0, s92
    s_nop 0
    buffer_load_dwordx4 v4, s[12:15], s56 offen offset:0 sc1 lds
    buffer_load_dwordx4 v4, s[12:15], s56 offen offset:1024 sc1 lds
    buffer_load_dwordx4 v4, s[12:15], s56 offen offset:2048 sc1 lds
    buffer_load_dwordx4 v4, s[12:15], s56 offen offset:3072 sc1 lds
    s_mov_b64 exec, -1
    s_add_u32 s91, s91, 16384
    s_and_b32 s91, s91, 0xffff
    s_add_u32 s92, s92, 16384
    v_mov_b32 v164, 0
    v_mov_b32 v166, 0
    v_mov_b32 v168, 0
    v_mov_b32 v170, 0
    s_mov_b64 exec, s[96:97]
    buffer_load_dwordx4 v[164:167], v195, s[12:15], s85 offen sc1
    buffer_load_dwordx4 v[168:171], v195, s[12:15], s85 offen offset:16 sc1
    s_mov_b64 exec, -1
    s_add_u32 s56, s90, s91
    s_cmp_eq_u32 s40, 2
    s_cselect_b64 exec, 0, -1
    s_mov_b32 m0, s92
    s_nop 0
    buffer_load_dwordx4 v4, s[12:15], s56 offen offset:0 sc1 lds
    buffer_load_dwordx4 v4, s[12:15], s56 offen offset:1024 sc1 lds
    buffer_load_dwordx4 v4, s[12:15], s56 offen offset:2048 sc1 lds
    buffer_load_dwordx4 v4, s[12:15], s56 offen offset:3072 sc1 lds
    s_mov_b64 exec, -1
    s_add_u32 s91, s91, 16384
    s_and_b32 s91, s91, 0xffff
    s_add_u32 s92, s92, 16384
    s_add_u32 s56, s90, s91
    s_cmp_eq_u32 s40, 3
    s_cselect_b64 exec, 0, -1
    s_mov_b32 m0, s92
    s_nop 0
    buffer_load_dwordx4 v4, s[12:15], s56 offen offset:0 sc1 lds
    buffer_load_dwordx4 v4, s[12:15], s56 offen offset:1024 sc1 lds
    buffer_load_dwordx4 v4, s[12:15], s56 offen offset:2048 sc1 lds
    buffer_load_dwordx4 v4, s[12:15], s56 offen offset:3072 sc1 lds
    s_mov_b64 exec, -1
    s_mov_b64 exec, s[96:97]
    s_waitcnt vmcnt(9)
    v_xor_b32 v5, s24, v165
    v_bitop3_b32 v5, v167, s24, v5 bitop3:0xbe
    s_waitcnt vmcnt(8)
    v_bitop3_b32 v5, v169, s24, v5 bitop3:0xbe
    v_bitop3_b32 v5, v171, s24, v5 bitop3:0xbe
    v_cmp_ne_u32 vcc, 0, v5
    s_nop 4
    s_cbranch_vccz L_hp_17_ok
    s_mov_b32 s69, 0
L_hp_17:
    buffer_load_dwordx4 v[164:167], v195, s[12:15], s85 offen sc1
    buffer_load_dwordx4 v[168:171], v195, s[12:15], s85 offen offset:16 sc1
    s_add_u32 s69, s69, 1
    s_cmp_gt_u32 s69, 200000
    s_cbranch_scc1 L_end
    s_waitcnt vmcnt(0)
    v_xor_b32 v5, s24, v165
    v_bitop3_b32 v5, v167, s24, v5 bitop3:0xbe
    v_bitop3_b32 v5, v169, s24, v5 bitop3:0xbe
    v_bitop3_b32 v5, v171, s24, v5 bitop3:0xbe
    v_cmp_ne_u32 vcc, 0, v5
    s_nop 4
    s_cbranch_vccnz L_hp_17
L_hp_17_ok:
    s_nop 1
    s_mov_b64 exec, -1
    v_mov_b32 v165, v166
    v_mov_b32 v166, v168
    v_mov_b32 v167, v170
    s_waitcnt lgkmcnt(0)
    s_barrier
    s_xor_b32 s56, s28, 1
    s_lshl_b32 s56, s56, 7
    s_add_u32 s56, s56, 155648
    v_lshl_add_u32 v5, v3, 6, s56
    ds_read_b128 v[220:223], v5 offset:0
    ds_read_b128 v[224:227], v5 offset:16
    ds_read_b128 v[228:231], v5 offset:32
    ds_read_b128 v[232:235], v5 offset:48
    s_waitcnt lgkmcnt(3)
    v_add_f32 v204, v204, v220
    v_add_f32 v205, v205, v221
    v_add_f32 v206, v206, v222
    v_add_f32 v207, v207, v223
    s_waitcnt lgkmcnt(2)
    v_add_f32 v208, v208, v224
    v_add_f32 v209, v209, v225
    v_add_f32 v210, v210, v226
    v_add_f32 v211, v211, v227
    s_waitcnt lgkmcnt(1)
    v_add_f32 v212, v212, v228
    v_add_f32 v213, v213, v229
    v_add_f32 v214, v214, v230
    v_add_f32 v215, v215, v231
    s_waitcnt lgkmcnt(0)
    v_add_f32 v216, v216, v232
    v_add_f32 v217, v217, v233
    v_add_f32 v218, v218, v234
    v_add_f32 v219, v219, v235
    v_cmp_eq_u32 vcc, 0, v197
    s_nop 3
    s_and_b64 exec, vcc, s[98:99]
    ds_write_b128 v196, v[164:167]
    s_mov_b64 exec, -1
    ds_read_b128 v[68:71], v114 offset:0
    ds_read_b128 v[64:67], v113 offset:0
    ds_read_b128 v[76:79], v114 offset:4096
    ds_read_b128 v[72:75], v113 offset:4096
    ds_read_b128 v[84:87], v114 offset:8192
    ds_read_b128 v[80:83], v113 offset:8192
    ds_read_b128 v[92:95], v114 offset:12288
    ds_read_b128 v[88:91], v113 offset:12288
    s_barrier
    v_cmp_eq_u32 vcc, 1, v197
    s_nop 3
    s_and_b64 exec, vcc, s[98:99]
    ds_write_b128 v196, v[164:167]
    s_mov_b64 exec, -1
    s_waitcnt lgkmcnt(8)
    v_mfma_f32_32x32x16_bf16 v[48:63], a[0:3], v[68:71], 0
    s_and_b32 s71, s71, 31
    s_lshl_b32 s72, s71, 10
    s_add_u32 s72, s72, s70
    s_add_u32 s71, s71, 4
    buffer_load_dwordx4 a[144:147], v4, s[12:15], s72 offen offset:0 sc1
    ds_read_b128 v[132:135], v114 offset:16384
    s_waitcnt lgkmcnt(8)
    v_mfma_f32_32x32x16_bf16 v[32:47], a[0:3], v[64:67], v[32:47]
    ds_read_b128 v[128:131], v113 offset:16384
    ds_read_b128 v[140:143], v114 offset:20480
    s_waitcnt lgkmcnt(9)
    v_mfma_f32_32x32x16_bf16 v[48:63], a[4:7], v[76:79], v[48:63]
    buffer_load_dwordx4 a[148:151], v4, s[12:15], s72 offen offset:1024 sc1
    ds_read_b128 v[136:139], v113 offset:20480
    ds_read_b128 v[148:151], v114 offset:24576
    s_waitcnt lgkmcnt(10)
    v_mfma_f32_32x32x16_bf16 v[32:47], a[4:7], v[72:75], v[32:47]
    ds_read_b128 v[144:147], v113 offset:24576
    ds_read_b128 v[156:159], v114 offset:28672
    s_waitcnt lgkmcnt(11)
    v_mfma_f32_32x32x16_bf16 v[48:63], a[8:11], v[84:87], v[48:63]
    buffer_load_dwordx4 a[152:155], v4, s[12:15], s72 offen offset:2048 sc1
    ds_read_b128 v[152:155], v113 offset:28672
    s_waitcnt lgkmcnt(11)
    v_mfma_f32_32x32x16_bf16 v[32:47], a[8:11], v[80:83], v[32:47]
    s_waitcnt lgkmcnt(10)
    v_mfma_f32_32x32x16_bf16 v[48:63], a[12:15], v[92:95], v[48:63]
    buffer_load_dwordx4 a[156:159], v4, s[12:15], s72 offen offset:3072 sc1
    s_waitcnt lgkmcnt(9)
    v_mfma_f32_32x32x16_bf16 v[32:47], a[12:15], v[88:91], v[32:47]
    s_waitcnt vmcnt(8)
    s_barrier
    v_cmp_eq_u32 vcc, 2, v197
    s_nop 3
    s_and_b64 exec, vcc, s[98:99]
    ds_write_b128 v196, v[164:167]
    s_mov_b64 exec, -1
    s_waitcnt lgkmcnt(8)
    v_mfma_f32_32x32x16_bf16 v[48:63], a[16:19], v[132:135], v[48:63]
    s_and_b32 s71, s71, 31
    s_lshl_b32 s72, s71, 10
    s_add_u32 s72, s72, s70
    s_add_u32 s71, s71, 4
    buffer_load_dwordx4 a[160:163], v4, s[12:15], s72 offen offset:0 sc1
    ds_read_b128 v[68:71], v114 offset:32768
    s_waitcnt lgkmcnt(8)
    v_mfma_f32_32x32x16_bf16 v[32:47], a[16:19], v[128:131], v[32:47]
    ds_read_b128 v[64:67], v113 offset:32768
    ds_read_b128 v[76:79], v114 offset:36864
    s_waitcnt lgkmcnt(9)
    v_mfma_f32_32x32x16_bf16 v[48:63], a[20:23], v[140:143], v[48:63]
    buffer_load_dwordx4 a[164:167], v4, s[12:15], s72 offen offset:1024 sc1
    ds_read_b128 v[72:75], v113 offset:36864
    ds_read_b128 v[84:87], v114 offset:40960
    s_waitcnt lgkmcnt(10)
    v_mfma_f32_32x32x16_bf16 v[32:47], a[20:23], v[136:139], v[32:47]
    ds_read_b128 v[80:83], v113 offset:40960
    ds_read_b128 v[92:95], v114 offset:45056
    s_waitcnt lgkmcnt(11)
    v_mfma_f32_32x32x16_bf16 v[48:63], a[24:27], v[148:151], v[48:63]
    buffer_load_dwordx4 a[168:171], v4, s[12:15], s72 offen offset:2048 sc1
    ds_read_b128 v[88:91], v113 offset:45056
    s_waitcnt lgkmcnt(11)
    v_mfma_f32_32x32x16_bf16 v[32:47], a[24:27], v[144:147], v[32:47]
    s_waitcnt lgkmcnt(10)
    v_mfma_f32_32x32x16_bf16 v[48:63], a[28:31], v[156:159], v[48:63]
    buffer_load_dwordx4 a[172:175], v4, s[12:15], s72 offen offset:3072 sc1
    s_waitcnt lgkmcnt(9)
    v_mfma_f32_32x32x16_bf16 v[32:47], a[28:31], v[152:155], v[32:47]
    s_waitcnt vmcnt(8)
    s_barrier
    v_cmp_eq_u32 vcc, 3, v197
    s_nop 3
    s_and_b64 exec, vcc, s[98:99]
    ds_write_b128 v196, v[164:167]
    s_mov_b64 exec, -1
    s_waitcnt lgkmcnt(8)
    v_mfma_f32_32x32x16_bf16 v[48:63], a[32:35], v[68:71], v[48:63]
    s_and_b32 s71, s71, 31
    s_lshl_b32 s72, s71, 10
    s_add_u32 s72, s72, s70
    s_add_u32 s71, s71, 4
    buffer_load_dwordx4 a[176:179], v4, s[12:15], s72 offen offset:0 sc1
    ds_read_b128 v[132:135], v114 offset:49152
    s_waitcnt lgkmcnt(8)
    v_mfma_f32_32x32x16_bf16 v[32:47], a[32:35], v[64:67], v[32:47]
    ds_read_b128 v[128:131], v113 offset:49152
    ds_read_b128 v[140:143], v114 offset:53248
    s_waitcnt lgkmcnt(9)
    v_mfma_f32_32x32x16_bf16 v[48:63], a[36:39], v[76:79], v[48:63]
    buffer_load_dwordx4 a[180:183], v4, s[12:15], s72 offen offset:1024 sc1
    ds_read_b128 v[136:139], v113 offset:53248
    ds_read_b128 v[148:151], v114 offset:57344
    s_waitcnt lgkmcnt(10)
    v_mfma_f32_32x32x16_bf16 v[32:47], a[36:39], v[72:75], v[32:47]
    ds_read_b128 v[144:147], v113 offset:57344
    ds_read_b128 v[156:159], v114 offset:61440
    s_waitcnt lgkmcnt(11)
    v_mfma_f32_32x32x16_bf16 v[48:63], a[40:43], v[84:87], v[48:63]
    buffer_load_dwordx4 a[184:187], v4, s[12:15], s72 offen offset:2048 sc1
    ds_read_b128 v[152:155], v113 offset:61440
    s_waitcnt lgkmcnt(11)
    v_mfma_f32_32x32x16_bf16 v[32:47], a[40:43], v[80:83], v[32:47]
    s_waitcnt lgkmcnt(10)
    v_mfma_f32_32x32x16_bf16 v[48:63], a[44:47], v[92:95], v[48:63]
    buffer_load_dwordx4 a[188:191], v4, s[12:15], s72 offen offset:3072 sc1
    s_waitcnt lgkmcnt(9)
    v_mfma_f32_32x32x16_bf16 v[32:47], a[44:47], v[88:91], v[32:47]
    s_waitcnt lgkmcnt(7)
    v_mfma_f32_32x32x16_bf16 v[48:63], a[48:51], v[132:135], v[48:63]
    s_lshl_b32 s70, s26, 2
    s_add_u32 s70, s70, s28
    s_mul_i32 s70, s70, 48
    s_add_u32 s70, s70, 1552
    s_lshl_b32 s70, s70, 10
    s_mul_i32 s71, s27, 8
    s_add_u32 s71, s71, 16
    s_and_b32 s71, s71, 31
    s_lshl_b32 s72, s71, 10
    s_add_u32 s72, s72, s70
    s_add_u32 s71, s71, 4
    buffer_load_dwordx4 a[192:195], v4, s[12:15], s72 offen offset:0 sc1
    s_waitcnt lgkmcnt(5)
    v_mfma_f32_32x32x16_bf16 v[48:63], a[52:55], v[140:143], v[48:63]
    s_waitcnt lgkmcnt(3)
    v_mfma_f32_32x32x16_bf16 v[48:63], a[56:59], v[148:151], v[48:63]
    buffer_load_dwordx4 a[196:199], v4, s[12:15], s72 offen offset:1024 sc1
    s_waitcnt lgkmcnt(1)
    v_mfma_f32_32x32x16_bf16 v[48:63], a[60:63], v[156:159], v[48:63]
    v_mfma_f32_32x32x16_bf16 v[32:47], a[48:51], v[128:131], v[32:47]
    buffer_load_dwordx4 a[200:203], v4, s[12:15], s72 offen offset:2048 sc1
    v_mfma_f32_32x32x16_bf16 v[32:47], a[52:55], v[136:139], v[32:47]
    v_mfma_f32_32x32x16_bf16 v[32:47], a[56:59], v[144:147], v[32:47]
    buffer_load_dwordx4 a[204:207], v4, s[12:15], s72 offen offset:3072 sc1
    s_waitcnt lgkmcnt(0)
    v_mfma_f32_32x32x16_bf16 v[32:47], a[60:63], v[152:155], v[32:47]
    s_nop 4
    ds_write_b128 v115, v[48:51] offset:0
    ds_write_b128 v115, v[52:55] offset:1024
    ds_write_b128 v115, v[56:59] offset:2048
    ds_write_b128 v115, v[60:63] offset:3072
    s_waitcnt lgkmcnt(0)
    s_barrier
    ds_read_b128 v[48:51], v116 offset:0
    ds_read_b128 v[52:55], v116 offset:1024
    ds_read_b128 v[56:59], v116 offset:2048
    ds_read_b128 v[60:63], v116 offset:3072
    s_waitcnt lgkmcnt(3)
    v_pk_add_f32 v[32:33], v[32:33], v[48:49]
    v_pk_add_f32 v[34:35], v[34:35], v[50:51]
    s_waitcnt lgkmcnt(2)
    v_pk_add_f32 v[36:37], v[36:37], v[52:53]
    v_pk_add_f32 v[38:39], v[38:39], v[54:55]
    s_waitcnt lgkmcnt(1)
    v_pk_add_f32 v[40:41], v[40:41], v[56:57]
    v_pk_add_f32 v[42:43], v[42:43], v[58:59]
    s_waitcnt lgkmcnt(0)
    v_pk_add_f32 v[44:45], v[44:45], v[60:61]
    v_pk_add_f32 v[46:47], v[46:47], v[62:63]
    v_cvt_pk_bf16_f32 v8, v32, v33
    v_cvt_pk_bf16_f32 v9, v34, v35
    v_cvt_pk_bf16_f32 v10, v36, v37
    v_cvt_pk_bf16_f32 v11, v38, v39
    v_cvt_pk_bf16_f32 v12, v40, v41
    v_cvt_pk_bf16_f32 v13, v42, v43
    v_cvt_pk_bf16_f32 v14, v44, v45
    v_cvt_pk_bf16_f32 v15, v46, v47
    s_add_u32 s91, s32, 0xe00000
    buffer_store_dwordx4 v[8:11], v112, s[12:15], s91 offen
    buffer_store_dwordx4 v[12:15], v112, s[12:15], s91 offen offset:2048
    s_add_u32 s56, s33, 65536
    v_add_u32 v5, s56, v112
    ds_write_b128 v5, v[8:11]
    ds_write_b128 v5, v[12:15] offset:2048
    v_pk_add_f32 v[68:69], v[32:33], v[34:35]
    v_pk_mul_f32 v[70:71], v[32:33], v[32:33]
    v_pk_add_f32 v[72:73], v[36:37], v[38:39]
    v_pk_mul_f32 v[74:75], v[34:35], v[34:35]
    v_pk_fma_f32 v[70:71], v[36:37], v[36:37], v[70:71]
    v_pk_fma_f32 v[74:75], v[38:39], v[38:39], v[74:75]
    v_pk_add_f32 v[72:73], v[72:73], v[42:43]
    v_pk_fma_f32 v[70:71], v[40:41], v[40:41], v[70:71]
    v_pk_add_f32 v[68:69], v[68:69], v[40:41]
    v_pk_fma_f32 v[74:75], v[42:43], v[42:43], v[74:75]
    v_pk_add_f32 v[72:73], v[72:73], v[46:47]
    v_pk_fma_f32 v[70:71], v[44:45], v[44:45], v[70:71]
    v_pk_add_f32 v[68:69], v[68:69], v[44:45]
    v_pk_fma_f32 v[74:75], v[46:47], v[46:47], v[74:75]
    v_pk_add_f32 v[68:69], v[68:69], v[72:73]
    v_pk_add_f32 v[70:71], v[70:71], v[74:75]
    v_add_f32 v68, v68, v69
    v_add_f32 v69, v70, v71
    v_mov_b32 v70, v68
    v_mov_b32 v71, v69
    s_add_u32 s91, s34, 0xa20000
    s_mov_b32 s56, -1
    s_mov_b32 s57, 0
    v_permlane32_swap_b32 v68, v70
    v_permlane32_swap_b32 v69, v71
    v_pk_add_f32 v[68:69], v[68:69], v[70:71]
    s_mov_b64 exec, s[56:57]
    buffer_store_dwordx2 v[68:69], v188, s[12:15], s91 offen
    s_mov_b64 exec, -1
    s_waitcnt vmcnt(0)
    s_waitcnt lgkmcnt(0)
    s_barrier
    s_cmp_eq_u32 s28, 0
    s_cbranch_scc0 L_fl_18
    s_add_u32 s56, s35, 384
    s_mov_b64 exec, 1
    buffer_store_dwordx2 v[184:185], v186, s[12:15], s56 offen
    s_mov_b64 exec, -1
L_fl_18:
    s_cmp_lt_u32 s26, 3
    s_cselect_b32 s73, 1, 0
    s_xor_b32 s74, s62, 1
    s_or_b32 s74, s74, s73
    s_min_u32 s75, s26, 3
    s_mul_i32 s56, s26, 5
    s_add_u32 s75, s75, s56
    s_lshl_b32 s56, s63, 1
    s_add_u32 s57, s56, 3
    s_add_u32 s76, s63, 3
    s_cmp_eq_u32 s73, 1
    s_cselect_b32 s57, s57, s76
    s_cmp_eq_u32 s62, 0
    s_cselect_b32 s76, s56, s57
    s_mul_i32 s77, s62, 3
    s_add_u32 s77, s77, 1
    v_lshlrev_b32 v5, 4, v2
    v_lshl_add_u32 v5, v3, 10, v5
    v_add_u32 v123, 65536, v5
    s_lshl_b32 s56, s63, 11
    v_add_u32 v124, s56, v123
    s_lshl_b32 s56, s63, 9
    v_add_u32 v125, s56, v124
    s_xor_b32 s56, s56, 512
    v_add_u32 v124, s56, v124
    v_lshlrev_b32 v5, 3, v2
    v_lshl_add_u32 v5, v3, 12, v5
    v_add_u32 v122, 131072, v5
    s_xor_b32 s57, s28, 1
    s_lshl_b32 s57, s57, 12
    s_add_u32 s57, s57, 139264
    v_add_u32 v121, s57, v4
    s_add_u32 s90, s38, 0xe00000
    s_mov_b32 s91, s37
    s_add_u32 s92, s39, 65536
    s_add_u32 s56, s36, 384
    s_nop 0
    s_mov_b32 s69, 0
L_fw_19:
    buffer_load_dwordx2 v[6:7], v187, s[12:15], s56 offen sc1
    s_add_u32 s69, s69, 1
    s_cmp_gt_u32 s69, 200000
    s_cbranch_scc1 L_end
    s_waitcnt vmcnt(0)
    v_xor_b32 v6, s24, v6
    v_bitop3_b32 v6, v7, s24, v6 bitop3:0xbe
    v_cmp_ne_u32 vcc, 0, v6
    s_nop 4
    s_cbranch_vccnz L_fw_19
    s_nop 0
    v_mov_b32 v236, 0x3f803f80
    v_mov_b32 v237, 0x3f803f80
    v_mov_b32 v238, 0x3f803f80
    v_mov_b32 v239, 0x3f803f80
    s_add_u32 s56, s90, s91
    s_cmp_eq_u32 s40, 0
    s_cselect_b64 exec, 0, -1
    s_mov_b32 m0, s92
    s_nop 0
    buffer_load_dwordx4 v4, s[12:15], s56 offen offset:0 sc1 lds
    buffer_load_dwordx4 v4, s[12:15], s56 offen offset:1024 sc1 lds
    buffer_load_dwordx4 v4, s[12:15], s56 offen offset:2048 sc1 lds
    buffer_load_dwordx4 v4, s[12:15], s56 offen offset:3072 sc1 lds
    s_mov_b64 exec, -1
    s_add_u32 s91, s91, 16384
    s_and_b32 s91, s91, 0xffff
    s_add_u32 s92, s92, 16384
    s_add_u32 s56, s90, s91
    s_cmp_eq_u32 s40, 1
    s_cselect_b64 exec, 0, -1
    s_mov_b32 m0, s92
    s_nop 0
    buffer_load_dwordx4 v4, s[12:15], s56 offen offset:0 sc1 lds
    buffer_load_dwordx4 v4, s[12:15], s56 offen offset:1024 sc1 lds
    buffer_load_dwordx4 v4, s[12:15], s56 offen offset:2048 sc1 lds
    buffer_load_dwordx4 v4, s[12:15], s56 offen offset:3072 sc1 lds
    s_mov_b64 exec, -1
    s_add_u32 s91, s91, 16384
    s_and_b32 s91, s91, 0xffff
    s_add_u32 s92, s92, 16384
    s_add_u32 s56, s41, 0xa20000
    s_add_u32 m0, s42, 131072
    s_nop 0
    buffer_load_dwordx4 v4, s[12:15], s56 offen sc1 lds
    buffer_load_dwordx4 v4, s[12:15], s56 offen offset:1024 sc1 lds
    s_add_u32 s56, s90, s91
    s_cmp_eq_u32 s40, 2
    s_cselect_b64 exec, 0, -1
    s_mov_b32 m0, s92
    s_nop 0
    buffer_load_dwordx4 v4, s[12:15], s56 offen offset:0 sc1 lds
    buffer_load_dwordx4 v4, s[12:15], s56 offen offset:1024 sc1 lds
    buffer_load_dwordx4 v4, s[12:15], s56 offen offset:2048 sc1 lds
    buffer_load_dwordx4 v4, s[12:15], s56 offen offset:3072 sc1 lds
    s_mov_b64 exec, -1
    s_add_u32 s91, s91, 16384
    s_and_b32 s91, s91, 0xffff
    s_add_u32 s92, s92, 16384
    s_add_u32 s56, s90, s91
    s_cmp_eq_u32 s40, 3
    s_cselect_b64 exec, 0, -1
    s_mov_b32 m0, s92
    s_nop 0
    buffer_load_dwordx4 v4, s[12:15], s56 offen offset:0 sc1 lds
    buffer_load_dwordx4 v4, s[12:15], s56 offen offset:1024 sc1 lds
    buffer_load_dwordx4 v4, s[12:15], s56 offen offset:2048 sc1 lds
    buffer_load_dwordx4 v4, s[12:15], s56 offen offset:3072 sc1 lds
    s_mov_b64 exec, -1
    v_mfma_f32_32x32x16_bf16 v[144:159], a[128:131], v[236:239], 0
    v_mfma_f32_32x32x16_bf16 v[144:159], a[132:135], v[236:239], v[144:159]
    v_mfma_f32_32x32x16_bf16 v[144:159], a[136:139], v[236:239], v[144:159]
    v_mfma_f32_32x32x16_bf16 v[144:159], a[140:143], v[236:239], v[144:159]
    v_mfma_f32_32x32x16_bf16 v[144:159], a[144:147], v[236:239], v[144:159]
    v_mfma_f32_32x32x16_bf16 v[144:159], a[148:151], v[236:239], v[144:159]
    v_mfma_f32_32x32x16_bf16 v[144:159], a[152:155], v[236:239], v[144:159]
    v_mfma_f32_32x32x16_bf16 v[144:159], a[156:159], v[236:239], v[144:159]
    s_waitcnt vmcnt(14)
    s_barrier
    v_mfma_f32_32x32x16_bf16 v[144:159], a[160:163], v[236:239], v[144:159]
    s_and_b32 s71, s71, 31
    s_lshl_b32 s72, s71, 10
    s_add_u32 s72, s72, s70
    s_add_u32 s71, s71, 4
    buffer_load_dwordx4 a[208:211], v4, s[12:15], s72 offen offset:0 sc1
    ds_read_b128 v[68:71], v124 offset:0
    v_mfma_f32_32x32x16_bf16 v[144:159], a[164:167], v[236:239], v[144:159]
    ds_read_b128 v[64:67], v125 offset:0
    ds_read_b128 v[76:79], v124 offset:4096
    v_mfma_f32_32x32x16_bf16 v[144:159], a[168:171], v[236:239], v[144:159]
    buffer_load_dwordx4 a[212:215], v4, s[12:15], s72 offen offset:1024 sc1
    ds_read_b128 v[72:75], v125 offset:4096
    ds_read_b128 v[84:87], v124 offset:8192
    v_mfma_f32_32x32x16_bf16 v[144:159], a[172:175], v[236:239], v[144:159]
    ds_read_b128 v[80:83], v125 offset:8192
    ds_read_b128 v[92:95], v124 offset:12288
    v_mfma_f32_32x32x16_bf16 v[144:159], a[176:179], v[236:239], v[144:159]
    buffer_load_dwordx4 a[216:219], v4, s[12:15], s72 offen offset:2048 sc1
    ds_read_b128 v[88:91], v125 offset:12288
    v_mfma_f32_32x32x16_bf16 v[144:159], a[180:183], v[236:239], v[144:159]
    v_mfma_f32_32x32x16_bf16 v[144:159], a[184:187], v[236:239], v[144:159]
    buffer_load_dwordx4 a[220:223], v4, s[12:15], s72 offen offset:3072 sc1
    v_mfma_f32_32x32x16_bf16 v[144:159], a[188:191], v[236:239], v[144:159]
    s_waitcnt vmcnt(14)
    s_barrier
    s_waitcnt lgkmcnt(7)
    v_mfma_f32_32x32x16_bf16 v[48:63], a[64:67], v[68:71], 0
    s_and_b32 s71, s71, 31
    s_lshl_b32 s72, s71, 10
    s_add_u32 s72, s72, s70
    s_add_u32 s71, s71, 4
    buffer_load_dwordx4 a[224:227], v4, s[12:15], s72 offen offset:0 sc1
    ds_read_b128 v[28:31], v124 offset:16384
    s_waitcnt lgkmcnt(7)
    v_mfma_f32_32x32x16_bf16 v[32:47], a[64:67], v[64:67], 0
    ds_read_b128 v[24:27], v125 offset:16384
    ds_read_b128 v[100:103], v124 offset:20480
    s_waitcnt lgkmcnt(8)
    v_mfma_f32_32x32x16_bf16 v[48:63], a[68:71], v[76:79], v[48:63]
    buffer_load_dwordx4 a[228:231], v4, s[12:15], s72 offen offset:1024 sc1
    ds_read_b128 v[96:99], v125 offset:20480
    ds_read_b128 v[108:111], v124 offset:24576
    s_waitcnt lgkmcnt(9)
    v_mfma_f32_32x32x16_bf16 v[32:47], a[68:71], v[72:75], v[32:47]
    ds_read_b128 v[104:107], v125 offset:24576
    ds_read_b128 v[172:175], v124 offset:28672
    s_waitcnt lgkmcnt(10)
    v_mfma_f32_32x32x16_bf16 v[48:63], a[72:75], v[84:87], v[48:63]
    buffer_load_dwordx4 a[232:235], v4, s[12:15], s72 offen offset:2048 sc1
    ds_read_b128 v[168:171], v125 offset:28672
    s_waitcnt lgkmcnt(10)
    v_mfma_f32_32x32x16_bf16 v[32:47], a[72:75], v[80:83], v[32:47]
    s_waitcnt lgkmcnt(9)
    v_mfma_f32_32x32x16_bf16 v[48:63], a[76:79], v[92:95], v[48:63]
    buffer_load_dwordx4 a[236:239], v4, s[12:15], s72 offen offset:3072 sc1
    s_waitcnt lgkmcnt(8)
    v_mfma_f32_32x32x16_bf16 v[32:47], a[76:79], v[88:91], v[32:47]
    s_waitcnt vmcnt(12)
    s_barrier
    s_waitcnt lgkmcnt(7)
    v_mfma_f32_32x32x16_bf16 v[48:63], a[80:83], v[28:31], v[48:63]
    s_and_b32 s71, s71, 31
    s_lshl_b32 s72, s71, 10
    s_add_u32 s72, s72, s70
    s_add_u32 s71, s71, 4
    buffer_load_dwordx4 a[240:243], v4, s[12:15], s72 offen offset:0 sc1
    ds_read_b128 v[68:71], v124 offset:32768
    s_waitcnt lgkmcnt(7)
    v_mfma_f32_32x32x16_bf16 v[32:47], a[80:83], v[24:27], v[32:47]
    ds_read_b128 v[64:67], v125 offset:32768
    ds_read_b128 v[76:79], v124 offset:36864
    s_waitcnt lgkmcnt(8)
    v_mfma_f32_32x32x16_bf16 v[48:63], a[84:87], v[100:103], v[48:63]
    buffer_load_dwordx4 a[244:247], v4, s[12:15], s72 offen offset:1024 sc1
    ds_read_b128 v[72:75], v125 offset:36864
    ds_read_b128 v[84:87], v124 offset:40960
    s_waitcnt lgkmcnt(9)
    v_mfma_f32_32x32x16_bf16 v[32:47], a[84:87], v[96:99], v[32:47]
    ds_read_b128 v[80:83], v125 offset:40960
    ds_read_b128 v[92:95], v124 offset:45056
    s_waitcnt lgkmcnt(10)
    v_mfma_f32_32x32x16_bf16 v[48:63], a[88:91], v[108:111], v[48:63]
    buffer_load_dwordx4 a[248:251], v4, s[12:15], s72 offen offset:2048 sc1
    ds_read_b128 v[88:91], v125 offset:45056
    s_waitcnt lgkmcnt(10)
    v_mfma_f32_32x32x16_bf16 v[32:47], a[88:91], v[104:107], v[32:47]
    s_waitcnt lgkmcnt(9)
    v_mfma_f32_32x32x16_bf16 v[48:63], a[92:95], v[172:175], v[48:63]
    buffer_load_dwordx4 a[252:255], v4, s[12:15], s72 offen offset:3072 sc1
    s_waitcnt lgkmcnt(8)
    v_mfma_f32_32x32x16_bf16 v[32:47], a[92:95], v[168:171], v[32:47]
    s_waitcnt vmcnt(12)
    s_barrier
    s_waitcnt lgkmcnt(7)
    v_mfma_f32_32x32x16_bf16 v[48:63], a[96:99], v[68:71], v[48:63]
    s_lshl_b32 s70, s26, 2
    s_add_u32 s70, s70, s28
    s_mul_i32 s70, s70, 46
    s_add_u32 s70, s70, 3072
    s_lshl_b32 s70, s70, 10
    s_mul_i32 s71, s27, 12
    s_add_u32 s71, s71, 0
    s_sub_u32 s72, s71, 43
    s_cmp_ge_u32 s71, 43
    s_cselect_b32 s71, s72, s71
    s_lshl_b32 s72, s71, 10
    s_add_u32 s72, s72, s70
    s_add_u32 s71, s71, 4
    buffer_load_dwordx4 a[0:3], v4, s[12:15], s72 offen offset:0 sc1
    ds_read_b128 v[28:31], v124 offset:49152
    s_waitcnt lgkmcnt(7)
    v_mfma_f32_32x32x16_bf16 v[32:47], a[96:99], v[64:67], v[32:47]
    ds_read_b128 v[24:27], v125 offset:49152
    ds_read_b128 v[100:103], v124 offset:53248
    ds_read_b128 v[96:99], v125 offset:53248
    ds_read_b128 v[108:111], v124 offset:57344
    s_waitcnt lgkmcnt(10)
    v_mfma_f32_32x32x16_bf16 v[48:63], a[100:103], v[76:79], v[48:63]
    buffer_load_dwordx4 a[4:7], v4, s[12:15], s72 offen offset:1024 sc1
    ds_read_b128 v[104:107], v125 offset:57344
    ds_read_b128 v[172:175], v124 offset:61440
    ds_read_b128 v[168:171], v125 offset:61440
    ds_read_b64 v[220:221], v122 offset:0
    s_waitcnt lgkmcnt(13)
    v_mfma_f32_32x32x16_bf16 v[32:47], a[100:103], v[72:75], v[32:47]
    ds_read_b64 v[222:223], v122 offset:512
    ds_read_b64 v[224:225], v122 offset:1024
    ds_read_b64 v[226:227], v122 offset:1536
    ds_read_b64 v[228:229], v122 offset:2048
    s_waitcnt lgkmcnt(15)
    v_mfma_f32_32x32x16_bf16 v[48:63], a[104:107], v[84:87], v[48:63]
    buffer_load_dwordx4 a[8:11], v4, s[12:15], s72 offen offset:2048 sc1
    ds_read_b64 v[230:231], v122 offset:2560
    ds_read_b64 v[232:233], v122 offset:3072
    ds_read_b64 v[234:235], v122 offset:3584
    ds_read_b64 v[240:241], v122 offset:256
    v_mfma_f32_32x32x16_bf16 v[32:47], a[104:107], v[80:83], v[32:47]
    ds_read_b64 v[242:243], v122 offset:768
    ds_read_b64 v[244:245], v122 offset:1280
    ds_read_b64 v[246:247], v122 offset:1792
    ds_read_b64 v[248:249], v122 offset:2304
    s_waitcnt lgkmcnt(15)
    v_mfma_f32_32x32x16_bf16 v[48:63], a[108:111], v[92:95], v[48:63]
    buffer_load_dwordx4 a[12:15], v4, s[12:15], s72 offen offset:3072 sc1
    ds_read_b64 v[250:251], v122 offset:2816
    ds_read_b64 v[252:253], v122 offset:3328
    ds_read_b64 v[254:255], v122 offset:3840
    v_mfma_f32_32x32x16_bf16 v[32:47], a[108:111], v[88:91], v[32:47]
    v_mfma_f32_32x32x16_bf16 v[48:63], a[112:115], v[28:31], v[48:63]
    s_waitcnt lgkmcnt(14)
    v_add_f32 v220, v220, v222
    v_mfma_f32_32x32x16_bf16 v[48:63], a[116:119], v[100:103], v[48:63]
    v_add_f32 v221, v221, v223
    s_waitcnt lgkmcnt(12)
    v_add_f32 v224, v224, v226
    v_add_f32 v225, v225, v227
    s_waitcnt lgkmcnt(10)
    v_add_f32 v228, v228, v230
    v_add_f32 v229, v229, v231
    s_waitcnt lgkmcnt(8)
    v_add_f32 v232, v232, v234
    v_add_f32 v233, v233, v235
    v_mfma_f32_32x32x16_bf16 v[48:63], a[120:123], v[108:111], v[48:63]
    v_add_f32 v220, v220, v224
    v_add_f32 v221, v221, v225
    v_add_f32 v228, v228, v232
    v_add_f32 v229, v229, v233
    v_add_f32 v220, v220, v228
    v_add_f32 v221, v221, v229
    v_mov_b32 v222, v220
    v_mfma_f32_32x32x16_bf16 v[48:63], a[124:127], v[172:175], v[48:63]
    v_mov_b32 v223, v221
    v_nop
    v_permlane32_swap_b32 v220, v222
    v_permlane32_swap_b32 v221, v223
    v_add_f32 v220, v220, v222
    v_add_f32 v221, v221, v223
    v_mul_f32 v160, 0x3b000000, v220
    v_mfma_f32_32x32x16_bf16 v[32:47], a[112:115], v[24:27], v[32:47]
    v_mul_f32 v161, 0x3b000000, v221
    v_fma_f32 v161, -v160, v160, v161
    v_max_f32 v161, 0, v161
    v_add_f32 v161, 0x3727c5ac, v161
    v_rsq_f32 v161, v161
    v_sub_f32 v160, 0, v160
    s_waitcnt lgkmcnt(6)
    v_add_f32 v240, v240, v242
    v_mfma_f32_32x32x16_bf16 v[32:47], a[116:119], v[96:99], v[32:47]
    v_add_f32 v241, v241, v243
    s_waitcnt lgkmcnt(4)
    v_add_f32 v244, v244, v246
    v_add_f32 v245, v245, v247
    s_waitcnt lgkmcnt(2)
    v_add_f32 v248, v248, v250
    v_add_f32 v249, v249, v251
    s_waitcnt lgkmcnt(0)
    v_add_f32 v252, v252, v254
    v_add_f32 v253, v253, v255
    v_mfma_f32_32x32x16_bf16 v[32:47], a[120:123], v[104:107], v[32:47]
    v_add_f32 v240, v240, v244
    v_add_f32 v241, v241, v245
    v_add_f32 v248, v248, v252
    v_add_f32 v249, v249, v253
    v_add_f32 v240, v240, v248
    v_add_f32 v241, v241, v249
    v_mov_b32 v242, v240
    v_mfma_f32_32x32x16_bf16 v[32:47], a[124:127], v[168:171], v[32:47]
    v_mov_b32 v243, v241
    v_nop
    v_permlane32_swap_b32 v240, v242
    v_permlane32_swap_b32 v241, v243
    v_add_f32 v240, v240, v242
    v_add_f32 v241, v241, v243
    v_mul_f32 v162, 0x3b000000, v240
    v_mul_f32 v163, 0x3b000000, v241
    v_fma_f32 v163, -v162, v162, v163
    v_max_f32 v163, 0, v163
    v_add_f32 v163, 0x3727c5ac, v163
    v_rsq_f32 v163, v163
    v_sub_f32 v162, 0, v162
    s_cmp_eq_u32 s63, 1
    s_cselect_b64 s[56:57], -1, 0
    v_cndmask_b32 v164, v160, v162, s[56:57]
    v_cndmask_b32 v165, v161, v163, s[56:57]
    v_lshlrev_b32 v119, 4, v2
    v_lshl_add_u32 v119, v3, 10, v119
    s_mul_i32 s57, s25, 176128
    s_add_u32 s57, s57, 0x1400000
    s_add_u32 s56, s75, s76
    s_lshl_b32 s56, s56, 12
    s_add_u32 s78, s56, s57
    s_add_u32 s56, s75, s77
    s_lshl_b32 s56, s56, 12
    s_add_u32 s79, s56, s57
    s_lshl_b32 s56, s63, 9
    s_add_u32 s79, s79, s56
    s_add_u32 s80, s78, 512
    ds_write_b128 v115, v[48:51] offset:0
    ds_write_b128 v115, v[52:55] offset:1024
    ds_write_b128 v115, v[56:59] offset:2048
    ds_write_b128 v115, v[60:63] offset:3072
    s_waitcnt lgkmcnt(0)
    s_barrier
    ds_read_b128 v[48:51], v121 offset:0
    ds_read_b128 v[52:55], v121 offset:1024
    ds_read_b128 v[56:59], v121 offset:2048
    ds_read_b128 v[60:63], v121 offset:3072
    s_waitcnt lgkmcnt(3)
    v_pk_add_f32 v[32:33], v[32:33], v[48:49]
    v_pk_add_f32 v[34:35], v[34:35], v[50:51]
    s_waitcnt lgkmcnt(2)
    v_pk_add_f32 v[36:37], v[36:37], v[52:53]
    v_pk_add_f32 v[38:39], v[38:39], v[54:55]
    s_waitcnt lgkmcnt(1)
    v_pk_add_f32 v[40:41], v[40:41], v[56:57]
    v_pk_add_f32 v[42:43], v[42:43], v[58:59]
    s_waitcnt lgkmcnt(0)
    v_pk_add_f32 v[44:45], v[44:45], v[60:61]
    v_pk_add_f32 v[46:47], v[46:47], v[62:63]
    ds_read_b128 v[24:27], v123 offset:0
    ds_read_b128 v[28:31], v123 offset:2048
    ds_read_b128 v[168:171], v123 offset:4096
    ds_read_b128 v[172:175], v123 offset:6144
    ds_read_b128 v[48:51], v123 offset:8192
    ds_read_b128 v[52:55], v123 offset:10240
    s_waitcnt lgkmcnt(5)
    v_mfma_f32_32x32x16_bf16 v[64:79], a[128:131], v[24:27], 0
    v_fmac_f32 v32, v164, v204
    ds_read_b128 v[24:27], v123 offset:12288
    s_waitcnt lgkmcnt(5)
    v_mfma_f32_32x32x16_bf16 v[64:79], a[132:135], v[28:31], v[64:79]
    s_sub_u32 s72, s71, 43
    s_cmp_ge_u32 s71, 43
    s_cselect_b32 s71, s72, s71
    s_lshl_b32 s72, s71, 10
    s_add_u32 s72, s72, s70
    s_add_u32 s71, s71, 4
    buffer_load_dwordx4 a[16:19], v4, s[12:15], s72 offen offset:0 sc1
    v_fmac_f32 v33, v164, v205
    v_fmac_f32 v34, v164, v206
    v_fmac_f32 v35, v164, v207
    ds_read_b128 v[28:31], v123 offset:14336
    s_waitcnt lgkmcnt(5)
    v_mfma_f32_32x32x16_bf16 v[64:79], a[136:139], v[168:171], v[64:79]
    v_fmac_f32 v36, v164, v208
    v_fmac_f32 v37, v164, v209
    v_fmac_f32 v38, v164, v210
    ds_read_b128 v[168:171], v123 offset:16384
    s_waitcnt lgkmcnt(5)
    v_mfma_f32_32x32x16_bf16 v[64:79], a[140:143], v[172:175], v[64:79]
    v_fmac_f32 v39, v164, v211
    v_fmac_f32 v40, v164, v212
    v_fmac_f32 v41, v164, v213
    ds_read_b128 v[172:175], v123 offset:18432
    s_waitcnt lgkmcnt(5)
    v_mfma_f32_32x32x16_bf16 v[64:79], a[144:147], v[48:51], v[64:79]
    v_fmac_f32 v42, v164, v214
    v_fmac_f32 v43, v164, v215
    v_fmac_f32 v44, v164, v216
    ds_read_b128 v[48:51], v123 offset:20480
    s_waitcnt lgkmcnt(5)
    v_mfma_f32_32x32x16_bf16 v[64:79], a[148:151], v[52:55], v[64:79]
    buffer_load_dwordx4 a[20:23], v4, s[12:15], s72 offen offset:1024 sc1
    v_fmac_f32 v45, v164, v217
    v_fmac_f32 v46, v164, v218
    v_fmac_f32 v47, v164, v219
    ds_read_b128 v[52:55], v123 offset:22528
    s_waitcnt lgkmcnt(5)
    v_mfma_f32_32x32x16_bf16 v[64:79], a[152:155], v[24:27], v[64:79]
    v_mul_f32 v32, v165, v32
    v_mul_f32 v33, v165, v33
    v_mul_f32 v34, v165, v34
    v_mul_f32 v35, v165, v35
    ds_read_b128 v[24:27], v123 offset:24576
    s_waitcnt lgkmcnt(5)
    v_mfma_f32_32x32x16_bf16 v[64:79], a[156:159], v[28:31], v[64:79]
    v_mul_f32 v36, v165, v36
    v_mul_f32 v37, v165, v37
    v_mul_f32 v38, v165, v38
    ds_read_b128 v[28:31], v123 offset:26624
    s_waitcnt lgkmcnt(5)
    v_mfma_f32_32x32x16_bf16 v[64:79], a[160:163], v[168:171], v[64:79]
    v_mul_f32 v39, v165, v39
    v_mul_f32 v40, v165, v40
    v_mul_f32 v41, v165, v41
    ds_read_b128 v[168:171], v123 offset:28672
    s_waitcnt lgkmcnt(5)
    v_mfma_f32_32x32x16_bf16 v[64:79], a[164:167], v[172:175], v[64:79]
    buffer_load_dwordx4 a[24:27], v4, s[12:15], s72 offen offset:2048 sc1
    v_mul_f32 v42, v165, v42
    v_mul_f32 v43, v165, v43
    v_mul_f32 v44, v165, v44
    ds_read_b128 v[172:175], v123 offset:30720
    s_waitcnt lgkmcnt(5)
    v_mfma_f32_32x32x16_bf16 v[64:79], a[168:171], v[48:51], v[64:79]
    v_mul_f32 v45, v165, v45
    v_mul_f32 v46, v165, v46
    v_mul_f32 v47, v165, v47
    ds_read_b128 v[48:51], v123 offset:32768
    s_waitcnt lgkmcnt(5)
    v_mfma_f32_32x32x16_bf16 v[64:79], a[172:175], v[52:55], v[64:79]
    v_mul_f32 v96, v32, v32
    v_mul_f32 v97, v33, v33
    v_mul_f32 v98, v34, v34
    ds_read_b128 v[52:55], v123 offset:34816
    s_waitcnt lgkmcnt(5)
    v_mfma_f32_32x32x16_bf16 v[64:79], a[176:179], v[24:27], v[64:79]
    v_mul_f32 v99, v35, v35
    v_mul_f32 v100, v36, v36
    v_mul_f32 v101, v37, v37
    v_mul_f32 v102, v38, v38
    ds_read_b128 v[24:27], v123 offset:36864
    s_waitcnt lgkmcnt(5)
    v_mfma_f32_32x32x16_bf16 v[64:79], a[180:183], v[28:31], v[64:79]
    buffer_load_dwordx4 a[28:31], v4, s[12:15], s72 offen offset:3072 sc1
    v_mul_f32 v103, v39, v39
    v_mul_f32 v104, v40, v40
    v_mul_f32 v105, v41, v41
    ds_read_b128 v[28:31], v123 offset:38912
    s_waitcnt lgkmcnt(5)
    v_mfma_f32_32x32x16_bf16 v[64:79], a[184:187], v[168:171], v[64:79]
    v_mul_f32 v106, v42, v42
    v_mul_f32 v107, v43, v43
    v_mul_f32 v108, v44, v44
    ds_read_b128 v[168:171], v123 offset:40960
    s_waitcnt lgkmcnt(5)
    v_mfma_f32_32x32x16_bf16 v[64:79], a[188:191], v[172:175], v[64:79]
    v_mul_f32 v109, v45, v45
    v_mul_f32 v110, v46, v46
    v_mul_f32 v111, v47, v47
    ds_read_b128 v[172:175], v123 offset:43008
    s_waitcnt lgkmcnt(5)
    v_mfma_f32_32x32x16_bf16 v[64:79], a[192:195], v[48:51], v[64:79]
    v_fma_f32 v96, v96, s94, v126
    v_fma_f32 v97, v97, s94, v126
    v_fma_f32 v98, v98, s94, v126
    v_mfma_f32_32x32x16_bf16 v[144:159], a[192:195], v[236:239], v[144:159]
    s_sub_u32 s72, s71, 43
    s_cmp_ge_u32 s71, 43
    s_cselect_b32 s71, s72, s71
    s_lshl_b32 s72, s71, 10
    s_add_u32 s72, s72, s70
    s_add_u32 s71, s71, 4
    buffer_load_dwordx4 a[32:35], v4, s[12:15], s72 offen offset:0 sc1
    v_fma_f32 v99, v99, s94, v126
    v_fma_f32 v100, v100, s94, v126
    v_fma_f32 v101, v101, s94, v126
    ds_read_b128 v[48:51], v123 offset:45056
    s_waitcnt lgkmcnt(5)
    v_mfma_f32_32x32x16_bf16 v[64:79], a[196:199], v[52:55], v[64:79]
    v_fma_f32 v102, v102, s94, v126
    v_fma_f32 v103, v103, s94, v126
    v_fma_f32 v104, v104, s94, v126
    v_fma_f32 v105, v105, s94, v126
    v_mfma_f32_32x32x16_bf16 v[144:159], a[196:199], v[236:239], v[144:159]
    v_fma_f32 v106, v106, s94, v126
    v_fma_f32 v107, v107, s94, v126
    v_fma_f32 v108, v108, s94, v126
    ds_read_b128 v[52:55], v123 offset:47104
    s_waitcnt lgkmcnt(5)
    v_mfma_f32_32x32x16_bf16 v[64:79], a[200:203], v[24:27], v[64:79]
    v_fma_f32 v109, v109, s94, v126
    v_fma_f32 v110, v110, s94, v126
    v_fma_f32 v111, v111, s94, v126
    v_mfma_f32_32x32x16_bf16 v[144:159], a[200:203], v[236:239], v[144:159]
    buffer_load_dwordx4 a[36:39], v4, s[12:15], s72 offen offset:1024 sc1
    v_mul_f32 v96, v96, v32
    v_mul_f32 v97, v97, v33
    v_mul_f32 v98, v98, v34
    ds_read_b128 v[24:27], v123 offset:49152
    s_waitcnt lgkmcnt(5)
    v_mfma_f32_32x32x16_bf16 v[64:79], a[204:207], v[28:31], v[64:79]
    v_mul_f32 v99, v99, v35
    v_mul_f32 v100, v100, v36
    v_mul_f32 v101, v101, v37
    v_mfma_f32_32x32x16_bf16 v[144:159], a[204:207], v[236:239], v[144:159]
    v_mul_f32 v102, v102, v38
    v_mul_f32 v103, v103, v39
    v_mul_f32 v104, v104, v40
    ds_read_b128 v[28:31], v123 offset:51200
    s_waitcnt vmcnt(21)
    s_waitcnt lgkmcnt(5)
    v_mfma_f32_32x32x16_bf16 v[64:79], a[208:211], v[168:171], v[64:79]
    v_mul_f32 v105, v105, v41
    v_mul_f32 v106, v106, v42
    v_mul_f32 v107, v107, v43
    v_mul_f32 v108, v108, v44
    v_mfma_f32_32x32x16_bf16 v[144:159], a[208:211], v[236:239], v[144:159]
    buffer_load_dwordx4 a[40:43], v4, s[12:15], s72 offen offset:2048 sc1
    v_mul_f32 v109, v109, v45
    v_mul_f32 v110, v110, v46
    v_mul_f32 v111, v111, v47
    ds_read_b128 v[168:171], v123 offset:53248
    s_waitcnt vmcnt(21)
    s_waitcnt lgkmcnt(5)
    v_mfma_f32_32x32x16_bf16 v[64:79], a[212:215], v[172:175], v[64:79]
    v_exp_f32 v96, v96
    v_exp_f32 v97, v97
    v_exp_f32 v98, v98
    v_mfma_f32_32x32x16_bf16 v[144:159], a[212:215], v[236:239], v[144:159]
    v_exp_f32 v99, v99
    v_exp_f32 v100, v100
    v_exp_f32 v101, v101
    ds_read_b128 v[172:175], v123 offset:55296
    s_waitcnt vmcnt(20)
    s_waitcnt lgkmcnt(5)
    v_mfma_f32_32x32x16_bf16 v[64:79], a[216:219], v[48:51], v[64:79]
    v_exp_f32 v102, v102
    v_exp_f32 v103, v103
    v_exp_f32 v104, v104
    v_mfma_f32_32x32x16_bf16 v[144:159], a[216:219], v[236:239], v[144:159]
    buffer_load_dwordx4 a[44:47], v4, s[12:15], s72 offen offset:3072 sc1
    v_exp_f32 v105, v105
    v_exp_f32 v106, v106
    v_exp_f32 v107, v107
    ds_read_b128 v[48:51], v123 offset:57344
    s_waitcnt vmcnt(20)
    s_waitcnt lgkmcnt(5)
    v_mfma_f32_32x32x16_bf16 v[64:79], a[220:223], v[52:55], v[64:79]
    v_exp_f32 v108, v108
    v_exp_f32 v109, v109
    v_exp_f32 v110, v110
    v_exp_f32 v111, v111
    v_mfma_f32_32x32x16_bf16 v[144:159], a[220:223], v[236:239], v[144:159]
    v_add_f32 v96, 1.0, v96
    v_add_f32 v97, 1.0, v97
    v_add_f32 v98, 1.0, v98
    ds_read_b128 v[52:55], v123 offset:59392
    s_waitcnt vmcnt(19)
    s_waitcnt lgkmcnt(5)
    v_mfma_f32_32x32x16_bf16 v[64:79], a[224:227], v[24:27], v[64:79]
    v_add_f32 v99, 1.0, v99
    v_add_f32 v100, 1.0, v100
    v_add_f32 v101, 1.0, v101
    v_mfma_f32_32x32x16_bf16 v[144:159], a[224:227], v[236:239], v[144:159]
    s_sub_u32 s72, s71, 43
    s_cmp_ge_u32 s71, 43
    s_cselect_b32 s71, s72, s71
    s_lshl_b32 s72, s71, 10
    s_add_u32 s72, s72, s70
    s_add_u32 s71, s71, 4
    buffer_load_dwordx4 a[48:51], v4, s[12:15], s72 offen offset:0 sc1
    v_add_f32 v102, 1.0, v102
    v_add_f32 v103, 1.0, v103
    v_add_f32 v104, 1.0, v104
    ds_read_b128 v[24:27], v123 offset:61440
    s_waitcnt vmcnt(19)
    s_waitcnt lgkmcnt(5)
    v_mfma_f32_32x32x16_bf16 v[64:79], a[228:231], v[28:31], v[64:79]
    v_add_f32 v105, 1.0, v105
    v_add_f32 v106, 1.0, v106
    v_add_f32 v107, 1.0, v107
    v_mfma_f32_32x32x16_bf16 v[144:159], a[228:231], v[236:239], v[144:159]
    v_add_f32 v108, 1.0, v108
    v_add_f32 v109, 1.0, v109
    v_add_f32 v110, 1.0, v110
    ds_read_b128 v[28:31], v123 offset:63488
    s_waitcnt vmcnt(18)
    s_waitcnt lgkmcnt(5)
    v_mfma_f32_32x32x16_bf16 v[64:79], a[232:235], v[168:171], v[64:79]
    v_add_f32 v111, 1.0, v111
    v_rcp_f32 v96, v96
    v_rcp_f32 v97, v97
    v_rcp_f32 v98, v98
    v_mfma_f32_32x32x16_bf16 v[144:159], a[232:235], v[236:239], v[144:159]
    buffer_load_dwordx4 a[52:55], v4, s[12:15], s72 offen offset:1024 sc1
    v_rcp_f32 v99, v99
    v_rcp_f32 v100, v100
    v_rcp_f32 v101, v101
    s_waitcnt vmcnt(18)
    s_waitcnt lgkmcnt(4)
    v_mfma_f32_32x32x16_bf16 v[64:79], a[236:239], v[172:175], v[64:79]
    v_rcp_f32 v102, v102
    v_rcp_f32 v103, v103
    v_rcp_f32 v104, v104
    v_mfma_f32_32x32x16_bf16 v[144:159], a[236:239], v[236:239], v[144:159]
    v_rcp_f32 v105, v105
    v_rcp_f32 v106, v106
    v_rcp_f32 v107, v107
    s_waitcnt vmcnt(17)
    s_waitcnt lgkmcnt(3)
    v_mfma_f32_32x32x16_bf16 v[64:79], a[240:243], v[48:51], v[64:79]
    v_rcp_f32 v108, v108
    v_rcp_f32 v109, v109
    v_rcp_f32 v110, v110
    v_mfma_f32_32x32x16_bf16 v[144:159], a[240:243], v[236:239], v[144:159]
    buffer_load_dwordx4 a[56:59], v4, s[12:15], s72 offen offset:2048 sc1
    v_rcp_f32 v111, v111
    v_mul_f32 v32, v32, v96
    v_mul_f32 v33, v33, v97
    s_waitcnt vmcnt(17)
    s_waitcnt lgkmcnt(2)
    v_mfma_f32_32x32x16_bf16 v[64:79], a[244:247], v[52:55], v[64:79]
    v_mul_f32 v34, v34, v98
    v_mul_f32 v35, v35, v99
    v_mul_f32 v36, v36, v100
    v_mul_f32 v37, v37, v101
    v_mfma_f32_32x32x16_bf16 v[144:159], a[244:247], v[236:239], v[144:159]
    v_mul_f32 v38, v38, v102
    v_mul_f32 v39, v39, v103
    v_mul_f32 v40, v40, v104
    s_waitcnt vmcnt(16)
    s_waitcnt lgkmcnt(1)
    v_mfma_f32_32x32x16_bf16 v[64:79], a[248:251], v[24:27], v[64:79]
    v_mul_f32 v41, v41, v105
    v_mul_f32 v42, v42, v106
    v_mul_f32 v43, v43, v107
    v_mfma_f32_32x32x16_bf16 v[144:159], a[248:251], v[236:239], v[144:159]
    buffer_load_dwordx4 a[60:63], v4, s[12:15], s72 offen offset:3072 sc1
    v_mul_f32 v44, v44, v108
    v_mul_f32 v45, v45, v109
    v_mul_f32 v46, v46, v110
    s_waitcnt vmcnt(16)
    s_waitcnt lgkmcnt(0)
    v_mfma_f32_32x32x16_bf16 v[64:79], a[252:255], v[28:31], v[64:79]
    v_mul_f32 v47, v47, v111
    v_cvt_pk_bf16_f32 v104, v32, v33
    v_cvt_pk_bf16_f32 v105, v34, v35
    v_mfma_f32_32x32x16_bf16 v[144:159], a[252:255], v[236:239], v[144:159]
    v_cvt_pk_bf16_f32 v106, v36, v37
    v_cvt_pk_bf16_f32 v107, v38, v39
    v_cvt_pk_bf16_f32 v108, v40, v41
    v_cvt_pk_bf16_f32 v109, v42, v43
    v_cvt_pk_bf16_f32 v110, v44, v45
    v_cvt_pk_bf16_f32 v111, v46, v47
    s_cmp_eq_u32 s74, 0
    s_cselect_b64 exec, 0, -1
    buffer_store_dwordx4 v[104:107], v119, s[12:15], s79 offen sc1
    buffer_store_dwordx4 v[108:111], v119, s[12:15], s79 offen offset:2048 sc1
    s_mov_b64 exec, -1
    v_add_u32 v124, 512, v123
    ds_read_b128 v[24:27], v124 offset:0
    ds_read_b128 v[28:31], v124 offset:2048
    ds_read_b128 v[168:171], v124 offset:4096
    ds_read_b128 v[172:175], v124 offset:6144
    ds_read_b128 v[48:51], v124 offset:8192
    ds_read_b128 v[52:55], v124 offset:10240
    s_waitcnt lgkmcnt(5)
    v_mfma_f32_32x32x16_bf16 v[80:95], a[128:131], v[24:27], 0
    v_fmac_f32 v64, v160, v144
    ds_read_b128 v[24:27], v124 offset:12288
    s_waitcnt lgkmcnt(5)
    v_mfma_f32_32x32x16_bf16 v[80:95], a[132:135], v[28:31], v[80:95]
    s_sub_u32 s72, s71, 43
    s_cmp_ge_u32 s71, 43
    s_cselect_b32 s71, s72, s71
    s_lshl_b32 s72, s71, 10
    s_add_u32 s72, s72, s70
    s_add_u32 s71, s71, 4
    buffer_load_dwordx4 a[64:67], v4, s[12:15], s72 offen offset:0 sc1
    v_fmac_f32 v65, v160, v145
    v_fmac_f32 v66, v160, v146
    v_fmac_f32 v67, v160, v147
    v_fmac_f32 v68, v160, v148
    ds_read_b128 v[28:31], v124 offset:14336
    s_waitcnt lgkmcnt(5)
    v_mfma_f32_32x32x16_bf16 v[80:95], a[136:139], v[168:171], v[80:95]
    v_fmac_f32 v69, v160, v149
    v_fmac_f32 v70, v160, v150
    v_fmac_f32 v71, v160, v151
    v_fmac_f32 v72, v160, v152
    v_fmac_f32 v73, v160, v153
    ds_read_b128 v[168:171], v124 offset:16384
    s_waitcnt lgkmcnt(5)
    v_mfma_f32_32x32x16_bf16 v[80:95], a[140:143], v[172:175], v[80:95]
    v_fmac_f32 v74, v160, v154
    v_fmac_f32 v75, v160, v155
    v_fmac_f32 v76, v160, v156
    v_fmac_f32 v77, v160, v157
    v_fmac_f32 v78, v160, v158
    ds_read_b128 v[172:175], v124 offset:18432
    s_waitcnt lgkmcnt(5)
    v_mfma_f32_32x32x16_bf16 v[80:95], a[144:147], v[48:51], v[80:95]
    buffer_load_dwordx4 a[68:71], v4, s[12:15], s72 offen offset:1024 sc1
    v_fmac_f32 v79, v160, v159
    v_mul_f32 v64, v161, v64
    v_mul_f32 v65, v161, v65
    v_mul_f32 v66, v161, v66
    v_mul_f32 v67, v161, v67
    ds_read_b128 v[48:51], v124 offset:20480
    s_waitcnt lgkmcnt(5)
    v_mfma_f32_32x32x16_bf16 v[80:95], a[148:151], v[52:55], v[80:95]
    v_mul_f32 v68, v161, v68
    v_mul_f32 v69, v161, v69
    v_mul_f32 v70, v161, v70
    v_mul_f32 v71, v161, v71
    ds_read_b128 v[52:55], v124 offset:22528
    s_waitcnt lgkmcnt(5)
    v_mfma_f32_32x32x16_bf16 v[80:95], a[152:155], v[24:27], v[80:95]
    v_mul_f32 v72, v161, v72
    v_mul_f32 v73, v161, v73
    v_mul_f32 v74, v161, v74
    v_mul_f32 v75, v161, v75
    v_mul_f32 v76, v161, v76
    ds_read_b128 v[24:27], v124 offset:24576
    s_waitcnt lgkmcnt(5)
    v_mfma_f32_32x32x16_bf16 v[80:95], a[156:159], v[28:31], v[80:95]
    buffer_load_dwordx4 a[72:75], v4, s[12:15], s72 offen offset:2048 sc1
    v_mul_f32 v77, v161, v77
    v_mul_f32 v78, v161, v78
    v_mul_f32 v79, v161, v79
    v_mul_f32 v96, v64, v64
    v_mul_f32 v97, v65, v65
    ds_read_b128 v[28:31], v124 offset:26624
    s_waitcnt lgkmcnt(5)
    v_mfma_f32_32x32x16_bf16 v[80:95], a[160:163], v[168:171], v[80:95]
    v_mul_f32 v98, v66, v66
    v_mul_f32 v99, v67, v67
    v_mul_f32 v100, v68, v68
    v_mul_f32 v101, v69, v69
    v_mul_f32 v102, v70, v70
    ds_read_b128 v[168:171], v124 offset:28672
    s_waitcnt lgkmcnt(5)
    v_mfma_f32_32x32x16_bf16 v[80:95], a[164:167], v[172:175], v[80:95]
    v_mul_f32 v103, v71, v71
    v_mul_f32 v104, v72, v72
    v_mul_f32 v105, v73, v73
    v_mul_f32 v106, v74, v74
    ds_read_b128 v[172:175], v124 offset:30720
    s_waitcnt lgkmcnt(5)
    v_mfma_f32_32x32x16_bf16 v[80:95], a[168:171], v[48:51], v[80:95]
    buffer_load_dwordx4 a[76:79], v4, s[12:15], s72 offen offset:3072 sc1
    v_mul_f32 v107, v75, v75
    v_mul_f32 v108, v76, v76
    v_mul_f32 v109, v77, v77
    v_mul_f32 v110, v78, v78
    v_mul_f32 v111, v79, v79
    ds_read_b128 v[48:51], v124 offset:32768
    s_waitcnt lgkmcnt(5)
    v_mfma_f32_32x32x16_bf16 v[80:95], a[172:175], v[52:55], v[80:95]
    v_fma_f32 v96, v96, s94, v126
    v_fma_f32 v97, v97, s94, v126
    v_fma_f32 v98, v98, s94, v126
    v_fma_f32 v99, v99, s94, v126
    v_fma_f32 v100, v100, s94, v126
    ds_read_b128 v[52:55], v124 offset:34816
    s_waitcnt lgkmcnt(5)
    v_mfma_f32_32x32x16_bf16 v[80:95], a[176:179], v[24:27], v[80:95]
    v_fma_f32 v101, v101, s94, v126
    v_fma_f32 v102, v102, s94, v126
    v_fma_f32 v103, v103, s94, v126
    v_fma_f32 v104, v104, s94, v126
    v_fma_f32 v105, v105, s94, v126
    ds_read_b128 v[24:27], v124 offset:36864
    s_waitcnt lgkmcnt(5)
    v_mfma_f32_32x32x16_bf16 v[80:95], a[180:183], v[28:31], v[80:95]
    v_fma_f32 v106, v106, s94, v126
    v_fma_f32 v107, v107, s94, v126
    v_fma_f32 v108, v108, s94, v126
    v_fma_f32 v109, v109, s94, v126
    ds_read_b128 v[28:31], v124 offset:38912
    s_waitcnt lgkmcnt(5)
    v_mfma_f32_32x32x16_bf16 v[80:95], a[184:187], v[168:171], v[80:95]
    s_sub_u32 s72, s71, 43
    s_cmp_ge_u32 s71, 43
    s_cselect_b32 s71, s72, s71
    s_lshl_b32 s72, s71, 10
    s_add_u32 s72, s72, s70
    s_add_u32 s71, s71, 4
    buffer_load_dwordx4 a[80:83], v4, s[12:15], s72 offen offset:0 sc1
    v_fma_f32 v110, v110, s94, v126
    v_fma_f32 v111, v111, s94, v126
    v_mul_f32 v96, v96, v64
    v_mul_f32 v97, v97, v65
    v_mul_f32 v98, v98, v66
    ds_read_b128 v[168:171], v124 offset:40960
    s_waitcnt lgkmcnt(5)
    v_mfma_f32_32x32x16_bf16 v[80:95], a[188:191], v[172:175], v[80:95]
    v_mul_f32 v99, v99, v67
    v_mul_f32 v100, v100, v68
    v_mul_f32 v101, v101, v69
    v_mul_f32 v102, v102, v70
    v_mul_f32 v103, v103, v71
    ds_read_b128 v[172:175], v124 offset:43008
    s_waitcnt lgkmcnt(5)
    v_mfma_f32_32x32x16_bf16 v[80:95], a[192:195], v[48:51], v[80:95]
    v_mul_f32 v104, v104, v72
    v_mul_f32 v105, v105, v73
    v_mul_f32 v106, v106, v74
    v_mul_f32 v107, v107, v75
    v_mul_f32 v108, v108, v76
    ds_read_b128 v[48:51], v124 offset:45056
    s_waitcnt lgkmcnt(5)
    v_mfma_f32_32x32x16_bf16 v[80:95], a[196:199], v[52:55], v[80:95]
    buffer_load_dwordx4 a[84:87], v4, s[12:15], s72 offen offset:1024 sc1
    v_mul_f32 v109, v109, v77
    v_mul_f32 v110, v110, v78
    v_mul_f32 v111, v111, v79
    v_exp_f32 v96, v96
    ds_read_b128 v[52:55], v124 offset:47104
    s_waitcnt lgkmcnt(5)
    v_mfma_f32_32x32x16_bf16 v[80:95], a[200:203], v[24:27], v[80:95]
    v_exp_f32 v97, v97
    v_exp_f32 v98, v98
    v_exp_f32 v99, v99
    v_exp_f32 v100, v100
    v_exp_f32 v101, v101
    ds_read_b128 v[24:27], v124 offset:49152
    s_waitcnt lgkmcnt(5)
    v_mfma_f32_32x32x16_bf16 v[80:95], a[204:207], v[28:31], v[80:95]
    v_exp_f32 v102, v102
    v_exp_f32 v103, v103
    v_exp_f32 v104, v104
    v_exp_f32 v105, v105
    v_exp_f32 v106, v106
    ds_read_b128 v[28:31], v124 offset:51200
    s_waitcnt lgkmcnt(5)
    v_mfma_f32_32x32x16_bf16 v[80:95], a[208:211], v[168:171], v[80:95]
    buffer_load_dwordx4 a[88:91], v4, s[12:15], s72 offen offset:2048 sc1
    v_exp_f32 v107, v107
    v_exp_f32 v108, v108
    v_exp_f32 v109, v109
    v_exp_f32 v110, v110
    v_exp_f32 v111, v111
    ds_read_b128 v[168:171], v124 offset:53248
    s_waitcnt lgkmcnt(5)
    v_mfma_f32_32x32x16_bf16 v[80:95], a[212:215], v[172:175], v[80:95]
    v_add_f32 v96, 1.0, v96
    v_add_f32 v97, 1.0, v97
    v_add_f32 v98, 1.0, v98
    v_add_f32 v99, 1.0, v99
    ds_read_b128 v[172:175], v124 offset:55296
    s_waitcnt lgkmcnt(5)
    v_mfma_f32_32x32x16_bf16 v[80:95], a[216:219], v[48:51], v[80:95]
    v_add_f32 v100, 1.0, v100
    v_add_f32 v101, 1.0, v101
    v_add_f32 v102, 1.0, v102
    v_add_f32 v103, 1.0, v103
    v_add_f32 v104, 1.0, v104
    ds_read_b128 v[48:51], v124 offset:57344
    s_waitcnt lgkmcnt(5)
    v_mfma_f32_32x32x16_bf16 v[80:95], a[220:223], v[52:55], v[80:95]
    buffer_load_dwordx4 a[92:95], v4, s[12:15], s72 offen offset:3072 sc1
    v_add_f32 v105, 1.0, v105
    v_add_f32 v106, 1.0, v106
    v_add_f32 v107, 1.0, v107
    v_add_f32 v108, 1.0, v108
    v_add_f32 v109, 1.0, v109
    ds_read_b128 v[52:55], v124 offset:59392
    s_waitcnt lgkmcnt(5)
    v_mfma_f32_32x32x16_bf16 v[80:95], a[224:227], v[24:27], v[80:95]
    v_add_f32 v110, 1.0, v110
    v_add_f32 v111, 1.0, v111
    v_rcp_f32 v96, v96
    v_rcp_f32 v97, v97
    v_rcp_f32 v98, v98
    ds_read_b128 v[24:27], v124 offset:61440
    s_waitcnt lgkmcnt(5)
    v_mfma_f32_32x32x16_bf16 v[80:95], a[228:231], v[28:31], v[80:95]
    v_rcp_f32 v99, v99
    v_rcp_f32 v100, v100
    v_rcp_f32 v101, v101
    v_rcp_f32 v102, v102
    ds_read_b128 v[28:31], v124 offset:63488
    s_waitcnt lgkmcnt(5)
    v_mfma_f32_32x32x16_bf16 v[80:95], a[232:235], v[168:171], v[80:95]
    s_sub_u32 s72, s71, 43
    s_cmp_ge_u32 s71, 43
    s_cselect_b32 s71, s72, s71
    s_lshl_b32 s72, s71, 10
    s_add_u32 s72, s72, s70
    s_add_u32 s71, s71, 4
    buffer_load_dwordx4 a[96:99], v4, s[12:15], s72 offen offset:0 sc1
    v_rcp_f32 v103, v103
    v_rcp_f32 v104, v104
    v_rcp_f32 v105, v105
    v_rcp_f32 v106, v106
    v_rcp_f32 v107, v107
    s_waitcnt lgkmcnt(4)
    v_mfma_f32_32x32x16_bf16 v[80:95], a[236:239], v[172:175], v[80:95]
    v_rcp_f32 v108, v108
    v_rcp_f32 v109, v109
    v_rcp_f32 v110, v110
    v_rcp_f32 v111, v111
    v_mul_f32 v64, v64, v96
    s_waitcnt lgkmcnt(3)
    v_mfma_f32_32x32x16_bf16 v[80:95], a[240:243], v[48:51], v[80:95]
    v_mul_f32 v65, v65, v97
    v_mul_f32 v66, v66, v98
    v_mul_f32 v67, v67, v99
    v_mul_f32 v68, v68, v100
    v_mul_f32 v69, v69, v101
    s_waitcnt lgkmcnt(2)
    v_mfma_f32_32x32x16_bf16 v[80:95], a[244:247], v[52:55], v[80:95]
    v_mul_f32 v70, v70, v102
    v_mul_f32 v71, v71, v103
    v_mul_f32 v72, v72, v104
    v_mul_f32 v73, v73, v105
    s_waitcnt lgkmcnt(1)
    v_mfma_f32_32x32x16_bf16 v[80:95], a[248:251], v[24:27], v[80:95]
    buffer_load_dwordx4 a[100:103], v4, s[12:15], s72 offen offset:1024 sc1
    v_mul_f32 v74, v74, v106
    v_mul_f32 v75, v75, v107
    v_mul_f32 v76, v76, v108
    v_mul_f32 v77, v77, v109
    v_mul_f32 v78, v78, v110
    s_waitcnt lgkmcnt(0)
    v_mfma_f32_32x32x16_bf16 v[80:95], a[252:255], v[28:31], v[80:95]
    v_mul_f32 v79, v79, v111
    v_cvt_pk_bf16_f32 v104, v64, v65
    v_cvt_pk_bf16_f32 v105, v66, v67
    v_cvt_pk_bf16_f32 v106, v68, v69
    v_cvt_pk_bf16_f32 v107, v70, v71
    v_cvt_pk_bf16_f32 v108, v72, v73
    v_cvt_pk_bf16_f32 v109, v74, v75
    v_cvt_pk_bf16_f32 v110, v76, v77
    v_cvt_pk_bf16_f32 v111, v78, v79
    buffer_store_dwordx4 v[104:107], v119, s[12:15], s78 offen sc1
    buffer_store_dwordx4 v[108:111], v119, s[12:15], s78 offen offset:2048 sc1
    s_nop 0
    v_pk_fma_f32 v[80:81], v[144:145], v[162:163], v[80:81] op_sel_hi:[1,0,1]
    v_pk_mul_f32 v[80:81], v[80:81], v[162:163] op_sel:[0,1] op_sel_hi:[1,1]
    v_pk_fma_f32 v[82:83], v[146:147], v[162:163], v[82:83] op_sel_hi:[1,0,1]
    v_pk_mul_f32 v[82:83], v[82:83], v[162:163] op_sel:[0,1] op_sel_hi:[1,1]
    v_pk_fma_f32 v[84:85], v[148:149], v[162:163], v[84:85] op_sel_hi:[1,0,1]
    v_pk_mul_f32 v[84:85], v[84:85], v[162:163] op_sel:[0,1] op_sel_hi:[1,1]
    buffer_load_dwordx4 a[104:107], v4, s[12:15], s72 offen offset:2048 sc1
    v_pk_fma_f32 v[86:87], v[150:151], v[162:163], v[86:87] op_sel_hi:[1,0,1]
    v_pk_mul_f32 v[86:87], v[86:87], v[162:163] op_sel:[0,1] op_sel_hi:[1,1]
    v_pk_fma_f32 v[88:89], v[152:153], v[162:163], v[88:89] op_sel_hi:[1,0,1]
    v_pk_mul_f32 v[88:89], v[88:89], v[162:163] op_sel:[0,1] op_sel_hi:[1,1]
    v_pk_fma_f32 v[90:91], v[154:155], v[162:163], v[90:91] op_sel_hi:[1,0,1]
    v_pk_mul_f32 v[90:91], v[90:91], v[162:163] op_sel:[0,1] op_sel_hi:[1,1]
    v_pk_fma_f32 v[92:93], v[156:157], v[162:163], v[92:93] op_sel_hi:[1,0,1]
    v_pk_mul_f32 v[92:93], v[92:93], v[162:163] op_sel:[0,1] op_sel_hi:[1,1]
    v_pk_fma_f32 v[94:95], v[158:159], v[162:163], v[94:95] op_sel_hi:[1,0,1]
    v_pk_mul_f32 v[94:95], v[94:95], v[162:163] op_sel:[0,1] op_sel_hi:[1,1]
    v_pk_mul_f32 v[96:97], v[80:81], v[80:81]
    v_pk_mul_f32 v[98:99], v[82:83], v[82:83]
    buffer_load_dwordx4 a[108:111], v4, s[12:15], s72 offen offset:3072 sc1
    v_pk_mul_f32 v[100:101], v[84:85], v[84:85]
    v_pk_mul_f32 v[102:103], v[86:87], v[86:87]
    v_pk_mul_f32 v[104:105], v[88:89], v[88:89]
    v_pk_mul_f32 v[106:107], v[90:91], v[90:91]
    v_pk_mul_f32 v[108:109], v[92:93], v[92:93]
    v_pk_mul_f32 v[110:111], v[94:95], v[94:95]
    v_pk_fma_f32 v[96:97], v[96:97], s[94:95], v[126:127]
    v_pk_fma_f32 v[98:99], v[98:99], s[94:95], v[126:127]
    v_pk_fma_f32 v[100:101], v[100:101], s[94:95], v[126:127]
    v_pk_fma_f32 v[102:103], v[102:103], s[94:95], v[126:127]
    v_pk_fma_f32 v[104:105], v[104:105], s[94:95], v[126:127]
    v_pk_fma_f32 v[106:107], v[106:107], s[94:95], v[126:127]
    s_sub_u32 s72, s71, 43
    s_cmp_ge_u32 s71, 43
    s_cselect_b32 s71, s72, s71
    s_lshl_b32 s72, s71, 10
    s_add_u32 s72, s72, s70
    s_add_u32 s71, s71, 4
    buffer_load_dwordx4 a[112:115], v4, s[12:15], s72 offen offset:0 sc1
    v_pk_fma_f32 v[108:109], v[108:109], s[94:95], v[126:127]
    v_pk_fma_f32 v[110:111], v[110:111], s[94:95], v[126:127]
    v_pk_mul_f32 v[96:97], v[96:97], v[80:81]
    v_pk_mul_f32 v[98:99], v[98:99], v[82:83]
    v_pk_mul_f32 v[100:101], v[100:101], v[84:85]
    v_pk_mul_f32 v[102:103], v[102:103], v[86:87]
    v_pk_mul_f32 v[104:105], v[104:105], v[88:89]
    v_pk_mul_f32 v[106:107], v[106:107], v[90:91]
    v_pk_mul_f32 v[108:109], v[108:109], v[92:93]
    v_pk_mul_f32 v[110:111], v[110:111], v[94:95]
    v_exp_f32 v96, v96
    v_exp_f32 v97, v97
    buffer_load_dwordx4 v[200:203], v4, s[12:15], s72 offen offset:1024 sc1
    v_exp_f32 v98, v98
    v_exp_f32 v99, v99
    v_exp_f32 v100, v100
    v_exp_f32 v101, v101
    v_exp_f32 v102, v102
    v_exp_f32 v103, v103
    v_exp_f32 v104, v104
    v_exp_f32 v105, v105
    v_exp_f32 v106, v106
    v_exp_f32 v107, v107
    v_exp_f32 v108, v108
    v_exp_f32 v109, v109
    buffer_load_dwordx4 v[204:207], v4, s[12:15], s72 offen offset:2048 sc1
    v_exp_f32 v110, v110
    v_exp_f32 v111, v111
    v_pk_add_f32 v[96:97], v[96:97], 1.0 op_sel_hi:[1,0]
    v_pk_add_f32 v[98:99], v[98:99], 1.0 op_sel_hi:[1,0]
    v_pk_add_f32 v[100:101], v[100:101], 1.0 op_sel_hi:[1,0]
    v_pk_add_f32 v[102:103], v[102:103], 1.0 op_sel_hi:[1,0]
    v_pk_add_f32 v[104:105], v[104:105], 1.0 op_sel_hi:[1,0]
    v_pk_add_f32 v[106:107], v[106:107], 1.0 op_sel_hi:[1,0]
    v_pk_add_f32 v[108:109], v[108:109], 1.0 op_sel_hi:[1,0]
    v_pk_add_f32 v[110:111], v[110:111], 1.0 op_sel_hi:[1,0]
    v_rcp_f32 v96, v96
    v_rcp_f32 v97, v97
    buffer_load_dwordx4 v[208:211], v4, s[12:15], s72 offen offset:3072 sc1
    v_rcp_f32 v98, v98
    v_rcp_f32 v99, v99
    v_rcp_f32 v100, v100
    v_rcp_f32 v101, v101
    v_rcp_f32 v102, v102
    v_rcp_f32 v103, v103
    v_rcp_f32 v104, v104
    v_rcp_f32 v105, v105
    v_rcp_f32 v106, v106
    v_rcp_f32 v107, v107
    v_rcp_f32 v108, v108
    v_rcp_f32 v109, v109
    s_sub_u32 s72, s71, 43
    s_cmp_ge_u32 s71, 43
    s_cselect_b32 s71, s72, s71
    s_lshl_b32 s72, s71, 10
    s_add_u32 s72, s72, s70
    s_add_u32 s71, s71, 4
    buffer_load_dwordx4 v[212:215], v4, s[12:15], s72 offen offset:0 sc1
    v_rcp_f32 v110, v110
    v_rcp_f32 v111, v111
    v_pk_mul_f32 v[80:81], v[80:81], v[96:97]
    v_pk_mul_f32 v[82:83], v[82:83], v[98:99]
    v_pk_mul_f32 v[84:85], v[84:85], v[100:101]
    v_pk_mul_f32 v[86:87], v[86:87], v[102:103]
    v_pk_mul_f32 v[88:89], v[88:89], v[104:105]
    v_pk_mul_f32 v[90:91], v[90:91], v[106:107]
    v_pk_mul_f32 v[92:93], v[92:93], v[108:109]
    v_pk_mul_f32 v[94:95], v[94:95], v[110:111]
    v_cvt_pk_bf16_f32 v104, v80, v81
    v_cvt_pk_bf16_f32 v105, v82, v83
    buffer_load_dwordx4 v[216:219], v4, s[12:15], s72 offen offset:1024 sc1
    v_cvt_pk_bf16_f32 v106, v84, v85
    v_cvt_pk_bf16_f32 v107, v86, v87
    v_cvt_pk_bf16_f32 v108, v88, v89
    v_cvt_pk_bf16_f32 v109, v90, v91
    v_cvt_pk_bf16_f32 v110, v92, v93
    v_cvt_pk_bf16_f32 v111, v94, v95
    buffer_store_dwordx4 v[104:107], v119, s[12:15], s80 offen sc1
    buffer_store_dwordx4 v[108:111], v119, s[12:15], s80 offen offset:2048 sc1
    s_waitcnt vmcnt(0)
    s_barrier
    s_cmp_eq_u32 s28, 0
    s_cbranch_scc0 L_fl_20
    s_add_u32 s56, s35, 512
    s_mov_b64 exec, 1
    buffer_store_dwordx2 v[184:185], v186, s[12:15], s56 offen
    s_mov_b64 exec, -1
L_fl_20:
    v_add_u32 v123, 0x10000, v113
    v_add_u32 v124, 0x10000, v114
    v_add_u32 v125, 0x20000, v113
    v_add_u32 v122, 0x20000, v114
    s_mul_i32 s56, s27, 48
    s_lshl_b32 s57, s75, 2
    s_add_u32 s78, s56, s57
    s_lshl_b32 s56, s28, 2
    s_add_u32 s78, s78, s56
    s_sub_u32 s81, s78, 172
    s_cmp_ge_u32 s78, 172
    s_cselect_b32 s78, s81, s78
    s_mul_i32 s79, s25, 176128
    s_add_u32 s79, s79, 0x1400000
    s_lshl_b32 s80, s28, 12
    v_mfma_f32_32x32x16_bf16 v[32:47], v[176:179], v[16:19], 0
    v_mfma_f32_32x32x16_bf16 v[32:47], v[180:183], v[20:23], v[32:47]
    v_mfma_f32_32x32x16_bf16 v[32:47], v[176:179], v[8:11], v[32:47]
    v_mfma_f32_32x32x16_bf16 v[32:47], v[180:183], v[12:15], v[32:47]
    s_add_u32 s56, s36, 512
    s_nop 0
    s_mov_b32 s69, 0
L_fw_21:
    buffer_load_dwordx2 v[6:7], v187, s[12:15], s56 offen sc1
    s_add_u32 s69, s69, 1
    s_cmp_gt_u32 s69, 200000
    s_cbranch_scc1 L_end
    s_waitcnt vmcnt(0)
    v_xor_b32 v6, s24, v6
    v_bitop3_b32 v6, v7, s24, v6 bitop3:0xbe
    v_cmp_ne_u32 vcc, 0, v6
    s_nop 4
    s_cbranch_vccnz L_fw_21
    s_nop 0
    s_sub_u32 s81, s78, 172
    s_cmp_ge_u32 s78, 172
    s_cselect_b32 s78, s81, s78
    s_lshl_b32 s81, s78, 10
    s_add_u32 s81, s81, s79
    s_add_u32 m0, s80, 0
    s_add_u32 s78, s78, 16
    buffer_load_dwordx4 v4, s[12:15], s81 offen offset:0  lds
    buffer_load_dwordx4 v4, s[12:15], s81 offen offset:1024  lds
    buffer_load_dwordx4 v4, s[12:15], s81 offen offset:2048  lds
    buffer_load_dwordx4 v4, s[12:15], s81 offen offset:3072  lds
    s_sub_u32 s81, s78, 172
    s_cmp_ge_u32 s78, 172
    s_cselect_b32 s78, s81, s78
    s_lshl_b32 s81, s78, 10
    s_add_u32 s81, s81, s79
    s_add_u32 m0, s80, 16384
    s_add_u32 s78, s78, 16
    buffer_load_dwordx4 v4, s[12:15], s81 offen offset:0  lds
    buffer_load_dwordx4 v4, s[12:15], s81 offen offset:1024  lds
    buffer_load_dwordx4 v4, s[12:15], s81 offen offset:2048  lds
    buffer_load_dwordx4 v4, s[12:15], s81 offen offset:3072  lds
    s_sub_u32 s81, s78, 172
    s_cmp_ge_u32 s78, 172
    s_cselect_b32 s78, s81, s78
    s_lshl_b32 s81, s78, 10
    s_add_u32 s81, s81, s79
    s_add_u32 m0, s80, 32768
    s_add_u32 s78, s78, 16
    buffer_load_dwordx4 v4, s[12:15], s81 offen offset:0  lds
    buffer_load_dwordx4 v4, s[12:15], s81 offen offset:1024  lds
    buffer_load_dwordx4 v4, s[12:15], s81 offen offset:2048  lds
    buffer_load_dwordx4 v4, s[12:15], s81 offen offset:3072  lds
    s_waitcnt vmcnt(8)
    s_barrier
    s_sub_u32 s81, s78, 172
    s_cmp_ge_u32 s78, 172
    s_cselect_b32 s78, s81, s78
    s_lshl_b32 s81, s78, 10
    s_add_u32 s81, s81, s79
    s_add_u32 m0, s80, 49152
    s_add_u32 s78, s78, 16
    buffer_load_dwordx4 v4, s[12:15], s81 offen offset:0  lds
    buffer_load_dwordx4 v4, s[12:15], s81 offen offset:1024  lds
    buffer_load_dwordx4 v4, s[12:15], s81 offen offset:2048  lds
    buffer_load_dwordx4 v4, s[12:15], s81 offen offset:3072  lds
    ds_read_b128 v[64:67], v113 offset:0
    ds_read_b128 v[68:71], v114 offset:0
    ds_read_b128 v[72:75], v113 offset:4096
    ds_read_b128 v[76:79], v114 offset:4096
    ds_read_b128 v[80:83], v113 offset:8192
    ds_read_b128 v[84:87], v114 offset:8192
    ds_read_b128 v[88:91], v113 offset:12288
    ds_read_b128 v[92:95], v114 offset:12288
    s_waitcnt vmcnt(8)
    s_barrier
    s_waitcnt lgkmcnt(7)
    v_mfma_f32_32x32x16_bf16 v[32:47], a[0:3], v[64:67], v[32:47]
    s_sub_u32 s81, s78, 172
    s_cmp_ge_u32 s78, 172
    s_cselect_b32 s78, s81, s78
    s_lshl_b32 s81, s78, 10
    s_add_u32 s81, s81, s79
    s_add_u32 m0, s80, 65536
    s_add_u32 s78, s78, 16
    buffer_load_dwordx4 v4, s[12:15], s81 offen offset:0  lds
    ds_read_b128 v[128:131], v113 offset:16384
    s_waitcnt lgkmcnt(7)
    v_mfma_f32_32x32x16_bf16 v[48:63], a[0:3], v[68:71], 0
    buffer_load_dwordx4 v4, s[12:15], s81 offen offset:1024  lds
    ds_read_b128 v[132:135], v114 offset:16384
    ds_read_b128 v[136:139], v113 offset:20480
    s_waitcnt lgkmcnt(8)
    v_mfma_f32_32x32x16_bf16 v[32:47], a[4:7], v[72:75], v[32:47]
    buffer_load_dwordx4 v4, s[12:15], s81 offen offset:2048  lds
    ds_read_b128 v[140:143], v114 offset:20480
    ds_read_b128 v[144:147], v113 offset:24576
    s_waitcnt lgkmcnt(9)
    v_mfma_f32_32x32x16_bf16 v[48:63], a[4:7], v[76:79], v[48:63]
    buffer_load_dwordx4 v4, s[12:15], s81 offen offset:3072  lds
    ds_read_b128 v[148:151], v114 offset:24576
    ds_read_b128 v[152:155], v113 offset:28672
    s_waitcnt lgkmcnt(10)
    v_mfma_f32_32x32x16_bf16 v[32:47], a[8:11], v[80:83], v[32:47]
    buffer_load_dwordx4 v[220:223], v4, s[12:15], s72 offen offset:2048 sc1
    ds_read_b128 v[156:159], v114 offset:28672
    s_waitcnt lgkmcnt(10)
    v_mfma_f32_32x32x16_bf16 v[48:63], a[8:11], v[84:87], v[48:63]
    buffer_load_dwordx4 v[224:227], v4, s[12:15], s72 offen offset:3072 sc1
    s_waitcnt lgkmcnt(9)
    v_mfma_f32_32x32x16_bf16 v[32:47], a[12:15], v[88:91], v[32:47]
    s_sub_u32 s72, s71, 43
    s_cmp_ge_u32 s71, 43
    s_cselect_b32 s71, s72, s71
    s_lshl_b32 s72, s71, 10
    s_add_u32 s72, s72, s70
    s_add_u32 s71, s71, 4
    buffer_load_dwordx4 v[228:231], v4, s[12:15], s72 offen offset:0 sc1
    s_waitcnt lgkmcnt(8)
    v_mfma_f32_32x32x16_bf16 v[48:63], a[12:15], v[92:95], v[48:63]
    buffer_load_dwordx4 v[232:235], v4, s[12:15], s72 offen offset:1024 sc1
    s_waitcnt vmcnt(12)
    s_barrier
    s_waitcnt lgkmcnt(7)
    v_mfma_f32_32x32x16_bf16 v[32:47], a[16:19], v[128:131], v[32:47]
    s_sub_u32 s81, s78, 172
    s_cmp_ge_u32 s78, 172
    s_cselect_b32 s78, s81, s78
    s_lshl_b32 s81, s78, 10
    s_add_u32 s81, s81, s79
    s_add_u32 m0, s80, 81920
    s_add_u32 s78, s78, 16
    buffer_load_dwordx4 v4, s[12:15], s81 offen offset:0  lds
    ds_read_b128 v[64:67], v113 offset:32768
    s_waitcnt lgkmcnt(7)
    v_mfma_f32_32x32x16_bf16 v[48:63], a[16:19], v[132:135], v[48:63]
    buffer_load_dwordx4 v4, s[12:15], s81 offen offset:1024  lds
    ds_read_b128 v[68:71], v114 offset:32768
    ds_read_b128 v[72:75], v113 offset:36864
    s_waitcnt lgkmcnt(8)
    v_mfma_f32_32x32x16_bf16 v[32:47], a[20:23], v[136:139], v[32:47]
    buffer_load_dwordx4 v4, s[12:15], s81 offen offset:2048  lds
    ds_read_b128 v[76:79], v114 offset:36864
    ds_read_b128 v[80:83], v113 offset:40960
    s_waitcnt lgkmcnt(9)
    v_mfma_f32_32x32x16_bf16 v[48:63], a[20:23], v[140:143], v[48:63]
    buffer_load_dwordx4 v4, s[12:15], s81 offen offset:3072  lds
    ds_read_b128 v[84:87], v114 offset:40960
    ds_read_b128 v[88:91], v113 offset:45056
    s_waitcnt lgkmcnt(10)
    v_mfma_f32_32x32x16_bf16 v[32:47], a[24:27], v[144:147], v[32:47]
    buffer_load_dwordx4 v[236:239], v4, s[12:15], s72 offen offset:2048 sc1
    ds_read_b128 v[92:95], v114 offset:45056
    s_waitcnt lgkmcnt(10)
    v_mfma_f32_32x32x16_bf16 v[48:63], a[24:27], v[148:151], v[48:63]
    buffer_load_dwordx4 v[240:243], v4, s[12:15], s72 offen offset:3072 sc1
    s_waitcnt lgkmcnt(9)
    v_mfma_f32_32x32x16_bf16 v[32:47], a[28:31], v[152:155], v[32:47]
    s_sub_u32 s72, s71, 43
    s_cmp_ge_u32 s71, 43
    s_cselect_b32 s71, s72, s71
    s_lshl_b32 s72, s71, 10
    s_add_u32 s72, s72, s70
    s_add_u32 s71, s71, 4
    buffer_load_dwordx4 v[244:247], v4, s[12:15], s72 offen offset:0 sc1
    s_waitcnt lgkmcnt(8)
    v_mfma_f32_32x32x16_bf16 v[48:63], a[28:31], v[156:159], v[48:63]
    buffer_load_dwordx4 v[248:251], v4, s[12:15], s72 offen offset:1024 sc1
    s_waitcnt vmcnt(16)
    s_barrier
    s_waitcnt lgkmcnt(7)
    v_mfma_f32_32x32x16_bf16 v[32:47], a[32:35], v[64:67], v[32:47]
    s_sub_u32 s81, s78, 172
    s_cmp_ge_u32 s78, 172
    s_cselect_b32 s78, s81, s78
    s_lshl_b32 s81, s78, 10
    s_add_u32 s81, s81, s79
    s_add_u32 m0, s80, 98304
    s_add_u32 s78, s78, 16
    buffer_load_dwordx4 v4, s[12:15], s81 offen offset:0  lds
    ds_read_b128 v[128:131], v113 offset:49152
    s_waitcnt lgkmcnt(7)
    v_mfma_f32_32x32x16_bf16 v[48:63], a[32:35], v[68:71], v[48:63]
    ds_read_b128 v[132:135], v114 offset:49152
    ds_read_b128 v[136:139], v113 offset:53248
    s_waitcnt lgkmcnt(8)
    v_mfma_f32_32x32x16_bf16 v[32:47], a[36:39], v[72:75], v[32:47]
    buffer_load_dwordx4 v4, s[12:15], s81 offen offset:1024  lds
    ds_read_b128 v[140:143], v114 offset:53248
    ds_read_b128 v[144:147], v113 offset:57344
    s_waitcnt lgkmcnt(9)
    v_mfma_f32_32x32x16_bf16 v[48:63], a[36:39], v[76:79], v[48:63]
    ds_read_b128 v[148:151], v114 offset:57344
    ds_read_b128 v[152:155], v113 offset:61440
    s_waitcnt lgkmcnt(10)
    v_mfma_f32_32x32x16_bf16 v[32:47], a[40:43], v[80:83], v[32:47]
    buffer_load_dwordx4 v4, s[12:15], s81 offen offset:2048  lds
    ds_read_b128 v[156:159], v114 offset:61440
    s_waitcnt lgkmcnt(10)
    v_mfma_f32_32x32x16_bf16 v[48:63], a[40:43], v[84:87], v[48:63]
    buffer_load_dwordx4 v4, s[12:15], s81 offen offset:3072  lds
    s_waitcnt lgkmcnt(9)
    v_mfma_f32_32x32x16_bf16 v[32:47], a[44:47], v[88:91], v[32:47]
    s_waitcnt lgkmcnt(8)
    v_mfma_f32_32x32x16_bf16 v[48:63], a[44:47], v[92:95], v[48:63]
    buffer_load_dwordx4 v[252:255], v4, s[12:15], s72 offen offset:2048 sc1
    s_waitcnt vmcnt(17)
    s_barrier
    s_waitcnt lgkmcnt(7)
    v_mfma_f32_32x32x16_bf16 v[32:47], a[48:51], v[128:131], v[32:47]
    s_sub_u32 s81, s78, 172
    s_cmp_ge_u32 s78, 172
    s_cselect_b32 s78, s81, s78
    s_lshl_b32 s81, s78, 10
    s_add_u32 s81, s81, s79
    s_add_u32 m0, s80, 114688
    s_add_u32 s78, s78, 16
    buffer_load_dwordx4 v4, s[12:15], s81 offen offset:0  lds
    ds_read_b128 v[64:67], v123 offset:0
    s_waitcnt lgkmcnt(7)
    v_mfma_f32_32x32x16_bf16 v[48:63], a[48:51], v[132:135], v[48:63]
    ds_read_b128 v[68:71], v124 offset:0
    ds_read_b128 v[72:75], v123 offset:4096
    s_waitcnt lgkmcnt(8)
    v_mfma_f32_32x32x16_bf16 v[32:47], a[52:55], v[136:139], v[32:47]
    buffer_load_dwordx4 v4, s[12:15], s81 offen offset:1024  lds
    ds_read_b128 v[76:79], v124 offset:4096
    ds_read_b128 v[80:83], v123 offset:8192
    s_waitcnt lgkmcnt(9)
    v_mfma_f32_32x32x16_bf16 v[48:63], a[52:55], v[140:143], v[48:63]
    ds_read_b128 v[84:87], v124 offset:8192
    ds_read_b128 v[88:91], v123 offset:12288
    s_waitcnt lgkmcnt(10)
    v_mfma_f32_32x32x16_bf16 v[32:47], a[56:59], v[144:147], v[32:47]
    buffer_load_dwordx4 v4, s[12:15], s81 offen offset:2048  lds
    ds_read_b128 v[92:95], v124 offset:12288
    s_waitcnt lgkmcnt(10)
    v_mfma_f32_32x32x16_bf16 v[48:63], a[56:59], v[148:151], v[48:63]
    s_waitcnt lgkmcnt(9)
    v_mfma_f32_32x32x16_bf16 v[32:47], a[60:63], v[152:155], v[32:47]
    buffer_load_dwordx4 v4, s[12:15], s81 offen offset:3072  lds
    s_waitcnt lgkmcnt(8)
    v_mfma_f32_32x32x16_bf16 v[48:63], a[60:63], v[156:159], v[48:63]
    s_waitcnt vmcnt(13)
    s_barrier
    s_waitcnt lgkmcnt(7)
    v_mfma_f32_32x32x16_bf16 v[32:47], a[64:67], v[64:67], v[32:47]
    s_sub_u32 s81, s78, 172
    s_cmp_ge_u32 s78, 172
    s_cselect_b32 s78, s81, s78
    s_lshl_b32 s81, s78, 10
    s_add_u32 s81, s81, s79
    s_add_u32 m0, s80, 131072
    s_add_u32 s78, s78, 16
    buffer_load_dwordx4 v4, s[12:15], s81 offen offset:0  lds
    ds_read_b128 v[128:131], v123 offset:16384
    s_waitcnt lgkmcnt(7)
    v_mfma_f32_32x32x16_bf16 v[48:63], a[64:67], v[68:71], v[48:63]
    ds_read_b128 v[132:135], v124 offset:16384
    ds_read_b128 v[136:139], v123 offset:20480
    s_waitcnt lgkmcnt(8)
    v_mfma_f32_32x32x16_bf16 v[32:47], a[68:71], v[72:75], v[32:47]
    buffer_load_dwordx4 v4, s[12:15], s81 offen offset:1024  lds
    ds_read_b128 v[140:143], v124 offset:20480
    ds_read_b128 v[144:147], v123 offset:24576
    s_waitcnt lgkmcnt(9)
    v_mfma_f32_32x32x16_bf16 v[48:63], a[68:71], v[76:79], v[48:63]
    ds_read_b128 v[148:151], v124 offset:24576
    ds_read_b128 v[152:155], v123 offset:28672
    s_waitcnt lgkmcnt(10)
    v_mfma_f32_32x32x16_bf16 v[32:47], a[72:75], v[80:83], v[32:47]
    buffer_load_dwordx4 v4, s[12:15], s81 offen offset:2048  lds
    ds_read_b128 v[156:159], v124 offset:28672
    s_waitcnt lgkmcnt(10)
    v_mfma_f32_32x32x16_bf16 v[48:63], a[72:75], v[84:87], v[48:63]
    s_waitcnt lgkmcnt(9)
    v_mfma_f32_32x32x16_bf16 v[32:47], a[76:79], v[88:91], v[32:47]
    buffer_load_dwordx4 v4, s[12:15], s81 offen offset:3072  lds
    s_waitcnt lgkmcnt(8)
    v_mfma_f32_32x32x16_bf16 v[48:63], a[76:79], v[92:95], v[48:63]
    s_waitcnt vmcnt(9)
    s_barrier
    s_waitcnt lgkmcnt(7)
    v_mfma_f32_32x32x16_bf16 v[32:47], a[80:83], v[128:131], v[32:47]
    s_sub_u32 s81, s78, 172
    s_cmp_ge_u32 s78, 172
    s_cselect_b32 s78, s81, s78
    s_lshl_b32 s81, s78, 10
    s_add_u32 s81, s81, s79
    s_add_u32 s82, s80, 147456
    s_sub_u32 s83, s82, 155648
    s_cmp_ge_u32 s28, 2
    s_cselect_b32 m0, s83, s82
    s_add_u32 s78, s78, 16
    buffer_load_dwordx4 v4, s[12:15], s81 offen offset:0  lds
    ds_read_b128 v[64:67], v123 offset:32768
    s_waitcnt lgkmcnt(7)
    v_mfma_f32_32x32x16_bf16 v[48:63], a[80:83], v[132:135], v[48:63]
    ds_read_b128 v[68:71], v124 offset:32768
    ds_read_b128 v[72:75], v123 offset:36864
    s_waitcnt lgkmcnt(8)
    v_mfma_f32_32x32x16_bf16 v[32:47], a[84:87], v[136:139], v[32:47]
    buffer_load_dwordx4 v4, s[12:15], s81 offen offset:1024  lds
    ds_read_b128 v[76:79], v124 offset:36864
    ds_read_b128 v[80:83], v123 offset:40960
    s_waitcnt lgkmcnt(9)
    v_mfma_f32_32x32x16_bf16 v[48:63], a[84:87], v[140:143], v[48:63]
    ds_read_b128 v[84:87], v124 offset:40960
    ds_read_b128 v[88:91], v123 offset:45056
    s_waitcnt lgkmcnt(10)
    v_mfma_f32_32x32x16_bf16 v[32:47], a[88:91], v[144:147], v[32:47]
    buffer_load_dwordx4 v4, s[12:15], s81 offen offset:2048  lds
    ds_read_b128 v[92:95], v124 offset:45056
    s_waitcnt lgkmcnt(10)
    v_mfma_f32_32x32x16_bf16 v[48:63], a[88:91], v[148:151], v[48:63]
    s_waitcnt lgkmcnt(9)
    v_mfma_f32_32x32x16_bf16 v[32:47], a[92:95], v[152:155], v[32:47]
    buffer_load_dwordx4 v4, s[12:15], s81 offen offset:3072  lds
    s_waitcnt lgkmcnt(8)
    v_mfma_f32_32x32x16_bf16 v[48:63], a[92:95], v[156:159], v[48:63]
    s_waitcnt vmcnt(8)
    s_barrier
    s_waitcnt lgkmcnt(7)
    v_mfma_f32_32x32x16_bf16 v[32:47], a[96:99], v[64:67], v[32:47]
    s_sub_u32 s81, s78, 172
    s_cmp_ge_u32 s78, 172
    s_cselect_b32 s78, s81, s78
    s_lshl_b32 s81, s78, 10
    s_add_u32 s81, s81, s79
    s_add_u32 m0, s80, 8192
    s_add_u32 s82, s78, 168
    s_sub_u32 s83, s82, 172
    s_cmp_ge_u32 s82, 172
    s_cselect_b32 s82, s83, s82
    s_cmp_eq_u32 s28, 3
    s_cselect_b32 s82, s82, s78
    s_lshl_b32 s81, s82, 10
    s_add_u32 s81, s81, s79
    s_cmp_eq_u32 s28, 3
    s_cselect_b32 s82, 4096, 0
    s_sub_u32 m0, m0, s82
    s_add_u32 s78, s78, 16
    buffer_load_dwordx4 v4, s[12:15], s81 offen offset:0  lds
    ds_read_b128 v[128:131], v123 offset:49152
    s_waitcnt lgkmcnt(7)
    v_mfma_f32_32x32x16_bf16 v[48:63], a[96:99], v[68:71], v[48:63]
    ds_read_b128 v[132:135], v124 offset:49152
    ds_read_b128 v[136:139], v123 offset:53248
    s_waitcnt lgkmcnt(8)
    v_mfma_f32_32x32x16_bf16 v[32:47], a[100:103], v[72:75], v[32:47]
    buffer_load_dwordx4 v4, s[12:15], s81 offen offset:1024  lds
    ds_read_b128 v[140:143], v124 offset:53248
    ds_read_b128 v[144:147], v123 offset:57344
    s_waitcnt lgkmcnt(9)
    v_mfma_f32_32x32x16_bf16 v[48:63], a[100:103], v[76:79], v[48:63]
    ds_read_b128 v[148:151], v124 offset:57344
    ds_read_b128 v[152:155], v123 offset:61440
    s_waitcnt lgkmcnt(10)
    v_mfma_f32_32x32x16_bf16 v[32:47], a[104:107], v[80:83], v[32:47]
    buffer_load_dwordx4 v4, s[12:15], s81 offen offset:2048  lds
    ds_read_b128 v[156:159], v124 offset:61440
    s_waitcnt lgkmcnt(10)
    v_mfma_f32_32x32x16_bf16 v[48:63], a[104:107], v[84:87], v[48:63]
    s_waitcnt lgkmcnt(9)
    v_mfma_f32_32x32x16_bf16 v[32:47], a[108:111], v[88:91], v[32:47]
    buffer_load_dwordx4 v4, s[12:15], s81 offen offset:3072  lds
    s_waitcnt lgkmcnt(8)
    v_mfma_f32_32x32x16_bf16 v[48:63], a[108:111], v[92:95], v[48:63]
    s_waitcnt vmcnt(8)
    s_barrier
    s_waitcnt lgkmcnt(7)
    v_mfma_f32_32x32x16_bf16 v[32:47], a[112:115], v[128:131], v[32:47]
    ds_read_b128 v[64:67], v125 offset:0
    s_waitcnt lgkmcnt(7)
    v_mfma_f32_32x32x16_bf16 v[48:63], a[112:115], v[132:135], v[48:63]
    ds_read_b128 v[68:71], v122 offset:0
    ds_read_b128 v[72:75], v125 offset:4096
    s_waitcnt lgkmcnt(8)
    v_mfma_f32_32x32x16_bf16 v[32:47], v[200:203], v[136:139], v[32:47]
    s_lshl_b32 s56, s28, 14
    s_add_u32 s57, s56, s31
    s_add_u32 s57, s57, s61
    v_lshrrev_b32 v7, 2, v1
    v_lshlrev_b32 v7, 10, v7
    v_and_b32 v6, 3, v1
    v_lshl_add_u32 v7, v6, 5, v7
    s_mov_b32 m0, 163584
    s_nop 0
    buffer_load_dword v7, s[20:23], s57 offen lds
    ds_read_b128 v[76:79], v122 offset:4096
    ds_read_b128 v[80:83], v125 offset:8192
    s_waitcnt lgkmcnt(9)
    v_mfma_f32_32x32x16_bf16 v[48:63], v[200:203], v[140:143], v[48:63]
    ds_read_b128 v[84:87], v122 offset:8192
    ds_read_b128 v[88:91], v125 offset:12288
    s_waitcnt lgkmcnt(10)
    v_mfma_f32_32x32x16_bf16 v[32:47], v[204:207], v[144:147], v[32:47]
    ds_read_b128 v[92:95], v122 offset:12288
    s_waitcnt lgkmcnt(10)
    v_mfma_f32_32x32x16_bf16 v[48:63], v[204:207], v[148:151], v[48:63]
    s_waitcnt lgkmcnt(9)
    v_mfma_f32_32x32x16_bf16 v[32:47], v[208:211], v[152:155], v[32:47]
    s_waitcnt lgkmcnt(8)
    v_mfma_f32_32x32x16_bf16 v[48:63], v[208:211], v[156:159], v[48:63]
    s_waitcnt vmcnt(5)
    s_barrier
    s_waitcnt lgkmcnt(7)
    v_mfma_f32_32x32x16_bf16 v[32:47], v[212:215], v[64:67], v[32:47]
    ds_read_b128 v[128:131], v125 offset:16384
    s_waitcnt lgkmcnt(7)
    v_mfma_f32_32x32x16_bf16 v[48:63], v[212:215], v[68:71], v[48:63]
    ds_read_b128 v[132:135], v122 offset:16384
    ds_read_b128 v[136:139], v125 offset:20480
    s_waitcnt lgkmcnt(8)
    v_mfma_f32_32x32x16_bf16 v[32:47], v[216:219], v[72:75], v[32:47]
    ds_read_b128 v[140:143], v122 offset:20480
    ds_read_b128 v[144:147], v113 offset:0
    s_waitcnt lgkmcnt(9)
    v_mfma_f32_32x32x16_bf16 v[48:63], v[216:219], v[76:79], v[48:63]
    ds_read_b128 v[148:151], v114 offset:0
    ds_read_b128 v[152:155], v113 offset:4096
    s_waitcnt lgkmcnt(10)
    v_mfma_f32_32x32x16_bf16 v[32:47], v[220:223], v[80:83], v[32:47]
    ds_read_b128 v[156:159], v114 offset:4096
    s_waitcnt lgkmcnt(10)
    v_mfma_f32_32x32x16_bf16 v[48:63], v[220:223], v[84:87], v[48:63]
    s_waitcnt lgkmcnt(9)
    v_mfma_f32_32x32x16_bf16 v[32:47], v[224:227], v[88:91], v[32:47]
    s_waitcnt lgkmcnt(8)
    v_mfma_f32_32x32x16_bf16 v[48:63], v[224:227], v[92:95], v[48:63]
    s_waitcnt vmcnt(1)
    s_barrier
    s_waitcnt lgkmcnt(7)
    v_mfma_f32_32x32x16_bf16 v[32:47], v[228:231], v[128:131], v[32:47]
    ds_read_b128 v[64:67], v113 offset:8192
    s_waitcnt lgkmcnt(7)
    v_mfma_f32_32x32x16_bf16 v[48:63], v[228:231], v[132:135], v[48:63]
    ds_read_b128 v[68:71], v114 offset:8192
    s_waitcnt lgkmcnt(7)
    v_mfma_f32_32x32x16_bf16 v[32:47], v[232:235], v[136:139], v[32:47]
    ds_read_b128 v[72:75], v113 offset:12288
    ds_read_b128 v[76:79], v114 offset:12288
    s_waitcnt lgkmcnt(8)
    v_mfma_f32_32x32x16_bf16 v[48:63], v[232:235], v[140:143], v[48:63]
    ds_read_b128 v[80:83], v113 offset:16384
    s_waitcnt lgkmcnt(8)
    v_mfma_f32_32x32x16_bf16 v[32:47], v[236:239], v[144:147], v[32:47]
    ds_read_b128 v[84:87], v114 offset:16384
    s_waitcnt lgkmcnt(8)
    v_mfma_f32_32x32x16_bf16 v[48:63], v[236:239], v[148:151], v[48:63]
    s_waitcnt lgkmcnt(7)
    v_mfma_f32_32x32x16_bf16 v[32:47], v[240:243], v[152:155], v[32:47]
    s_waitcnt lgkmcnt(6)
    v_mfma_f32_32x32x16_bf16 v[48:63], v[240:243], v[156:159], v[48:63]
    s_waitcnt lgkmcnt(5)
    v_mfma_f32_32x32x16_bf16 v[32:47], v[244:247], v[64:67], v[32:47]
    s_waitcnt lgkmcnt(4)
    v_mfma_f32_32x32x16_bf16 v[48:63], v[244:247], v[68:71], v[48:63]
    s_waitcnt lgkmcnt(3)
    v_mfma_f32_32x32x16_bf16 v[32:47], v[248:251], v[72:75], v[32:47]
    s_waitcnt lgkmcnt(2)
    v_mfma_f32_32x32x16_bf16 v[48:63], v[248:251], v[76:79], v[48:63]
    s_waitcnt lgkmcnt(1)
    v_mfma_f32_32x32x16_bf16 v[32:47], v[252:255], v[80:83], v[32:47]
    s_waitcnt lgkmcnt(0)
    v_mfma_f32_32x32x16_bf16 v[48:63], v[252:255], v[84:87], v[48:63]
    s_barrier
    s_nop 10
    ds_write_b128 v115, v[48:51] offset:0
    ds_write_b128 v115, v[52:55] offset:1024
    ds_write_b128 v115, v[56:59] offset:2048
    ds_write_b128 v115, v[60:63] offset:3072
    s_waitcnt lgkmcnt(0)
    s_barrier
    ds_read_b128 v[48:51], v116 offset:0
    ds_read_b128 v[52:55], v116 offset:1024
    ds_read_b128 v[56:59], v116 offset:2048
    ds_read_b128 v[60:63], v116 offset:3072
    s_waitcnt lgkmcnt(3)
    v_pk_add_f32 v[32:33], v[32:33], v[48:49]
    v_pk_add_f32 v[34:35], v[34:35], v[50:51]
    s_waitcnt lgkmcnt(2)
    v_pk_add_f32 v[36:37], v[36:37], v[52:53]
    v_pk_add_f32 v[38:39], v[38:39], v[54:55]
    s_waitcnt lgkmcnt(1)
    v_pk_add_f32 v[40:41], v[40:41], v[56:57]
    v_pk_add_f32 v[42:43], v[42:43], v[58:59]
    s_waitcnt lgkmcnt(0)
    v_pk_add_f32 v[44:45], v[44:45], v[60:61]
    v_pk_add_f32 v[46:47], v[46:47], v[62:63]
    v_cvt_pk_bf16_f32 v64, v32, v33
    v_cvt_pk_bf16_f32 v65, v34, v35
    v_cvt_pk_bf16_f32 v66, v36, v37
    v_cvt_pk_bf16_f32 v67, v38, v39
    v_cvt_pk_bf16_f32 v68, v40, v41
    v_cvt_pk_bf16_f32 v69, v42, v43
    v_cvt_pk_bf16_f32 v70, v44, v45
    v_cvt_pk_bf16_f32 v71, v46, v47
    s_lshl_b32 s56, s62, 5
    v_add_u32 v5, s56, v2
    v_lshlrev_b32 v5, 10, v5
    v_lshl_add_u32 v5, v3, 4, v5
    v_permlane32_swap_b32 v64, v66
    v_permlane32_swap_b32 v65, v67
    v_permlane32_swap_b32 v68, v70
    v_permlane32_swap_b32 v69, v71
    buffer_store_dwordx4 v[64:67], v5, s[20:23], s88 offen
    buffer_store_dwordx4 v[68:71], v5, s[20:23], s88 offen offset:32
    s_endpgm
L_code_end:
L_slow_tail:
    s_waitcnt vmcnt(7)
    v_xor_b32 v5, s24, v65
    v_bitop3_b32 v5, v67, s24, v5 bitop3:0xbe
    s_waitcnt vmcnt(6)
    v_bitop3_b32 v5, v69, s24, v5 bitop3:0xbe
    v_bitop3_b32 v5, v71, s24, v5 bitop3:0xbe
    s_waitcnt vmcnt(5)
    v_bitop3_b32 v5, v73, s24, v5 bitop3:0xbe
    v_bitop3_b32 v5, v75, s24, v5 bitop3:0xbe
    s_waitcnt vmcnt(4)
    v_bitop3_b32 v5, v77, s24, v5 bitop3:0xbe
    v_bitop3_b32 v5, v79, s24, v5 bitop3:0xbe
    s_waitcnt vmcnt(3)
    v_bitop3_b32 v5, v81, s24, v5 bitop3:0xbe
    v_bitop3_b32 v5, v83, s24, v5 bitop3:0xbe
    s_waitcnt vmcnt(2)
    v_bitop3_b32 v5, v85, s24, v5 bitop3:0xbe
    v_bitop3_b32 v5, v87, s24, v5 bitop3:0xbe
    s_waitcnt vmcnt(1)
    v_bitop3_b32 v5, v89, s24, v5 bitop3:0xbe
    v_bitop3_b32 v5, v91, s24, v5 bitop3:0xbe
    s_waitcnt vmcnt(0)
    v_bitop3_b32 v5, v93, s24, v5 bitop3:0xbe
    v_bitop3_b32 v5, v95, s24, v5 bitop3:0xbe
    v_cmp_ne_u32 vcc, 0, v5
    s_nop 4
    s_cbranch_vccz L_fkv_22_ok
    s_mov_b32 s69, 0
L_fkv_22:
    buffer_load_dwordx4 v[64:67], v24, s[12:15], s86 offen offset:0 sc1
    buffer_load_dwordx4 v[68:71], v24, s[12:15], s86 offen offset:1024 sc1
    buffer_load_dwordx4 v[72:75], v24, s[12:15], s86 offen offset:2048 sc1
    buffer_load_dwordx4 v[76:79], v24, s[12:15], s86 offen offset:3072 sc1
    buffer_load_dwordx4 v[80:83], v24, s[12:15], s87 offen offset:0 sc1
    buffer_load_dwordx4 v[84:87], v24, s[12:15], s87 offen offset:1024 sc1
    buffer_load_dwordx4 v[88:91], v24, s[12:15], s87 offen offset:2048 sc1
    buffer_load_dwordx4 v[92:95], v24, s[12:15], s87 offen offset:3072 sc1
    s_add_u32 s69, s69, 1
    s_cmp_gt_u32 s69, 200000
    s_cbranch_scc1 L_end
    s_waitcnt vmcnt(0)
    v_xor_b32 v5, s24, v65
    v_bitop3_b32 v5, v67, s24, v5 bitop3:0xbe
    v_bitop3_b32 v5, v69, s24, v5 bitop3:0xbe
    v_bitop3_b32 v5, v71, s24, v5 bitop3:0xbe
    v_bitop3_b32 v5, v73, s24, v5 bitop3:0xbe
    v_bitop3_b32 v5, v75, s24, v5 bitop3:0xbe
    v_bitop3_b32 v5, v77, s24, v5 bitop3:0xbe
    v_bitop3_b32 v5, v79, s24, v5 bitop3:0xbe
    v_bitop3_b32 v5, v81, s24, v5 bitop3:0xbe
    v_bitop3_b32 v5, v83, s24, v5 bitop3:0xbe
    v_bitop3_b32 v5, v85, s24, v5 bitop3:0xbe
    v_bitop3_b32 v5, v87, s24, v5 bitop3:0xbe
    v_bitop3_b32 v5, v89, s24, v5 bitop3:0xbe
    v_bitop3_b32 v5, v91, s24, v5 bitop3:0xbe
    v_bitop3_b32 v5, v93, s24, v5 bitop3:0xbe
    v_bitop3_b32 v5, v95, s24, v5 bitop3:0xbe
    v_cmp_ne_u32 vcc, 0, v5
    s_nop 4
    s_cbranch_vccnz L_fkv_22
L_fkv_22_ok:
    s_nop 1
    v_mov_b32 v96, v64
    v_mov_b32 v97, v66
    v_mov_b32 v98, v68
    v_mov_b32 v99, v70
    v_mov_b32 v100, v72
    v_mov_b32 v101, v74
    v_mov_b32 v102, v76
    v_mov_b32 v103, v78
    v_mov_b32 v104, v80
    v_mov_b32 v105, v82
    v_mov_b32 v106, v84
    v_mov_b32 v107, v86
    v_mov_b32 v108, v88
    v_mov_b32 v109, v90
    v_mov_b32 v110, v92
    v_mov_b32 v111, v94
    v_mfma_f32_32x32x16_bf16 v[32:47], v[96:99], v[8:11], 0
    v_mfma_f32_32x32x16_bf16 v[32:47], v[100:103], v[12:15], v[32:47]
    v_mfma_f32_32x32x16_bf16 v[48:63], v[104:107], v[16:19], 0
    v_mfma_f32_32x32x16_bf16 v[48:63], v[108:111], v[20:23], v[48:63]
    s_lshl_b32 s56, s63, 5
    v_add_u32 v5, s56, v2
    v_lshlrev_b32 v5, 4, v5
    v_lshl_add_u32 v6, v3, 10, v5
    s_lshl_b32 s56, s26, 2
    s_lshl_b32 s57, s62, 1
    s_add_u32 s56, s56, s57
    s_lshl_b32 s56, s56, 11
    s_add_u32 s56, s56, s38
    s_add_u32 s91, s56, 0xc00000
    v_add_f32 v40, 0x358637bd, v40
    v_rcp_f32 v40, v40
    v_add_f32 v56, 0x358637bd, v56
    v_rcp_f32 v56, v56
    v_pk_mul_f32 v[32:33], v[32:33], v[40:41] op_sel_hi:[1,0]
    v_pk_mul_f32 v[34:35], v[34:35], v[40:41] op_sel_hi:[1,0]
    v_pk_mul_f32 v[36:37], v[36:37], v[40:41] op_sel_hi:[1,0]
    v_pk_mul_f32 v[38:39], v[38:39], v[40:41] op_sel_hi:[1,0]
    v_cvt_pk_bf16_f32 v64, v32, v33
    v_cvt_pk_bf16_f32 v65, v34, v35
    v_cvt_pk_bf16_f32 v66, v36, v37
    v_cvt_pk_bf16_f32 v67, v38, v39
    v_pk_mul_f32 v[48:49], v[48:49], v[56:57] op_sel_hi:[1,0]
    v_pk_mul_f32 v[50:51], v[50:51], v[56:57] op_sel_hi:[1,0]
    v_pk_mul_f32 v[52:53], v[52:53], v[56:57] op_sel_hi:[1,0]
    v_pk_mul_f32 v[54:55], v[54:55], v[56:57] op_sel_hi:[1,0]
    v_cvt_pk_bf16_f32 v68, v48, v49
    v_cvt_pk_bf16_f32 v69, v50, v51
    v_cvt_pk_bf16_f32 v70, v52, v53
    v_cvt_pk_bf16_f32 v71, v54, v55
    buffer_store_dwordx4 v[64:67], v6, s[12:15], s91 offen sc1
    buffer_store_dwordx4 v[68:71], v6, s[12:15], s91 offen offset:2048 sc1
    s_lshl_b32 s56, s62, 1
    s_lshl_b32 s57, s27, 3
    s_sub_u32 s56, s56, s57
    s_and_b32 s56, s56, 31
    s_lshl_b32 s56, s56, 11
    v_add_u32 v5, s56, v6
    ds_write_b128 v5, v[64:67]
    ds_write_b128 v5, v[68:71] offset:2048
    s_and_b32 s71, s71, 15
    s_lshl_b32 s72, s71, 10
    s_add_u32 s72, s72, s70
    s_add_u32 s71, s71, 4
    buffer_load_dwordx4 a[224:227], v4, s[12:15], s72 offen offset:0 sc1
    buffer_load_dwordx4 a[228:231], v4, s[12:15], s72 offen offset:1024 sc1
    buffer_load_dwordx4 a[232:235], v4, s[12:15], s72 offen offset:2048 sc1
    buffer_load_dwordx4 a[236:239], v4, s[12:15], s72 offen offset:3072 sc1
    s_and_b32 s71, s71, 15
    s_lshl_b32 s72, s71, 10
    s_add_u32 s72, s72, s70
    s_add_u32 s71, s71, 4
    buffer_load_dwordx4 a[240:243], v4, s[12:15], s72 offen offset:0 sc1
    buffer_load_dwordx4 a[244:247], v4, s[12:15], s72 offen offset:1024 sc1
    buffer_load_dwordx4 a[248:251], v4, s[12:15], s72 offen offset:2048 sc1
    buffer_load_dwordx4 a[252:255], v4, s[12:15], s72 offen offset:3072 sc1
    v_mov_b32 v96, v120
    v_mov_b32 v97, v121
    v_mov_b32 v98, v122
    v_mov_b32 v99, v123
    v_mov_b32 v100, v124
    v_mov_b32 v101, v125
    v_mov_b32 v102, v126
    v_mov_b32 v103, v127
    s_lshl_b32 s56, s62, 5
    v_add_u32 v5, s56, v2
    v_lshlrev_b32 v6, 4, v5
    v_lshl_add_u32 v112, v3, 10, v6
    v_lshlrev_b32 v6, 4, v2
    v_lshl_add_u32 v6, v3, 10, v6
    s_lshl_b32 s56, s62, 11
    v_add_u32 v6, s56, v6
    s_lshl_b32 s56, s62, 9
    v_add_u32 v113, s56, v6
    s_xor_b32 s56, s56, 512
    v_add_u32 v114, s56, v6
    s_lshl_b32 s56, s28, 12
    s_add_u32 s56, s56, 139264
    v_add_u32 v115, s56, v4
    s_xor_b32 s57, s28, 2
    s_lshl_b32 s57, s57, 12
    s_add_u32 s57, s57, 139264
    v_add_u32 v116, s57, v4
    v_lshlrev_b32 v6, 3, v5
    v_lshl_add_u32 v6, v3, 12, v6
    v_add_u32 v117, 131072, v6
    s_mov_b32 s88, s89
    v_lshlrev_b32 v188, 3, v2
    v_lshlrev_b32 v5, 2, v3
    v_sub_u32 v5, v2, v5
    v_mov_b32 v6, 0x3f80
    v_mov_b32 v7, 0x3f800000
    v_cmp_eq_u32 vcc, 0, v5
    s_nop 1
    v_cndmask_b32 v176, 0, v6, vcc
    v_cmp_eq_u32 vcc, 1, v5
    s_nop 1
    v_cndmask_b32 v176, v176, v7, vcc
    v_cmp_eq_u32 vcc, 2, v5
    s_nop 1
    v_cndmask_b32 v177, 0, v6, vcc
    v_cmp_eq_u32 vcc, 3, v5
    s_nop 1
    v_cndmask_b32 v177, v177, v7, vcc
    v_cmp_eq_u32 vcc, 8, v5
    s_nop 1
    v_cndmask_b32 v178, 0, v6, vcc
    v_cmp_eq_u32 vcc, 9, v5
    s_nop 1
    v_cndmask_b32 v178, v178, v7, vcc
    v_cmp_eq_u32 vcc, 10, v5
    s_nop 1
    v_cndmask_b32 v179, 0, v6, vcc
    v_cmp_eq_u32 vcc, 11, v5
    s_nop 1
    v_cndmask_b32 v179, v179, v7, vcc
    v_cmp_eq_u32 vcc, 16, v5
    s_nop 1
    v_cndmask_b32 v180, 0, v6, vcc
    v_cmp_eq_u32 vcc, 17, v5
    s_nop 1
    v_cndmask_b32 v180, v180, v7, vcc
    v_cmp_eq_u32 vcc, 18, v5
    s_nop 1
    v_cndmask_b32 v181, 0, v6, vcc
    v_cmp_eq_u32 vcc, 19, v5
    s_nop 1
    v_cndmask_b32 v181, v181, v7, vcc
    v_cmp_eq_u32 vcc, 24, v5
    s_nop 1
    v_cndmask_b32 v182, 0, v6, vcc
    v_cmp_eq_u32 vcc, 25, v5
    s_nop 1
    v_cndmask_b32 v182, v182, v7, vcc
    v_cmp_eq_u32 vcc, 26, v5
    s_nop 1
    v_cndmask_b32 v183, 0, v6, vcc
    v_cmp_eq_u32 vcc, 27, v5
    s_nop 1
    v_cndmask_b32 v183, v183, v7, vcc
    s_waitcnt vmcnt(8)
    s_waitcnt lgkmcnt(0)
    s_barrier
    s_cmp_eq_u32 s28, 0
    s_cbranch_scc0 L_fl_23
    s_add_u32 s56, s35, 0
    s_mov_b64 exec, 1
    buffer_store_dwordx2 v[184:185], v186, s[12:15], s56 offen sc1
    s_mov_b64 exec, -1
L_fl_23:
    s_lshl_b32 s70, s26, 2
    s_add_u32 s70, s70, s28
    s_mul_i32 s70, s70, 16
    s_add_u32 s70, s70, 1024
    s_lshl_b32 s70, s70, 10
    s_mul_i32 s71, s27, 4
    s_add_u32 s71, s71, 0
    s_and_b32 s71, s71, 15
    s_lshl_b32 s72, s71, 10
    s_add_u32 s72, s72, s70
    s_add_u32 s71, s71, 4
    buffer_load_dwordx4 a[0:3], v4, s[12:15], s72 offen offset:0 sc1
    buffer_load_dwordx4 a[4:7], v4, s[12:15], s72 offen offset:1024 sc1
    buffer_load_dwordx4 a[8:11], v4, s[12:15], s72 offen offset:2048 sc1
    buffer_load_dwordx4 a[12:15], v4, s[12:15], s72 offen offset:3072 sc1
    s_add_u32 s90, s38, 0xc00000
    s_mov_b32 s91, s37
    s_add_u32 s92, s39, 0
    v_mfma_f32_32x32x16_bf16 v[32:47], v[176:179], v[96:99], 0
    v_mfma_f32_32x32x16_bf16 v[32:47], v[180:183], v[100:103], v[32:47]
    v_mov_b32 v172, 0x3f803f80
    v_mov_b32 v173, 0x3f803f80
    v_mov_b32 v174, 0x3f803f80
    v_mov_b32 v175, 0x3f803f80
    s_nop 0
    s_nop 0
    v_mfma_f32_32x32x16_bf16 v[96:111], a[192:195], v[172:175], 0
    v_mfma_f32_32x32x16_bf16 v[96:111], a[196:199], v[172:175], v[96:111]
    v_mfma_f32_32x32x16_bf16 v[96:111], a[200:203], v[172:175], v[96:111]
    v_mfma_f32_32x32x16_bf16 v[96:111], a[204:207], v[172:175], v[96:111]
    v_mfma_f32_32x32x16_bf16 v[96:111], a[208:211], v[172:175], v[96:111]
    v_mfma_f32_32x32x16_bf16 v[96:111], a[212:215], v[172:175], v[96:111]
    v_mfma_f32_32x32x16_bf16 v[96:111], a[216:219], v[172:175], v[96:111]
    v_mfma_f32_32x32x16_bf16 v[96:111], a[220:223], v[172:175], v[96:111]
    s_waitcnt vmcnt(11)
    v_mfma_f32_32x32x16_bf16 v[96:111], a[224:227], v[172:175], v[96:111]
    s_waitcnt vmcnt(10)
    v_mfma_f32_32x32x16_bf16 v[96:111], a[228:231], v[172:175], v[96:111]
    s_waitcnt vmcnt(9)
    v_mfma_f32_32x32x16_bf16 v[96:111], a[232:235], v[172:175], v[96:111]
    s_waitcnt vmcnt(8)
    v_mfma_f32_32x32x16_bf16 v[96:111], a[236:239], v[172:175], v[96:111]
    s_waitcnt vmcnt(7)
    v_mfma_f32_32x32x16_bf16 v[96:111], a[240:243], v[172:175], v[96:111]
    s_waitcnt vmcnt(6)
    v_mfma_f32_32x32x16_bf16 v[96:111], a[244:247], v[172:175], v[96:111]
    s_waitcnt vmcnt(5)
    v_mfma_f32_32x32x16_bf16 v[96:111], a[248:251], v[172:175], v[96:111]
    s_waitcnt vmcnt(4)
    v_mfma_f32_32x32x16_bf16 v[96:111], a[252:255], v[172:175], v[96:111]
    s_lshl_b32 s56, s28, 7
    s_add_u32 s56, s56, 155648
    v_lshl_add_u32 v5, v3, 6, s56
    s_mov_b32 s56, 1
    s_mov_b32 s57, 1
    s_mov_b64 exec, s[56:57]
    s_nop 5
    ds_write_b128 v5, v[96:99] offset:0
    ds_write_b128 v5, v[100:103] offset:16
    ds_write_b128 v5, v[104:107] offset:32
    ds_write_b128 v5, v[108:111] offset:48
    s_mov_b64 exec, -1
    s_add_u32 s56, s36, 0
    s_nop 0
    s_mov_b32 s69, 0
L_fw_24:
    buffer_load_dwordx2 v[6:7], v187, s[12:15], s56 offen sc1
    s_add_u32 s69, s69, 1
    s_cmp_gt_u32 s69, 200000
    s_cbranch_scc1 L_end
    s_waitcnt vmcnt(0)
    v_xor_b32 v6, s24, v6
    v_bitop3_b32 v6, v7, s24, v6 bitop3:0xbe
    v_cmp_ne_u32 vcc, 0, v6
    s_nop 4
    s_cbranch_vccnz L_fw_24
    s_nop 0
    s_add_u32 s56, s90, s91
    s_cmp_eq_u32 s40, 0
    s_cselect_b64 exec, 0, -1
    s_mov_b32 m0, s92
    s_nop 0
    buffer_load_dwordx4 v4, s[12:15], s56 offen offset:0 sc1 lds
    buffer_load_dwordx4 v4, s[12:15], s56 offen offset:1024 sc1 lds
    buffer_load_dwordx4 v4, s[12:15], s56 offen offset:2048 sc1 lds
    buffer_load_dwordx4 v4, s[12:15], s56 offen offset:3072 sc1 lds
    s_mov_b64 exec, -1
    s_add_u32 s91, s91, 16384
    s_and_b32 s91, s91, 0xffff
    s_add_u32 s92, s92, 16384
    s_add_u32 s56, s90, s91
    s_cmp_eq_u32 s40, 1
    s_cselect_b64 exec, 0, -1
    s_mov_b32 m0, s92
    s_nop 0
    buffer_load_dwordx4 v4, s[12:15], s56 offen offset:0 sc1 lds
    buffer_load_dwordx4 v4, s[12:15], s56 offen offset:1024 sc1 lds
    buffer_load_dwordx4 v4, s[12:15], s56 offen offset:2048 sc1 lds
    buffer_load_dwordx4 v4, s[12:15], s56 offen offset:3072 sc1 lds
    s_mov_b64 exec, -1
    s_add_u32 s91, s91, 16384
    s_and_b32 s91, s91, 0xffff
    s_add_u32 s92, s92, 16384
    s_add_u32 s56, s90, s91
    s_cmp_eq_u32 s40, 2
    s_cselect_b64 exec, 0, -1
    s_mov_b32 m0, s92
    s_nop 0
    buffer_load_dwordx4 v4, s[12:15], s56 offen offset:0 sc1 lds
    buffer_load_dwordx4 v4, s[12:15], s56 offen offset:1024 sc1 lds
    buffer_load_dwordx4 v4, s[12:15], s56 offen offset:2048 sc1 lds
    buffer_load_dwordx4 v4, s[12:15], s56 offen offset:3072 sc1 lds
    s_mov_b64 exec, -1
    s_add_u32 s91, s91, 16384
    s_and_b32 s91, s91, 0xffff
    s_add_u32 s92, s92, 16384
    s_add_u32 s56, s90, s91
    s_cmp_eq_u32 s40, 3
    s_cselect_b64 exec, 0, -1
    s_mov_b32 m0, s92
    s_nop 0
    buffer_load_dwordx4 v4, s[12:15], s56 offen offset:0 sc1 lds
    buffer_load_dwordx4 v4, s[12:15], s56 offen offset:1024 sc1 lds
    buffer_load_dwordx4 v4, s[12:15], s56 offen offset:2048 sc1 lds
    buffer_load_dwordx4 v4, s[12:15], s56 offen offset:3072 sc1 lds
    s_mov_b64 exec, -1
    s_waitcnt vmcnt(12)
    s_waitcnt lgkmcnt(0)
    s_barrier
    s_xor_b32 s56, s28, 2
    s_lshl_b32 s56, s56, 7
    s_add_u32 s56, s56, 155648
    v_lshl_add_u32 v5, v3, 6, s56
    ds_read_b128 v[160:163], v5 offset:0
    ds_read_b128 v[164:167], v5 offset:16
    ds_read_b128 v[168:171], v5 offset:32
    ds_read_b128 v[172:175], v5 offset:48
    s_waitcnt lgkmcnt(3)
    v_add_f32 v96, v96, v160
    v_add_f32 v97, v97, v161
    v_add_f32 v98, v98, v162
    v_add_f32 v99, v99, v163
    s_waitcnt lgkmcnt(2)
    v_add_f32 v100, v100, v164
    v_add_f32 v101, v101, v165
    v_add_f32 v102, v102, v166
    v_add_f32 v103, v103, v167
    s_waitcnt lgkmcnt(1)
    v_add_f32 v104, v104, v168
    v_add_f32 v105, v105, v169
    v_add_f32 v106, v106, v170
    v_add_f32 v107, v107, v171
    s_waitcnt lgkmcnt(0)
    v_add_f32 v108, v108, v172
    v_add_f32 v109, v109, v173
    v_add_f32 v110, v110, v174
    v_add_f32 v111, v111, v175
    ds_read_b128 v[68:71], v114 offset:0
    ds_read_b128 v[64:67], v113 offset:0
    ds_read_b128 v[76:79], v114 offset:4096
    ds_read_b128 v[72:75], v113 offset:4096
    ds_read_b128 v[84:87], v114 offset:8192
    ds_read_b128 v[80:83], v113 offset:8192
    ds_read_b128 v[92:95], v114 offset:12288
    ds_read_b128 v[88:91], v113 offset:12288
    s_waitcnt vmcnt(8)
    s_barrier
    s_waitcnt lgkmcnt(7)
    v_mfma_f32_32x32x16_bf16 v[48:63], a[128:131], v[68:71], 0
    s_and_b32 s71, s71, 15
    s_lshl_b32 s72, s71, 10
    s_add_u32 s72, s72, s70
    s_add_u32 s71, s71, 4
    buffer_load_dwordx4 a[16:19], v4, s[12:15], s72 offen offset:0 sc1
    ds_read_b128 v[132:135], v114 offset:16384
    s_waitcnt lgkmcnt(7)
    v_mfma_f32_32x32x16_bf16 v[32:47], a[128:131], v[64:67], v[32:47]
    ds_read_b128 v[128:131], v113 offset:16384
    ds_read_b128 v[140:143], v114 offset:20480
    s_waitcnt lgkmcnt(8)
    v_mfma_f32_32x32x16_bf16 v[48:63], a[132:135], v[76:79], v[48:63]
    buffer_load_dwordx4 a[20:23], v4, s[12:15], s72 offen offset:1024 sc1
    ds_read_b128 v[136:139], v113 offset:20480
    ds_read_b128 v[148:151], v114 offset:24576
    s_waitcnt lgkmcnt(9)
    v_mfma_f32_32x32x16_bf16 v[32:47], a[132:135], v[72:75], v[32:47]
    ds_read_b128 v[144:147], v113 offset:24576
    ds_read_b128 v[156:159], v114 offset:28672
    s_waitcnt lgkmcnt(10)
    v_mfma_f32_32x32x16_bf16 v[48:63], a[136:139], v[84:87], v[48:63]
    buffer_load_dwordx4 a[24:27], v4, s[12:15], s72 offen offset:2048 sc1
    ds_read_b128 v[152:155], v113 offset:28672
    s_waitcnt lgkmcnt(10)
    v_mfma_f32_32x32x16_bf16 v[32:47], a[136:139], v[80:83], v[32:47]
    s_waitcnt lgkmcnt(9)
    v_mfma_f32_32x32x16_bf16 v[48:63], a[140:143], v[92:95], v[48:63]
    buffer_load_dwordx4 a[28:31], v4, s[12:15], s72 offen offset:3072 sc1
    s_waitcnt lgkmcnt(8)
    v_mfma_f32_32x32x16_bf16 v[32:47], a[140:143], v[88:91], v[32:47]
    s_waitcnt vmcnt(8)
    s_barrier
    s_waitcnt lgkmcnt(7)
    v_mfma_f32_32x32x16_bf16 v[48:63], a[144:147], v[132:135], v[48:63]
    s_and_b32 s71, s71, 15
    s_lshl_b32 s72, s71, 10
    s_add_u32 s72, s72, s70
    s_add_u32 s71, s71, 4
    buffer_load_dwordx4 a[32:35], v4, s[12:15], s72 offen offset:0 sc1
    ds_read_b128 v[68:71], v114 offset:32768
    s_waitcnt lgkmcnt(7)
    v_mfma_f32_32x32x16_bf16 v[32:47], a[144:147], v[128:131], v[32:47]
    ds_read_b128 v[64:67], v113 offset:32768
    ds_read_b128 v[76:79], v114 offset:36864
    s_waitcnt lgkmcnt(8)
    v_mfma_f32_32x32x16_bf16 v[48:63], a[148:151], v[140:143], v[48:63]
    buffer_load_dwordx4 a[36:39], v4, s[12:15], s72 offen offset:1024 sc1
    ds_read_b128 v[72:75], v113 offset:36864
    ds_read_b128 v[84:87], v114 offset:40960
    s_waitcnt lgkmcnt(9)
    v_mfma_f32_32x32x16_bf16 v[32:47], a[148:151], v[136:139], v[32:47]
    ds_read_b128 v[80:83], v113 offset:40960
    ds_read_b128 v[92:95], v114 offset:45056
    s_waitcnt lgkmcnt(10)
    v_mfma_f32_32x32x16_bf16 v[48:63], a[152:155], v[148:151], v[48:63]
    buffer_load_dwordx4 a[40:43], v4, s[12:15], s72 offen offset:2048 sc1
    ds_read_b128 v[88:91], v113 offset:45056
    s_waitcnt lgkmcnt(10)
    v_mfma_f32_32x32x16_bf16 v[32:47], a[152:155], v[144:147], v[32:47]
    s_waitcnt lgkmcnt(9)
    v_mfma_f32_32x32x16_bf16 v[48:63], a[156:159], v[156:159], v[48:63]
    buffer_load_dwordx4 a[44:47], v4, s[12:15], s72 offen offset:3072 sc1
    s_waitcnt lgkmcnt(8)
    v_mfma_f32_32x32x16_bf16 v[32:47], a[156:159], v[152:155], v[32:47]
    s_waitcnt vmcnt(8)
    s_barrier
    s_waitcnt lgkmcnt(7)
    v_mfma_f32_32x32x16_bf16 v[48:63], a[160:163], v[68:71], v[48:63]
    s_and_b32 s71, s71, 15
    s_lshl_b32 s72, s71, 10
    s_add_u32 s72, s72, s70
    s_add_u32 s71, s71, 4
    buffer_load_dwordx4 a[48:51], v4, s[12:15], s72 offen offset:0 sc1
    ds_read_b128 v[132:135], v114 offset:49152
    s_waitcnt lgkmcnt(7)
    v_mfma_f32_32x32x16_bf16 v[32:47], a[160:163], v[64:67], v[32:47]
    ds_read_b128 v[128:131], v113 offset:49152
    ds_read_b128 v[140:143], v114 offset:53248
    s_waitcnt lgkmcnt(8)
    v_mfma_f32_32x32x16_bf16 v[48:63], a[164:167], v[76:79], v[48:63]
    buffer_load_dwordx4 a[52:55], v4, s[12:15], s72 offen offset:1024 sc1
    ds_read_b128 v[136:139], v113 offset:53248
    ds_read_b128 v[148:151], v114 offset:57344
    s_waitcnt lgkmcnt(9)
    v_mfma_f32_32x32x16_bf16 v[32:47], a[164:167], v[72:75], v[32:47]
    ds_read_b128 v[144:147], v113 offset:57344
    ds_read_b128 v[156:159], v114 offset:61440
    s_waitcnt lgkmcnt(10)
    v_mfma_f32_32x32x16_bf16 v[48:63], a[168:171], v[84:87], v[48:63]
    buffer_load_dwordx4 a[56:59], v4, s[12:15], s72 offen offset:2048 sc1
    ds_read_b128 v[152:155], v113 offset:61440
    s_waitcnt lgkmcnt(10)
    v_mfma_f32_32x32x16_bf16 v[32:47], a[168:171], v[80:83], v[32:47]
    s_waitcnt lgkmcnt(9)
    v_mfma_f32_32x32x16_bf16 v[48:63], a[172:175], v[92:95], v[48:63]
    buffer_load_dwordx4 a[60:63], v4, s[12:15], s72 offen offset:3072 sc1
    s_waitcnt lgkmcnt(8)
    v_mfma_f32_32x32x16_bf16 v[32:47], a[172:175], v[88:91], v[32:47]
    s_waitcnt lgkmcnt(7)
    v_mfma_f32_32x32x16_bf16 v[48:63], a[176:179], v[132:135], v[48:63]
    s_lshl_b32 s70, s26, 2
    s_add_u32 s70, s70, s28
    s_mul_i32 s70, s70, 48
    s_add_u32 s70, s70, 1536
    s_lshl_b32 s70, s70, 10
    s_mul_i32 s71, s27, 4
    s_add_u32 s71, s71, 0
    s_and_b32 s71, s71, 15
    s_lshl_b32 s72, s71, 10
    s_add_u32 s72, s72, s70
    s_add_u32 s71, s71, 4
    buffer_load_dwordx4 a[64:67], v4, s[12:15], s72 offen offset:0 sc1
    s_waitcnt lgkmcnt(5)
    v_mfma_f32_32x32x16_bf16 v[48:63], a[180:183], v[140:143], v[48:63]
    s_waitcnt lgkmcnt(3)
    v_mfma_f32_32x32x16_bf16 v[48:63], a[184:187], v[148:151], v[48:63]
    buffer_load_dwordx4 a[68:71], v4, s[12:15], s72 offen offset:1024 sc1
    s_waitcnt lgkmcnt(1)
    v_mfma_f32_32x32x16_bf16 v[48:63], a[188:191], v[156:159], v[48:63]
    v_mfma_f32_32x32x16_bf16 v[32:47], a[176:179], v[128:131], v[32:47]
    buffer_load_dwordx4 a[72:75], v4, s[12:15], s72 offen offset:2048 sc1
    v_mfma_f32_32x32x16_bf16 v[32:47], a[180:183], v[136:139], v[32:47]
    v_mfma_f32_32x32x16_bf16 v[32:47], a[184:187], v[144:147], v[32:47]
    buffer_load_dwordx4 a[76:79], v4, s[12:15], s72 offen offset:3072 sc1
    s_waitcnt lgkmcnt(0)
    v_mfma_f32_32x32x16_bf16 v[32:47], a[188:191], v[152:155], v[32:47]
    s_nop 4
    ds_write_b128 v115, v[48:51] offset:0
    ds_write_b128 v115, v[52:55] offset:1024
    ds_write_b128 v115, v[56:59] offset:2048
    ds_write_b128 v115, v[60:63] offset:3072
    s_waitcnt lgkmcnt(0)
    s_barrier
    ds_read_b128 v[48:51], v116 offset:0
    ds_read_b128 v[52:55], v116 offset:1024
    ds_read_b128 v[56:59], v116 offset:2048
    ds_read_b128 v[60:63], v116 offset:3072
    s_waitcnt lgkmcnt(3)
    v_pk_add_f32 v[32:33], v[32:33], v[48:49]
    v_pk_add_f32 v[34:35], v[34:35], v[50:51]
    s_waitcnt lgkmcnt(2)
    v_pk_add_f32 v[36:37], v[36:37], v[52:53]
    v_pk_add_f32 v[38:39], v[38:39], v[54:55]
    s_waitcnt lgkmcnt(1)
    v_pk_add_f32 v[40:41], v[40:41], v[56:57]
    v_pk_add_f32 v[42:43], v[42:43], v[58:59]
    s_waitcnt lgkmcnt(0)
    v_pk_add_f32 v[44:45], v[44:45], v[60:61]
    v_pk_add_f32 v[46:47], v[46:47], v[62:63]
    v_cvt_pk_bf16_f32 v16, v32, v33
    v_cvt_pk_bf16_f32 v17, v34, v35
    v_cvt_pk_bf16_f32 v18, v36, v37
    v_cvt_pk_bf16_f32 v19, v38, v39
    v_cvt_pk_bf16_f32 v20, v40, v41
    v_cvt_pk_bf16_f32 v21, v42, v43
    v_cvt_pk_bf16_f32 v22, v44, v45
    v_cvt_pk_bf16_f32 v23, v46, v47
    s_add_u32 s91, s32, 0xe00000
    buffer_store_dwordx4 v[16:19], v112, s[12:15], s91 offen sc1
    buffer_store_dwordx4 v[20:23], v112, s[12:15], s91 offen offset:2048 sc1
    s_add_u32 s56, s33, 65536
    v_add_u32 v5, s56, v112
    ds_write_b128 v5, v[16:19]
    ds_write_b128 v5, v[20:23] offset:2048
    v_pk_add_f32 v[68:69], v[32:33], v[34:35]
    v_pk_mul_f32 v[70:71], v[32:33], v[32:33]
    v_pk_add_f32 v[72:73], v[36:37], v[38:39]
    v_pk_mul_f32 v[74:75], v[34:35], v[34:35]
    v_pk_fma_f32 v[70:71], v[36:37], v[36:37], v[70:71]
    v_pk_fma_f32 v[74:75], v[38:39], v[38:39], v[74:75]
    v_pk_add_f32 v[72:73], v[72:73], v[42:43]
    v_pk_fma_f32 v[70:71], v[40:41], v[40:41], v[70:71]
    v_pk_add_f32 v[68:69], v[68:69], v[40:41]
    v_pk_fma_f32 v[74:75], v[42:43], v[42:43], v[74:75]
    v_pk_add_f32 v[72:73], v[72:73], v[46:47]
    v_pk_fma_f32 v[70:71], v[44:45], v[44:45], v[70:71]
    v_pk_add_f32 v[68:69], v[68:69], v[44:45]
    v_pk_fma_f32 v[74:75], v[46:47], v[46:47], v[74:75]
    v_pk_add_f32 v[68:69], v[68:69], v[72:73]
    v_pk_add_f32 v[70:71], v[70:71], v[74:75]
    v_add_f32 v68, v68, v69
    v_add_f32 v69, v70, v71
    v_mov_b32 v70, v68
    v_mov_b32 v71, v69
    s_add_u32 s91, s34, 0xa20000
    s_mov_b32 s56, -1
    s_mov_b32 s57, 0
    v_permlane32_swap_b32 v68, v70
    v_permlane32_swap_b32 v69, v71
    v_pk_add_f32 v[68:69], v[68:69], v[70:71]
    s_mov_b64 exec, s[56:57]
    buffer_store_dwordx2 v[68:69], v188, s[12:15], s91 offen sc1
    s_mov_b64 exec, -1
    s_waitcnt vmcnt(0)
    s_waitcnt lgkmcnt(0)
    s_barrier
    s_cmp_eq_u32 s28, 0
    s_cbranch_scc0 L_fl_25
    s_add_u32 s56, s35, 128
    s_mov_b64 exec, 1
    buffer_store_dwordx2 v[184:185], v186, s[12:15], s56 offen sc1
    s_mov_b64 exec, -1
L_fl_25:
    s_mov_b32 s94, 0xbdd2d3e8
    s_mov_b32 s95, 0xbdd2d3e8
    v_mov_b32 v126, 0xc0135761
    v_mov_b32 v127, 0xc0135761
    s_lshr_b32 s98, s26, 1
    s_lshr_b32 s97, s98, 1
    s_add_u32 s97, s97, 1
    s_sub_u32 s96, 0, s97
    s_bitcmp1_b32 s98, 0
    s_cselect_b32 s96, s96, s97
    s_lshl_b32 s56, s62, 5
    v_add_u32 v5, s56, v2
    v_add_u32 v6, s96, v5
    v_lshlrev_b32 v7, 4, v6
    v_lshl_add_u32 v125, v3, 10, v7
    v_cmp_gt_u32 vcc, 64, v6
    s_nop 3
    s_mov_b64 s[58:59], vcc
    s_not_b64 s[46:47], vcc
    s_add_u32 s44, s32, 0xc00000
    s_add_u32 s56, s25, 1
    s_sub_u32 s57, s25, 1
    s_bitcmp1_b32 s98, 0
    s_cselect_b32 s56, s57, s56
    s_cmp_ge_u32 s56, 32
    s_cselect_b64 s[46:47], 0, s[46:47]
    s_cselect_b32 s56, 0, s56
    s_lshl_b32 s56, s56, 12
    s_add_u32 s45, s56, 0xaa0000
    v_subrev_u32 v7, 64, v6
    s_bitcmp1_b32 s98, 0
    s_cselect_b64 s[56:57], -1, 0
    v_cndmask_b32 v7, v7, v5, s[56:57]
    s_lshl_b32 s56, s26, 2
    s_lshl_b32 s57, s63, 1
    s_add_u32 s99, s56, s57
    s_lshl_b32 s56, s98, 4
    s_cmp_eq_u32 s98, 3
    s_cselect_b32 s56, 64, s56
    s_lshl_b32 s57, s98, 3
    s_sub_u32 s57, s99, s57
    s_lshl_b32 s57, s57, 1
    v_add_u32 v189, s57, v3
    v_mul_lo_u32 v189, v189, s97
    v_add_u32 v189, v189, v7
    v_add_u32 v189, s56, v189
    v_lshlrev_b32 v189, 5, v189
    s_lshl_b32 s57, s97, 6
    v_add_u32 v190, s57, v189
    v_lshrrev_b32 v64, 3, v1
    v_cmp_gt_u32 vcc, 16, v1
    v_lshrrev_b32 v65, 4, v1
    v_add_u32 v65, 1, v65
    v_cndmask_b32 v66, v65, v64, vcc
    v_and_b32 v64, 7, v1
    v_and_b32 v65, 15, v1
    v_lshrrev_b32 v67, 1, v64
    v_lshrrev_b32 v68, 2, v65
    v_cndmask_b32 v67, v68, v67, vcc
    v_and_b32 v68, 1, v64
    v_bfe_u32 v69, v65, 1, 1
    v_cndmask_b32 v68, v69, v68, vcc
    v_and_b32 v69, 1, v65
    v_mov_b32 v70, 0
    v_cndmask_b32 v69, v69, v70, vcc
    v_lshlrev_b32 v70, 1, v67
    v_add_u32 v70, s62, v70
    v_lshlrev_b32 v71, 1, v70
    v_add_u32 v71, v71, v68
    v_mov_b32 v72, 1
    v_mov_b32 v73, 2
    v_cndmask_b32 v72, v73, v72, vcc
    v_mul_lo_u32 v71, v71, v72
    v_add_u32 v71, v71, v69
    v_lshlrev_b32 v72, 4, v66
    v_mov_b32 v73, 64
    v_cmp_eq_u32 s[56:57], 3, v66
    s_nop 1
    v_cndmask_b32 v72, v72, v73, s[56:57]
    v_add_u32 v71, v71, v72
    v_lshlrev_b32 v195, 5, v71
    v_lshl_add_u32 v70, v66, 3, v70
    s_lshl_b32 s56, s26, 2
    s_lshl_b32 s57, s27, 3
    s_add_u32 s56, s56, s57
    v_subrev_u32 v70, s56, v70
    v_and_b32 v70, 31, v70
    v_lshrrev_b32 v197, 3, v70
    v_lshlrev_b32 v70, 11, v70
    v_lshl_add_u32 v70, v68, 10, v70
    v_and_b32 v72, 1, v66
    v_sub_u32 v73, 63, v69
    v_add_u32 v74, 62, v69
    v_cndmask_b32 v73, v74, v73, vcc
    v_cmp_eq_u32 s[56:57], 1, v72
    s_nop 1
    v_cndmask_b32 v73, v69, v73, s[56:57]
    v_lshl_add_u32 v70, v73, 4, v70
    v_add_u32 v196, 0, v70
    s_cmp_lt_u32 s25, 31
    s_cselect_b32 s90, 1, 0
    s_cmp_gt_u32 s25, 0
    s_cselect_b32 s91, 1, 0
    v_mov_b32 v73, s91
    v_mov_b32 v74, s90
    v_cndmask_b32 v73, v73, v74, s[56:57]
    v_cmp_eq_u32 vcc, 1, v73
    v_cmp_gt_u32 s[56:57], 48, v1
    s_nop 2
    s_nop 0
    s_and_b64 s[96:97], vcc, s[56:57]
    s_mov_b64 s[98:99], s[56:57]
    s_lshl_b32 s56, s25, 12
    s_add_u32 s85, s56, 0xaa0000
    v_add_u32 v123, 0x10000, v113
    v_add_u32 v124, 0x10000, v114
    s_add_u32 s90, s38, 0xe00000
    s_mov_b32 s91, s37
    s_add_u32 s92, s39, 65536
    s_add_u32 s56, s36, 128
    s_nop 0
    s_mov_b32 s69, 0
L_fw_26:
    buffer_load_dwordx2 v[6:7], v187, s[12:15], s56 offen sc1
    s_add_u32 s69, s69, 1
    s_cmp_gt_u32 s69, 200000
    s_cbranch_scc1 L_end
    s_waitcnt vmcnt(0)
    v_xor_b32 v6, s24, v6
    v_bitop3_b32 v6, v7, s24, v6 bitop3:0xbe
    v_cmp_ne_u32 vcc, 0, v6
    s_nop 4
    s_cbranch_vccnz L_fw_26
    s_nop 0
    s_add_u32 s56, s90, s91
    s_cmp_eq_u32 s40, 0
    s_cselect_b64 exec, 0, -1
    s_mov_b32 m0, s92
    s_nop 0
    buffer_load_dwordx4 v4, s[12:15], s56 offen offset:0 sc1 lds
    buffer_load_dwordx4 v4, s[12:15], s56 offen offset:1024 sc1 lds
    buffer_load_dwordx4 v4, s[12:15], s56 offen offset:2048 sc1 lds
    buffer_load_dwordx4 v4, s[12:15], s56 offen offset:3072 sc1 lds
    s_mov_b64 exec, -1
    s_add_u32 s91, s91, 16384
    s_and_b32 s91, s91, 0xffff
    s_add_u32 s92, s92, 16384
    s_add_u32 s56, s90, s91
    s_cmp_eq_u32 s40, 1
    s_cselect_b64 exec, 0, -1
    s_mov_b32 m0, s92
    s_nop 0
    buffer_load_dwordx4 v4, s[12:15], s56 offen offset:0 sc1 lds
    buffer_load_dwordx4 v4, s[12:15], s56 offen offset:1024 sc1 lds
    buffer_load_dwordx4 v4, s[12:15], s56 offen offset:2048 sc1 lds
    buffer_load_dwordx4 v4, s[12:15], s56 offen offset:3072 sc1 lds
    s_mov_b64 exec, -1
    s_add_u32 s91, s91, 16384
    s_and_b32 s91, s91, 0xffff
    s_add_u32 s92, s92, 16384
    s_add_u32 s56, s41, 0xa20000
    s_add_u32 m0, s42, 131072
    s_nop 0
    buffer_load_dwordx4 v4, s[12:15], s56 offen sc1 lds
    buffer_load_dwordx4 v4, s[12:15], s56 offen offset:1024 sc1 lds
    s_add_u32 s56, s90, s91
    s_cmp_eq_u32 s40, 2
    s_cselect_b64 exec, 0, -1
    s_mov_b32 m0, s92
    s_nop 0
    buffer_load_dwordx4 v4, s[12:15], s56 offen offset:0 sc1 lds
    buffer_load_dwordx4 v4, s[12:15], s56 offen offset:1024 sc1 lds
    buffer_load_dwordx4 v4, s[12:15], s56 offen offset:2048 sc1 lds
    buffer_load_dwordx4 v4, s[12:15], s56 offen offset:3072 sc1 lds
    s_mov_b64 exec, -1
    s_add_u32 s91, s91, 16384
    s_and_b32 s91, s91, 0xffff
    s_add_u32 s92, s92, 16384
    s_add_u32 s56, s90, s91
    s_cmp_eq_u32 s40, 3
    s_cselect_b64 exec, 0, -1
    s_mov_b32 m0, s92
    s_nop 0
    buffer_load_dwordx4 v4, s[12:15], s56 offen offset:0 sc1 lds
    buffer_load_dwordx4 v4, s[12:15], s56 offen offset:1024 sc1 lds
    buffer_load_dwordx4 v4, s[12:15], s56 offen offset:2048 sc1 lds
    buffer_load_dwordx4 v4, s[12:15], s56 offen offset:3072 sc1 lds
    s_mov_b64 exec, -1
    s_waitcnt vmcnt(14)
    s_barrier
    ds_read_b128 v[68:71], v124 offset:0
    ds_read_b128 v[64:67], v123 offset:0
    ds_read_b128 v[76:79], v124 offset:4096
    ds_read_b128 v[72:75], v123 offset:4096
    ds_read_b128 v[84:87], v124 offset:8192
    ds_read_b128 v[80:83], v123 offset:8192
    ds_read_b128 v[92:95], v124 offset:12288
    ds_read_b128 v[88:91], v123 offset:12288
    s_waitcnt vmcnt(10)
    s_barrier
    s_waitcnt lgkmcnt(7)
    v_mfma_f32_32x32x16_bf16 v[48:63], a[192:195], v[68:71], 0
    s_and_b32 s71, s71, 15
    s_lshl_b32 s72, s71, 10
    s_add_u32 s72, s72, s70
    s_add_u32 s71, s71, 4
    buffer_load_dwordx4 a[80:83], v4, s[12:15], s72 offen offset:0 sc1
    ds_read_b128 v[132:135], v124 offset:16384
    s_waitcnt lgkmcnt(7)
    v_mfma_f32_32x32x16_bf16 v[32:47], a[192:195], v[64:67], 0
    ds_read_b128 v[128:131], v123 offset:16384
    ds_read_b128 v[140:143], v124 offset:20480
    s_waitcnt lgkmcnt(8)
    v_mfma_f32_32x32x16_bf16 v[48:63], a[196:199], v[76:79], v[48:63]
    buffer_load_dwordx4 a[84:87], v4, s[12:15], s72 offen offset:1024 sc1
    ds_read_b128 v[136:139], v123 offset:20480
    ds_read_b128 v[148:151], v124 offset:24576
    s_waitcnt lgkmcnt(9)
    v_mfma_f32_32x32x16_bf16 v[32:47], a[196:199], v[72:75], v[32:47]
    ds_read_b128 v[144:147], v123 offset:24576
    ds_read_b128 v[156:159], v124 offset:28672
    s_waitcnt lgkmcnt(10)
    v_mfma_f32_32x32x16_bf16 v[48:63], a[200:203], v[84:87], v[48:63]
    buffer_load_dwordx4 a[88:91], v4, s[12:15], s72 offen offset:2048 sc1
    ds_read_b128 v[152:155], v123 offset:28672
    s_waitcnt lgkmcnt(10)
    v_mfma_f32_32x32x16_bf16 v[32:47], a[200:203], v[80:83], v[32:47]
    s_waitcnt lgkmcnt(9)
    v_mfma_f32_32x32x16_bf16 v[48:63], a[204:207], v[92:95], v[48:63]
    buffer_load_dwordx4 a[92:95], v4, s[12:15], s72 offen offset:3072 sc1
    s_waitcnt lgkmcnt(8)
    v_mfma_f32_32x32x16_bf16 v[32:47], a[204:207], v[88:91], v[32:47]
    s_waitcnt vmcnt(8)
    s_barrier
    s_waitcnt lgkmcnt(7)
    v_mfma_f32_32x32x16_bf16 v[48:63], a[208:211], v[132:135], v[48:63]
    s_and_b32 s71, s71, 15
    s_lshl_b32 s72, s71, 10
    s_add_u32 s72, s72, s70
    s_add_u32 s71, s71, 4
    buffer_load_dwordx4 a[96:99], v4, s[12:15], s72 offen offset:0 sc1
    ds_read_b128 v[68:71], v124 offset:32768
    s_waitcnt lgkmcnt(7)
    v_mfma_f32_32x32x16_bf16 v[32:47], a[208:211], v[128:131], v[32:47]
    ds_read_b128 v[64:67], v123 offset:32768
    ds_read_b128 v[76:79], v124 offset:36864
    s_waitcnt lgkmcnt(8)
    v_mfma_f32_32x32x16_bf16 v[48:63], a[212:215], v[140:143], v[48:63]
    buffer_load_dwordx4 a[100:103], v4, s[12:15], s72 offen offset:1024 sc1
    ds_read_b128 v[72:75], v123 offset:36864
    ds_read_b128 v[84:87], v124 offset:40960
    s_waitcnt lgkmcnt(9)
    v_mfma_f32_32x32x16_bf16 v[32:47], a[212:215], v[136:139], v[32:47]
    ds_read_b128 v[80:83], v123 offset:40960
    ds_read_b128 v[92:95], v124 offset:45056
    s_waitcnt lgkmcnt(10)
    v_mfma_f32_32x32x16_bf16 v[48:63], a[216:219], v[148:151], v[48:63]
    buffer_load_dwordx4 a[104:107], v4, s[12:15], s72 offen offset:2048 sc1
    ds_read_b128 v[88:91], v123 offset:45056
    s_waitcnt lgkmcnt(10)
    v_mfma_f32_32x32x16_bf16 v[32:47], a[216:219], v[144:147], v[32:47]
    s_waitcnt lgkmcnt(9)
    v_mfma_f32_32x32x16_bf16 v[48:63], a[220:223], v[156:159], v[48:63]
    buffer_load_dwordx4 a[108:111], v4, s[12:15], s72 offen offset:3072 sc1
    s_waitcnt lgkmcnt(8)
    v_mfma_f32_32x32x16_bf16 v[32:47], a[220:223], v[152:155], v[32:47]
    s_waitcnt vmcnt(8)
    s_barrier
    s_waitcnt lgkmcnt(7)
    v_mfma_f32_32x32x16_bf16 v[48:63], a[224:227], v[68:71], v[48:63]
    s_and_b32 s71, s71, 15
    s_lshl_b32 s72, s71, 10
    s_add_u32 s72, s72, s70
    s_add_u32 s71, s71, 4
    buffer_load_dwordx4 a[112:115], v4, s[12:15], s72 offen offset:0 sc1
    ds_read_b128 v[132:135], v124 offset:49152
    s_waitcnt lgkmcnt(7)
    v_mfma_f32_32x32x16_bf16 v[32:47], a[224:227], v[64:67], v[32:47]
    ds_read_b128 v[128:131], v123 offset:49152
    ds_read_b128 v[140:143], v124 offset:53248
    s_waitcnt lgkmcnt(8)
    v_mfma_f32_32x32x16_bf16 v[48:63], a[228:231], v[76:79], v[48:63]
    buffer_load_dwordx4 a[116:119], v4, s[12:15], s72 offen offset:1024 sc1
    ds_read_b128 v[136:139], v123 offset:53248
    ds_read_b128 v[148:151], v124 offset:57344
    s_waitcnt lgkmcnt(9)
    v_mfma_f32_32x32x16_bf16 v[32:47], a[228:231], v[72:75], v[32:47]
    ds_read_b128 v[144:147], v123 offset:57344
    ds_read_b128 v[156:159], v124 offset:61440
    s_waitcnt lgkmcnt(10)
    v_mfma_f32_32x32x16_bf16 v[48:63], a[232:235], v[84:87], v[48:63]
    buffer_load_dwordx4 a[120:123], v4, s[12:15], s72 offen offset:2048 sc1
    ds_read_b128 v[152:155], v123 offset:61440
    s_waitcnt lgkmcnt(10)
    v_mfma_f32_32x32x16_bf16 v[32:47], a[232:235], v[80:83], v[32:47]
    s_waitcnt lgkmcnt(9)
    v_mfma_f32_32x32x16_bf16 v[48:63], a[236:239], v[92:95], v[48:63]
    buffer_load_dwordx4 a[124:127], v4, s[12:15], s72 offen offset:3072 sc1
    s_waitcnt lgkmcnt(8)
    v_mfma_f32_32x32x16_bf16 v[32:47], a[236:239], v[88:91], v[32:47]
    s_waitcnt lgkmcnt(7)
    v_mfma_f32_32x32x16_bf16 v[48:63], a[240:243], v[132:135], v[48:63]
    s_lshl_b32 s70, s26, 2
    s_add_u32 s70, s70, s28
    s_mul_i32 s70, s70, 48
    s_add_u32 s70, s70, 1552
    s_lshl_b32 s70, s70, 10
    s_mul_i32 s71, s27, 8
    s_add_u32 s71, s71, 0
    s_and_b32 s71, s71, 31
    s_lshl_b32 s72, s71, 10
    s_add_u32 s72, s72, s70
    s_add_u32 s71, s71, 4
    buffer_load_dwordx4 a[128:131], v4, s[12:15], s72 offen offset:0 sc1
    s_waitcnt lgkmcnt(5)
    v_mfma_f32_32x32x16_bf16 v[48:63], a[244:247], v[140:143], v[48:63]
    s_waitcnt lgkmcnt(3)
    v_mfma_f32_32x32x16_bf16 v[48:63], a[248:251], v[148:151], v[48:63]
    buffer_load_dwordx4 a[132:135], v4, s[12:15], s72 offen offset:1024 sc1
    s_waitcnt lgkmcnt(1)
    v_mfma_f32_32x32x16_bf16 v[48:63], a[252:255], v[156:159], v[48:63]
    v_mfma_f32_32x32x16_bf16 v[32:47], a[240:243], v[128:131], v[32:47]
    ds_read_b64 v[160:161], v117 offset:0
    ds_read_b64 v[162:163], v117 offset:512
    ds_read_b64 v[164:165], v117 offset:1024
    ds_read_b64 v[166:167], v117 offset:1536
    ds_read_b64 v[168:169], v117 offset:2048
    ds_read_b64 v[170:171], v117 offset:2560
    ds_read_b64 v[172:173], v117 offset:3072
    ds_read_b64 v[174:175], v117 offset:3584
    s_waitcnt lgkmcnt(6)
    v_add_f32 v160, v160, v162
    v_add_f32 v161, v161, v163
    buffer_load_dwordx4 a[136:139], v4, s[12:15], s72 offen offset:2048 sc1
    v_mfma_f32_32x32x16_bf16 v[32:47], a[244:247], v[136:139], v[32:47]
    s_waitcnt lgkmcnt(4)
    v_add_f32 v164, v164, v166
    v_add_f32 v165, v165, v167
    s_waitcnt lgkmcnt(2)
    v_add_f32 v168, v168, v170
    v_add_f32 v169, v169, v171
    s_waitcnt lgkmcnt(0)
    v_add_f32 v172, v172, v174
    v_add_f32 v173, v173, v175
    v_add_f32 v160, v160, v164
    v_add_f32 v161, v161, v165
    v_add_f32 v168, v168, v172
    v_add_f32 v169, v169, v173
    v_mfma_f32_32x32x16_bf16 v[32:47], a[248:251], v[144:147], v[32:47]
    v_add_f32 v160, v160, v168
    v_add_f32 v161, v161, v169
    v_mov_b32 v162, v160
    v_mov_b32 v163, v161
    v_nop
    v_permlane32_swap_b32 v160, v162
    v_permlane32_swap_b32 v161, v163
    v_add_f32 v160, v160, v162
    v_add_f32 v161, v161, v163
    v_mul_f32 v118, 0x3b000000, v160
    buffer_load_dwordx4 a[140:143], v4, s[12:15], s72 offen offset:3072 sc1
    v_mfma_f32_32x32x16_bf16 v[32:47], a[252:255], v[152:155], v[32:47]
    v_mul_f32 v119, 0x3b000000, v161
    v_fma_f32 v119, -v118, v118, v119
    v_max_f32 v119, 0, v119
    v_add_f32 v160, 0x3727c5ac, v119
    v_rsq_f32 v120, v160
    s_nop 0
    v_mul_f32 v160, v120, v120
    v_mul_f32 v160, v160, v119
    v_add_f32 v160, 0x3727c5ac, v160
    v_rsq_f32 v160, v160
    s_nop 0
    v_mul_f32 v121, v120, v160
    v_sub_f32 v119, 0, v118
    ds_write_b128 v115, v[48:51] offset:0
    ds_write_b128 v115, v[52:55] offset:1024
    ds_write_b128 v115, v[56:59] offset:2048
    ds_write_b128 v115, v[60:63] offset:3072
    s_waitcnt lgkmcnt(0)
    s_barrier
    ds_read_b128 v[48:51], v116 offset:0
    ds_read_b128 v[52:55], v116 offset:1024
    ds_read_b128 v[56:59], v116 offset:2048
    ds_read_b128 v[60:63], v116 offset:3072
    s_waitcnt lgkmcnt(3)
    v_pk_add_f32 v[32:33], v[32:33], v[48:49]
    v_pk_add_f32 v[34:35], v[34:35], v[50:51]
    s_waitcnt lgkmcnt(2)
    v_pk_add_f32 v[36:37], v[36:37], v[52:53]
    v_pk_add_f32 v[38:39], v[38:39], v[54:55]
    s_waitcnt lgkmcnt(1)
    v_pk_add_f32 v[40:41], v[40:41], v[56:57]
    v_pk_add_f32 v[42:43], v[42:43], v[58:59]
    s_waitcnt lgkmcnt(0)
    v_pk_add_f32 v[44:45], v[44:45], v[60:61]
    v_pk_add_f32 v[46:47], v[46:47], v[62:63]
    v_pk_fma_f32 v[32:33], v[96:97], v[118:119], v[32:33] op_sel:[0,1,0] op_sel_hi:[1,1,1]
    v_pk_fma_f32 v[34:35], v[98:99], v[118:119], v[34:35] op_sel:[0,1,0] op_sel_hi:[1,1,1]
    v_pk_fma_f32 v[36:37], v[100:101], v[118:119], v[36:37] op_sel:[0,1,0] op_sel_hi:[1,1,1]
    v_pk_fma_f32 v[38:39], v[102:103], v[118:119], v[38:39] op_sel:[0,1,0] op_sel_hi:[1,1,1]
    v_pk_fma_f32 v[40:41], v[104:105], v[118:119], v[40:41] op_sel:[0,1,0] op_sel_hi:[1,1,1]
    v_pk_fma_f32 v[42:43], v[106:107], v[118:119], v[42:43] op_sel:[0,1,0] op_sel_hi:[1,1,1]
    v_pk_fma_f32 v[44:45], v[108:109], v[118:119], v[44:45] op_sel:[0,1,0] op_sel_hi:[1,1,1]
    v_pk_fma_f32 v[46:47], v[110:111], v[118:119], v[46:47] op_sel:[0,1,0] op_sel_hi:[1,1,1]
    v_pk_mul_f32 v[32:33], v[32:33], v[120:121] op_sel:[0,1] op_sel_hi:[1,1]
    v_pk_mul_f32 v[34:35], v[34:35], v[120:121] op_sel:[0,1] op_sel_hi:[1,1]
    v_pk_mul_f32 v[36:37], v[36:37], v[120:121] op_sel:[0,1] op_sel_hi:[1,1]
    v_pk_mul_f32 v[38:39], v[38:39], v[120:121] op_sel:[0,1] op_sel_hi:[1,1]
    v_pk_mul_f32 v[40:41], v[40:41], v[120:121] op_sel:[0,1] op_sel_hi:[1,1]
    v_pk_mul_f32 v[42:43], v[42:43], v[120:121] op_sel:[0,1] op_sel_hi:[1,1]
    v_pk_mul_f32 v[44:45], v[44:45], v[120:121] op_sel:[0,1] op_sel_hi:[1,1]
    v_pk_mul_f32 v[46:47], v[46:47], v[120:121] op_sel:[0,1] op_sel_hi:[1,1]
    v_pk_mul_f32 v[64:65], v[32:33], v[32:33]
    v_pk_mul_f32 v[66:67], v[34:35], v[34:35]
    v_pk_mul_f32 v[68:69], v[36:37], v[36:37]
    v_pk_mul_f32 v[70:71], v[38:39], v[38:39]
    v_pk_mul_f32 v[72:73], v[40:41], v[40:41]
    v_pk_mul_f32 v[74:75], v[42:43], v[42:43]
    v_pk_mul_f32 v[76:77], v[44:45], v[44:45]
    v_pk_mul_f32 v[78:79], v[46:47], v[46:47]
    v_pk_fma_f32 v[64:65], v[64:65], s[94:95], v[126:127]
    v_pk_fma_f32 v[66:67], v[66:67], s[94:95], v[126:127]
    v_pk_fma_f32 v[68:69], v[68:69], s[94:95], v[126:127]
    v_pk_fma_f32 v[70:71], v[70:71], s[94:95], v[126:127]
    v_pk_fma_f32 v[72:73], v[72:73], s[94:95], v[126:127]
    v_pk_fma_f32 v[74:75], v[74:75], s[94:95], v[126:127]
    v_pk_fma_f32 v[76:77], v[76:77], s[94:95], v[126:127]
    v_pk_fma_f32 v[78:79], v[78:79], s[94:95], v[126:127]
    v_pk_mul_f32 v[64:65], v[64:65], v[32:33]
    v_pk_mul_f32 v[66:67], v[66:67], v[34:35]
    v_pk_mul_f32 v[68:69], v[68:69], v[36:37]
    v_pk_mul_f32 v[70:71], v[70:71], v[38:39]
    v_pk_mul_f32 v[72:73], v[72:73], v[40:41]
    v_pk_mul_f32 v[74:75], v[74:75], v[42:43]
    v_pk_mul_f32 v[76:77], v[76:77], v[44:45]
    v_pk_mul_f32 v[78:79], v[78:79], v[46:47]
    v_exp_f32 v64, v64
    v_exp_f32 v65, v65
    v_exp_f32 v66, v66
    v_exp_f32 v67, v67
    v_exp_f32 v68, v68
    v_exp_f32 v69, v69
    v_exp_f32 v70, v70
    v_exp_f32 v71, v71
    v_exp_f32 v72, v72
    v_exp_f32 v73, v73
    v_exp_f32 v74, v74
    v_exp_f32 v75, v75
    v_exp_f32 v76, v76
    v_exp_f32 v77, v77
    v_exp_f32 v78, v78
    v_exp_f32 v79, v79
    v_pk_add_f32 v[64:65], v[64:65], 1.0 op_sel_hi:[1,0]
    v_pk_add_f32 v[66:67], v[66:67], 1.0 op_sel_hi:[1,0]
    v_pk_add_f32 v[68:69], v[68:69], 1.0 op_sel_hi:[1,0]
    v_pk_add_f32 v[70:71], v[70:71], 1.0 op_sel_hi:[1,0]
    v_pk_add_f32 v[72:73], v[72:73], 1.0 op_sel_hi:[1,0]
    v_pk_add_f32 v[74:75], v[74:75], 1.0 op_sel_hi:[1,0]
    v_pk_add_f32 v[76:77], v[76:77], 1.0 op_sel_hi:[1,0]
    v_pk_add_f32 v[78:79], v[78:79], 1.0 op_sel_hi:[1,0]
    v_rcp_f32 v64, v64
    v_rcp_f32 v65, v65
    v_rcp_f32 v66, v66
    v_rcp_f32 v67, v67
    v_rcp_f32 v68, v68
    v_rcp_f32 v69, v69
    v_rcp_f32 v70, v70
    v_rcp_f32 v71, v71
    v_rcp_f32 v72, v72
    v_rcp_f32 v73, v73
    v_rcp_f32 v74, v74
    v_rcp_f32 v75, v75
    v_rcp_f32 v76, v76
    v_rcp_f32 v77, v77
    v_rcp_f32 v78, v78
    v_rcp_f32 v79, v79
    v_pk_mul_f32 v[32:33], v[32:33], v[64:65]
    v_pk_mul_f32 v[34:35], v[34:35], v[66:67]
    v_pk_mul_f32 v[36:37], v[36:37], v[68:69]
    v_pk_mul_f32 v[38:39], v[38:39], v[70:71]
    v_pk_mul_f32 v[40:41], v[40:41], v[72:73]
    v_pk_mul_f32 v[42:43], v[42:43], v[74:75]
    v_pk_mul_f32 v[44:45], v[44:45], v[76:77]
    v_pk_mul_f32 v[46:47], v[46:47], v[78:79]
    v_cvt_pk_bf16_f32 v80, v32, v33
    v_cvt_pk_bf16_f32 v81, v34, v35
    v_cvt_pk_bf16_f32 v82, v36, v37
    v_cvt_pk_bf16_f32 v83, v38, v39
    v_cvt_pk_bf16_f32 v84, v40, v41
    v_cvt_pk_bf16_f32 v85, v42, v43
    v_cvt_pk_bf16_f32 v86, v44, v45
    v_cvt_pk_bf16_f32 v87, v46, v47
    s_mov_b64 exec, s[58:59]
    buffer_store_dwordx4 v[80:83], v125, s[12:15], s44 offen sc1
    buffer_store_dwordx4 v[84:87], v125, s[12:15], s44 offen offset:2048 sc1
    s_add_u32 s56, s33, 0
    v_add_u32 v5, s56, v125
    ds_write_b128 v5, v[80:83]
    ds_write_b128 v5, v[84:87] offset:2048
    s_mov_b64 exec, s[46:47]
    v_mov_b32 v64, v80
    v_mov_b32 v65, s24
    v_mov_b32 v66, v81
    v_mov_b32 v67, s24
    v_mov_b32 v68, v82
    v_mov_b32 v69, s24
    v_mov_b32 v70, v83
    v_mov_b32 v71, s24
    buffer_store_dwordx4 v[64:67], v189, s[12:15], s45 offen sc1
    buffer_store_dwordx4 v[68:71], v189, s[12:15], s45 offen offset:16 sc1
    v_mov_b32 v72, v84
    v_mov_b32 v73, s24
    v_mov_b32 v74, v85
    v_mov_b32 v75, s24
    v_mov_b32 v76, v86
    v_mov_b32 v77, s24
    v_mov_b32 v78, v87
    v_mov_b32 v79, s24
    buffer_store_dwordx4 v[72:75], v190, s[12:15], s45 offen sc1
    buffer_store_dwordx4 v[76:79], v190, s[12:15], s45 offen offset:16 sc1
    s_mov_b64 exec, -1
    v_lshlrev_b32 v64, 16, v16
    v_and_b32 v65, 0xffff0000, v16
    v_pk_add_f32 v[64:65], v[64:65], v[118:119] op_sel:[0,1] op_sel_hi:[1,1]
    v_pk_mul_f32 v[64:65], v[64:65], v[120:121] op_sel_hi:[1,0]
    v_cvt_pk_bf16_f32 v24, v64, v65
    v_lshlrev_b32 v66, 16, v17
    v_and_b32 v67, 0xffff0000, v17
    v_pk_add_f32 v[66:67], v[66:67], v[118:119] op_sel:[0,1] op_sel_hi:[1,1]
    v_pk_mul_f32 v[66:67], v[66:67], v[120:121] op_sel_hi:[1,0]
    v_cvt_pk_bf16_f32 v25, v66, v67
    v_lshlrev_b32 v68, 16, v18
    v_and_b32 v69, 0xffff0000, v18
    v_pk_add_f32 v[68:69], v[68:69], v[118:119] op_sel:[0,1] op_sel_hi:[1,1]
    v_pk_mul_f32 v[68:69], v[68:69], v[120:121] op_sel_hi:[1,0]
    v_cvt_pk_bf16_f32 v26, v68, v69
    v_lshlrev_b32 v70, 16, v19
    v_and_b32 v71, 0xffff0000, v19
    v_pk_add_f32 v[70:71], v[70:71], v[118:119] op_sel:[0,1] op_sel_hi:[1,1]
    v_pk_mul_f32 v[70:71], v[70:71], v[120:121] op_sel_hi:[1,0]
    v_cvt_pk_bf16_f32 v27, v70, v71
    v_lshlrev_b32 v64, 16, v20
    v_and_b32 v65, 0xffff0000, v20
    v_pk_add_f32 v[64:65], v[64:65], v[118:119] op_sel:[0,1] op_sel_hi:[1,1]
    v_pk_mul_f32 v[64:65], v[64:65], v[120:121] op_sel_hi:[1,0]
    v_cvt_pk_bf16_f32 v28, v64, v65
    v_lshlrev_b32 v66, 16, v21
    v_and_b32 v67, 0xffff0000, v21
    v_pk_add_f32 v[66:67], v[66:67], v[118:119] op_sel:[0,1] op_sel_hi:[1,1]
    v_pk_mul_f32 v[66:67], v[66:67], v[120:121] op_sel_hi:[1,0]
    v_cvt_pk_bf16_f32 v29, v66, v67
    v_lshlrev_b32 v68, 16, v22
    v_and_b32 v69, 0xffff0000, v22
    v_pk_add_f32 v[68:69], v[68:69], v[118:119] op_sel:[0,1] op_sel_hi:[1,1]
    v_pk_mul_f32 v[68:69], v[68:69], v[120:121] op_sel_hi:[1,0]
    v_cvt_pk_bf16_f32 v30, v68, v69
    v_lshlrev_b32 v70, 16, v23
    v_and_b32 v71, 0xffff0000, v23
    v_pk_add_f32 v[70:71], v[70:71], v[118:119] op_sel:[0,1] op_sel_hi:[1,1]
    v_pk_mul_f32 v[70:71], v[70:71], v[120:121] op_sel_hi:[1,0]
    v_cvt_pk_bf16_f32 v31, v70, v71
    s_waitcnt vmcnt(4)
    s_waitcnt lgkmcnt(0)
    s_barrier
    s_cmp_eq_u32 s28, 0
    s_cbranch_scc0 L_fl_27
    s_add_u32 s56, s35, 256
    s_mov_b64 exec, 1
    buffer_store_dwordx2 v[184:185], v186, s[12:15], s56 offen sc1
    s_mov_b64 exec, -1
L_fl_27:
    s_add_u32 s90, s38, 0xc00000
    s_mov_b32 s91, s37
    s_add_u32 s92, s39, 0
    v_mfma_f32_32x32x16_bf16 v[32:47], v[176:179], v[24:27], 0
    v_mfma_f32_32x32x16_bf16 v[32:47], v[180:183], v[28:31], v[32:47]
    v_mov_b32 v172, 0x3f803f80
    v_mov_b32 v173, 0x3f803f80
    v_mov_b32 v174, 0x3f803f80
    v_mov_b32 v175, 0x3f803f80
    s_nop 0
    s_nop 0
    v_mfma_f32_32x32x16_bf16 v[204:219], a[64:67], v[172:175], 0
    v_mfma_f32_32x32x16_bf16 v[204:219], a[68:71], v[172:175], v[204:219]
    v_mfma_f32_32x32x16_bf16 v[204:219], a[72:75], v[172:175], v[204:219]
    v_mfma_f32_32x32x16_bf16 v[204:219], a[76:79], v[172:175], v[204:219]
    v_mfma_f32_32x32x16_bf16 v[204:219], a[80:83], v[172:175], v[204:219]
    v_mfma_f32_32x32x16_bf16 v[204:219], a[84:87], v[172:175], v[204:219]
    v_mfma_f32_32x32x16_bf16 v[204:219], a[88:91], v[172:175], v[204:219]
    v_mfma_f32_32x32x16_bf16 v[204:219], a[92:95], v[172:175], v[204:219]
    v_mfma_f32_32x32x16_bf16 v[204:219], a[96:99], v[172:175], v[204:219]
    v_mfma_f32_32x32x16_bf16 v[204:219], a[100:103], v[172:175], v[204:219]
    v_mfma_f32_32x32x16_bf16 v[204:219], a[104:107], v[172:175], v[204:219]
    v_mfma_f32_32x32x16_bf16 v[204:219], a[108:111], v[172:175], v[204:219]
    v_mfma_f32_32x32x16_bf16 v[204:219], a[112:115], v[172:175], v[204:219]
    v_mfma_f32_32x32x16_bf16 v[204:219], a[116:119], v[172:175], v[204:219]
    v_mfma_f32_32x32x16_bf16 v[204:219], a[120:123], v[172:175], v[204:219]
    v_mfma_f32_32x32x16_bf16 v[204:219], a[124:127], v[172:175], v[204:219]
    s_lshl_b32 s56, s28, 7
    s_add_u32 s56, s56, 155648
    v_lshl_add_u32 v5, v3, 6, s56
    s_mov_b32 s56, 1
    s_mov_b32 s57, 1
    s_mov_b64 exec, s[56:57]
    s_nop 5
    ds_write_b128 v5, v[204:207] offset:0
    ds_write_b128 v5, v[208:211] offset:16
    ds_write_b128 v5, v[212:215] offset:32
    ds_write_b128 v5, v[216:219] offset:48
    s_mov_b64 exec, -1
    s_add_u32 s56, s36, 256
    s_nop 0
    s_mov_b32 s69, 0
L_fw_28:
    buffer_load_dwordx2 v[6:7], v187, s[12:15], s56 offen sc1
    s_add_u32 s69, s69, 1
    s_cmp_gt_u32 s69, 200000
    s_cbranch_scc1 L_end
    s_waitcnt vmcnt(0)
    v_xor_b32 v6, s24, v6
    v_bitop3_b32 v6, v7, s24, v6 bitop3:0xbe
    v_cmp_ne_u32 vcc, 0, v6
    s_nop 4
    s_cbranch_vccnz L_fw_28
    s_nop 0
    s_add_u32 s56, s90, s91
    s_cmp_eq_u32 s40, 0
    s_cselect_b64 exec, 0, -1
    s_mov_b32 m0, s92
    s_nop 0
    buffer_load_dwordx4 v4, s[12:15], s56 offen offset:0 sc1 lds
    buffer_load_dwordx4 v4, s[12:15], s56 offen offset:1024 sc1 lds
    buffer_load_dwordx4 v4, s[12:15], s56 offen offset:2048 sc1 lds
    buffer_load_dwordx4 v4, s[12:15], s56 offen offset:3072 sc1 lds
    s_mov_b64 exec, -1
    s_add_u32 s91, s91, 16384
    s_and_b32 s91, s91, 0xffff
    s_add_u32 s92, s92, 16384
    s_add_u32 s56, s90, s91
    s_cmp_eq_u32 s40, 1
    s_cselect_b64 exec, 0, -1
    s_mov_b32 m0, s92
    s_nop 0
    buffer_load_dwordx4 v4, s[12:15], s56 offen offset:0 sc1 lds
    buffer_load_dwordx4 v4, s[12:15], s56 offen offset:1024 sc1 lds
    buffer_load_dwordx4 v4, s[12:15], s56 offen offset:2048 sc1 lds
    buffer_load_dwordx4 v4, s[12:15], s56 offen offset:3072 sc1 lds
    s_mov_b64 exec, -1
    s_add_u32 s91, s91, 16384
    s_and_b32 s91, s91, 0xffff
    s_add_u32 s92, s92, 16384
    v_mov_b32 v164, 0
    v_mov_b32 v166, 0
    v_mov_b32 v168, 0
    v_mov_b32 v170, 0
    s_mov_b64 exec, s[96:97]
    buffer_load_dwordx4 v[164:167], v195, s[12:15], s85 offen sc1
    buffer_load_dwordx4 v[168:171], v195, s[12:15], s85 offen offset:16 sc1
    s_mov_b64 exec, -1
    s_add_u32 s56, s90, s91
    s_cmp_eq_u32 s40, 2
    s_cselect_b64 exec, 0, -1
    s_mov_b32 m0, s92
    s_nop 0
    buffer_load_dwordx4 v4, s[12:15], s56 offen offset:0 sc1 lds
    buffer_load_dwordx4 v4, s[12:15], s56 offen offset:1024 sc1 lds
    buffer_load_dwordx4 v4, s[12:15], s56 offen offset:2048 sc1 lds
    buffer_load_dwordx4 v4, s[12:15], s56 offen offset:3072 sc1 lds
    s_mov_b64 exec, -1
    s_add_u32 s91, s91, 16384
    s_and_b32 s91, s91, 0xffff
    s_add_u32 s92, s92, 16384
    s_add_u32 s56, s90, s91
    s_cmp_eq_u32 s40, 3
    s_cselect_b64 exec, 0, -1
    s_mov_b32 m0, s92
    s_nop 0
    buffer_load_dwordx4 v4, s[12:15], s56 offen offset:0 sc1 lds
    buffer_load_dwordx4 v4, s[12:15], s56 offen offset:1024 sc1 lds
    buffer_load_dwordx4 v4, s[12:15], s56 offen offset:2048 sc1 lds
    buffer_load_dwordx4 v4, s[12:15], s56 offen offset:3072 sc1 lds
    s_mov_b64 exec, -1
    s_mov_b64 exec, s[96:97]
    s_waitcnt vmcnt(9)
    v_xor_b32 v5, s24, v165
    v_bitop3_b32 v5, v167, s24, v5 bitop3:0xbe
    s_waitcnt vmcnt(8)
    v_bitop3_b32 v5, v169, s24, v5 bitop3:0xbe
    v_bitop3_b32 v5, v171, s24, v5 bitop3:0xbe
    v_cmp_ne_u32 vcc, 0, v5
    s_nop 4
    s_cbranch_vccz L_hp_29_ok
    s_mov_b32 s69, 0
L_hp_29:
    buffer_load_dwordx4 v[164:167], v195, s[12:15], s85 offen sc1
    buffer_load_dwordx4 v[168:171], v195, s[12:15], s85 offen offset:16 sc1
    s_add_u32 s69, s69, 1
    s_cmp_gt_u32 s69, 200000
    s_cbranch_scc1 L_end
    s_waitcnt vmcnt(0)
    v_xor_b32 v5, s24, v165
    v_bitop3_b32 v5, v167, s24, v5 bitop3:0xbe
    v_bitop3_b32 v5, v169, s24, v5 bitop3:0xbe
    v_bitop3_b32 v5, v171, s24, v5 bitop3:0xbe
    v_cmp_ne_u32 vcc, 0, v5
    s_nop 4
    s_cbranch_vccnz L_hp_29
L_hp_29_ok:
    s_nop 1
    s_mov_b64 exec, -1
    v_mov_b32 v165, v166
    v_mov_b32 v166, v168
    v_mov_b32 v167, v170
    s_waitcnt lgkmcnt(0)
    s_barrier
    s_xor_b32 s56, s28, 1
    s_lshl_b32 s56, s56, 7
    s_add_u32 s56, s56, 155648
    v_lshl_add_u32 v5, v3, 6, s56
    ds_read_b128 v[220:223], v5 offset:0
    ds_read_b128 v[224:227], v5 offset:16
    ds_read_b128 v[228:231], v5 offset:32
    ds_read_b128 v[232:235], v5 offset:48
    s_waitcnt lgkmcnt(3)
    v_add_f32 v204, v204, v220
    v_add_f32 v205, v205, v221
    v_add_f32 v206, v206, v222
    v_add_f32 v207, v207, v223
    s_waitcnt lgkmcnt(2)
    v_add_f32 v208, v208, v224
    v_add_f32 v209, v209, v225
    v_add_f32 v210, v210, v226
    v_add_f32 v211, v211, v227
    s_waitcnt lgkmcnt(1)
    v_add_f32 v212, v212, v228
    v_add_f32 v213, v213, v229
    v_add_f32 v214, v214, v230
    v_add_f32 v215, v215, v231
    s_waitcnt lgkmcnt(0)
    v_add_f32 v216, v216, v232
    v_add_f32 v217, v217, v233
    v_add_f32 v218, v218, v234
    v_add_f32 v219, v219, v235
    v_cmp_eq_u32 vcc, 0, v197
    s_nop 3
    s_and_b64 exec, vcc, s[98:99]
    ds_write_b128 v196, v[164:167]
    s_mov_b64 exec, -1
    ds_read_b128 v[68:71], v114 offset:0
    ds_read_b128 v[64:67], v113 offset:0
    ds_read_b128 v[76:79], v114 offset:4096
    ds_read_b128 v[72:75], v113 offset:4096
    ds_read_b128 v[84:87], v114 offset:8192
    ds_read_b128 v[80:83], v113 offset:8192
    ds_read_b128 v[92:95], v114 offset:12288
    ds_read_b128 v[88:91], v113 offset:12288
    s_barrier
    v_cmp_eq_u32 vcc, 1, v197
    s_nop 3
    s_and_b64 exec, vcc, s[98:99]
    ds_write_b128 v196, v[164:167]
    s_mov_b64 exec, -1
    s_waitcnt lgkmcnt(8)
    v_mfma_f32_32x32x16_bf16 v[48:63], a[0:3], v[68:71], 0
    s_and_b32 s71, s71, 31
    s_lshl_b32 s72, s71, 10
    s_add_u32 s72, s72, s70
    s_add_u32 s71, s71, 4
    buffer_load_dwordx4 a[144:147], v4, s[12:15], s72 offen offset:0 sc1
    ds_read_b128 v[132:135], v114 offset:16384
    s_waitcnt lgkmcnt(8)
    v_mfma_f32_32x32x16_bf16 v[32:47], a[0:3], v[64:67], v[32:47]
    ds_read_b128 v[128:131], v113 offset:16384
    ds_read_b128 v[140:143], v114 offset:20480
    s_waitcnt lgkmcnt(9)
    v_mfma_f32_32x32x16_bf16 v[48:63], a[4:7], v[76:79], v[48:63]
    buffer_load_dwordx4 a[148:151], v4, s[12:15], s72 offen offset:1024 sc1
    ds_read_b128 v[136:139], v113 offset:20480
    ds_read_b128 v[148:151], v114 offset:24576
    s_waitcnt lgkmcnt(10)
    v_mfma_f32_32x32x16_bf16 v[32:47], a[4:7], v[72:75], v[32:47]
    ds_read_b128 v[144:147], v113 offset:24576
    ds_read_b128 v[156:159], v114 offset:28672
    s_waitcnt lgkmcnt(11)
    v_mfma_f32_32x32x16_bf16 v[48:63], a[8:11], v[84:87], v[48:63]
    buffer_load_dwordx4 a[152:155], v4, s[12:15], s72 offen offset:2048 sc1
    ds_read_b128 v[152:155], v113 offset:28672
    s_waitcnt lgkmcnt(11)
    v_mfma_f32_32x32x16_bf16 v[32:47], a[8:11], v[80:83], v[32:47]
    s_waitcnt lgkmcnt(10)
    v_mfma_f32_32x32x16_bf16 v[48:63], a[12:15], v[92:95], v[48:63]
    buffer_load_dwordx4 a[156:159], v4, s[12:15], s72 offen offset:3072 sc1
    s_waitcnt lgkmcnt(9)
    v_mfma_f32_32x32x16_bf16 v[32:47], a[12:15], v[88:91], v[32:47]
    s_waitcnt vmcnt(8)
    s_barrier
    v_cmp_eq_u32 vcc, 2, v197
    s_nop 3
    s_and_b64 exec, vcc, s[98:99]
    ds_write_b128 v196, v[164:167]
    s_mov_b64 exec, -1
    s_waitcnt lgkmcnt(8)
    v_mfma_f32_32x32x16_bf16 v[48:63], a[16:19], v[132:135], v[48:63]
    s_and_b32 s71, s71, 31
    s_lshl_b32 s72, s71, 10
    s_add_u32 s72, s72, s70
    s_add_u32 s71, s71, 4
    buffer_load_dwordx4 a[160:163], v4, s[12:15], s72 offen offset:0 sc1
    ds_read_b128 v[68:71], v114 offset:32768
    s_waitcnt lgkmcnt(8)
    v_mfma_f32_32x32x16_bf16 v[32:47], a[16:19], v[128:131], v[32:47]
    ds_read_b128 v[64:67], v113 offset:32768
    ds_read_b128 v[76:79], v114 offset:36864
    s_waitcnt lgkmcnt(9)
    v_mfma_f32_32x32x16_bf16 v[48:63], a[20:23], v[140:143], v[48:63]
    buffer_load_dwordx4 a[164:167], v4, s[12:15], s72 offen offset:1024 sc1
    ds_read_b128 v[72:75], v113 offset:36864
    ds_read_b128 v[84:87], v114 offset:40960
    s_waitcnt lgkmcnt(10)
    v_mfma_f32_32x32x16_bf16 v[32:47], a[20:23], v[136:139], v[32:47]
    ds_read_b128 v[80:83], v113 offset:40960
    ds_read_b128 v[92:95], v114 offset:45056
    s_waitcnt lgkmcnt(11)
    v_mfma_f32_32x32x16_bf16 v[48:63], a[24:27], v[148:151], v[48:63]
    buffer_load_dwordx4 a[168:171], v4, s[12:15], s72 offen offset:2048 sc1
    ds_read_b128 v[88:91], v113 offset:45056
    s_waitcnt lgkmcnt(11)
    v_mfma_f32_32x32x16_bf16 v[32:47], a[24:27], v[144:147], v[32:47]
    s_waitcnt lgkmcnt(10)
    v_mfma_f32_32x32x16_bf16 v[48:63], a[28:31], v[156:159], v[48:63]
    buffer_load_dwordx4 a[172:175], v4, s[12:15], s72 offen offset:3072 sc1
    s_waitcnt lgkmcnt(9)
    v_mfma_f32_32x32x16_bf16 v[32:47], a[28:31], v[152:155], v[32:47]
    s_waitcnt vmcnt(8)
    s_barrier
    v_cmp_eq_u32 vcc, 3, v197
    s_nop 3
    s_and_b64 exec, vcc, s[98:99]
    ds_write_b128 v196, v[164:167]
    s_mov_b64 exec, -1
    s_waitcnt lgkmcnt(8)
    v_mfma_f32_32x32x16_bf16 v[48:63], a[32:35], v[68:71], v[48:63]
    s_and_b32 s71, s71, 31
    s_lshl_b32 s72, s71, 10
    s_add_u32 s72, s72, s70
    s_add_u32 s71, s71, 4
    buffer_load_dwordx4 a[176:179], v4, s[12:15], s72 offen offset:0 sc1
    ds_read_b128 v[132:135], v114 offset:49152
    s_waitcnt lgkmcnt(8)
    v_mfma_f32_32x32x16_bf16 v[32:47], a[32:35], v[64:67], v[32:47]
    ds_read_b128 v[128:131], v113 offset:49152
    ds_read_b128 v[140:143], v114 offset:53248
    s_waitcnt lgkmcnt(9)
    v_mfma_f32_32x32x16_bf16 v[48:63], a[36:39], v[76:79], v[48:63]
    buffer_load_dwordx4 a[180:183], v4, s[12:15], s72 offen offset:1024 sc1
    ds_read_b128 v[136:139], v113 offset:53248
    ds_read_b128 v[148:151], v114 offset:57344
    s_waitcnt lgkmcnt(10)
    v_mfma_f32_32x32x16_bf16 v[32:47], a[36:39], v[72:75], v[32:47]
    ds_read_b128 v[144:147], v113 offset:57344
    ds_read_b128 v[156:159], v114 offset:61440
    s_waitcnt lgkmcnt(11)
    v_mfma_f32_32x32x16_bf16 v[48:63], a[40:43], v[84:87], v[48:63]
    buffer_load_dwordx4 a[184:187], v4, s[12:15], s72 offen offset:2048 sc1
    ds_read_b128 v[152:155], v113 offset:61440
    s_waitcnt lgkmcnt(11)
    v_mfma_f32_32x32x16_bf16 v[32:47], a[40:43], v[80:83], v[32:47]
    s_waitcnt lgkmcnt(10)
    v_mfma_f32_32x32x16_bf16 v[48:63], a[44:47], v[92:95], v[48:63]
    buffer_load_dwordx4 a[188:191], v4, s[12:15], s72 offen offset:3072 sc1
    s_waitcnt lgkmcnt(9)
    v_mfma_f32_32x32x16_bf16 v[32:47], a[44:47], v[88:91], v[32:47]
    s_waitcnt lgkmcnt(7)
    v_mfma_f32_32x32x16_bf16 v[48:63], a[48:51], v[132:135], v[48:63]
    s_lshl_b32 s70, s26, 2
    s_add_u32 s70, s70, s28
    s_mul_i32 s70, s70, 48
    s_add_u32 s70, s70, 1552
    s_lshl_b32 s70, s70, 10
    s_mul_i32 s71, s27, 8
    s_add_u32 s71, s71, 16
    s_and_b32 s71, s71, 31
    s_lshl_b32 s72, s71, 10
    s_add_u32 s72, s72, s70
    s_add_u32 s71, s71, 4
    buffer_load_dwordx4 a[192:195], v4, s[12:15], s72 offen offset:0 sc1
    s_waitcnt lgkmcnt(5)
    v_mfma_f32_32x32x16_bf16 v[48:63], a[52:55], v[140:143], v[48:63]
    s_waitcnt lgkmcnt(3)
    v_mfma_f32_32x32x16_bf16 v[48:63], a[56:59], v[148:151], v[48:63]
    buffer_load_dwordx4 a[196:199], v4, s[12:15], s72 offen offset:1024 sc1
    s_waitcnt lgkmcnt(1)
    v_mfma_f32_32x32x16_bf16 v[48:63], a[60:63], v[156:159], v[48:63]
    v_mfma_f32_32x32x16_bf16 v[32:47], a[48:51], v[128:131], v[32:47]
    buffer_load_dwordx4 a[200:203], v4, s[12:15], s72 offen offset:2048 sc1
    v_mfma_f32_32x32x16_bf16 v[32:47], a[52:55], v[136:139], v[32:47]
    v_mfma_f32_32x32x16_bf16 v[32:47], a[56:59], v[144:147], v[32:47]
    buffer_load_dwordx4 a[204:207], v4, s[12:15], s72 offen offset:3072 sc1
    s_waitcnt lgkmcnt(0)
    v_mfma_f32_32x32x16_bf16 v[32:47], a[60:63], v[152:155], v[32:47]
    s_nop 4
    ds_write_b128 v115, v[48:51] offset:0
    ds_write_b128 v115, v[52:55] offset:1024
    ds_write_b128 v115, v[56:59] offset:2048
    ds_write_b128 v115, v[60:63] offset:3072
    s_waitcnt lgkmcnt(0)
    s_barrier
    ds_read_b128 v[48:51], v116 offset:0
    ds_read_b128 v[52:55], v116 offset:1024
    ds_read_b128 v[56:59], v116 offset:2048
    ds_read_b128 v[60:63], v116 offset:3072
    s_waitcnt lgkmcnt(3)
    v_pk_add_f32 v[32:33], v[32:33], v[48:49]
    v_pk_add_f32 v[34:35], v[34:35], v[50:51]
    s_waitcnt lgkmcnt(2)
    v_pk_add_f32 v[36:37], v[36:37], v[52:53]
    v_pk_add_f32 v[38:39], v[38:39], v[54:55]
    s_waitcnt lgkmcnt(1)
    v_pk_add_f32 v[40:41], v[40:41], v[56:57]
    v_pk_add_f32 v[42:43], v[42:43], v[58:59]
    s_waitcnt lgkmcnt(0)
    v_pk_add_f32 v[44:45], v[44:45], v[60:61]
    v_pk_add_f32 v[46:47], v[46:47], v[62:63]
    v_cvt_pk_bf16_f32 v8, v32, v33
    v_cvt_pk_bf16_f32 v9, v34, v35
    v_cvt_pk_bf16_f32 v10, v36, v37
    v_cvt_pk_bf16_f32 v11, v38, v39
    v_cvt_pk_bf16_f32 v12, v40, v41
    v_cvt_pk_bf16_f32 v13, v42, v43
    v_cvt_pk_bf16_f32 v14, v44, v45
    v_cvt_pk_bf16_f32 v15, v46, v47
    s_add_u32 s91, s32, 0xe00000
    buffer_store_dwordx4 v[8:11], v112, s[12:15], s91 offen sc1
    buffer_store_dwordx4 v[12:15], v112, s[12:15], s91 offen offset:2048 sc1
    s_add_u32 s56, s33, 65536
    v_add_u32 v5, s56, v112
    ds_write_b128 v5, v[8:11]
    ds_write_b128 v5, v[12:15] offset:2048
    v_pk_add_f32 v[68:69], v[32:33], v[34:35]
    v_pk_mul_f32 v[70:71], v[32:33], v[32:33]
    v_pk_add_f32 v[72:73], v[36:37], v[38:39]
    v_pk_mul_f32 v[74:75], v[34:35], v[34:35]
    v_pk_fma_f32 v[70:71], v[36:37], v[36:37], v[70:71]
    v_pk_fma_f32 v[74:75], v[38:39], v[38:39], v[74:75]
    v_pk_add_f32 v[72:73], v[72:73], v[42:43]
    v_pk_fma_f32 v[70:71], v[40:41], v[40:41], v[70:71]
    v_pk_add_f32 v[68:69], v[68:69], v[40:41]
    v_pk_fma_f32 v[74:75], v[42:43], v[42:43], v[74:75]
    v_pk_add_f32 v[72:73], v[72:73], v[46:47]
    v_pk_fma_f32 v[70:71], v[44:45], v[44:45], v[70:71]
    v_pk_add_f32 v[68:69], v[68:69], v[44:45]
    v_pk_fma_f32 v[74:75], v[46:47], v[46:47], v[74:75]
    v_pk_add_f32 v[68:69], v[68:69], v[72:73]
    v_pk_add_f32 v[70:71], v[70:71], v[74:75]
    v_add_f32 v68, v68, v69
    v_add_f32 v69, v70, v71
    v_mov_b32 v70, v68
    v_mov_b32 v71, v69
    s_add_u32 s91, s34, 0xa20000
    s_mov_b32 s56, -1
    s_mov_b32 s57, 0
    v_permlane32_swap_b32 v68, v70
    v_permlane32_swap_b32 v69, v71
    v_pk_add_f32 v[68:69], v[68:69], v[70:71]
    s_mov_b64 exec, s[56:57]
    buffer_store_dwordx2 v[68:69], v188, s[12:15], s91 offen sc1
    s_mov_b64 exec, -1
    s_waitcnt vmcnt(0)
    s_waitcnt lgkmcnt(0)
    s_barrier
    s_cmp_eq_u32 s28, 0
    s_cbranch_scc0 L_fl_30
    s_add_u32 s56, s35, 384
    s_mov_b64 exec, 1
    buffer_store_dwordx2 v[184:185], v186, s[12:15], s56 offen sc1
    s_mov_b64 exec, -1
L_fl_30:
    s_cmp_lt_u32 s26, 3
    s_cselect_b32 s73, 1, 0
    s_xor_b32 s74, s62, 1
    s_or_b32 s74, s74, s73
    s_min_u32 s75, s26, 3
    s_mul_i32 s56, s26, 5
    s_add_u32 s75, s75, s56
    s_lshl_b32 s56, s63, 1
    s_add_u32 s57, s56, 3
    s_add_u32 s76, s63, 3
    s_cmp_eq_u32 s73, 1
    s_cselect_b32 s57, s57, s76
    s_cmp_eq_u32 s62, 0
    s_cselect_b32 s76, s56, s57
    s_mul_i32 s77, s62, 3
    s_add_u32 s77, s77, 1
    v_lshlrev_b32 v5, 4, v2
    v_lshl_add_u32 v5, v3, 10, v5
    v_add_u32 v123, 65536, v5
    s_lshl_b32 s56, s63, 11
    v_add_u32 v124, s56, v123
    s_lshl_b32 s56, s63, 9
    v_add_u32 v125, s56, v124
    s_xor_b32 s56, s56, 512
    v_add_u32 v124, s56, v124
    v_lshlrev_b32 v5, 3, v2
    v_lshl_add_u32 v5, v3, 12, v5
    v_add_u32 v122, 131072, v5
    s_xor_b32 s57, s28, 1
    s_lshl_b32 s57, s57, 12
    s_add_u32 s57, s57, 139264
    v_add_u32 v121, s57, v4
    s_add_u32 s90, s38, 0xe00000
    s_mov_b32 s91, s37
    s_add_u32 s92, s39, 65536
    s_add_u32 s56, s36, 384
    s_nop 0
    s_mov_b32 s69, 0
L_fw_31:
    buffer_load_dwordx2 v[6:7], v187, s[12:15], s56 offen sc1
    s_add_u32 s69, s69, 1
    s_cmp_gt_u32 s69, 200000
    s_cbranch_scc1 L_end
    s_waitcnt vmcnt(0)
    v_xor_b32 v6, s24, v6
    v_bitop3_b32 v6, v7, s24, v6 bitop3:0xbe
    v_cmp_ne_u32 vcc, 0, v6
    s_nop 4
    s_cbranch_vccnz L_fw_31
    s_nop 0
    v_mov_b32 v236, 0x3f803f80
    v_mov_b32 v237, 0x3f803f80
    v_mov_b32 v238, 0x3f803f80
    v_mov_b32 v239, 0x3f803f80
    s_add_u32 s56, s90, s91
    s_cmp_eq_u32 s40, 0
    s_cselect_b64 exec, 0, -1
    s_mov_b32 m0, s92
    s_nop 0
    buffer_load_dwordx4 v4, s[12:15], s56 offen offset:0 sc1 lds
    buffer_load_dwordx4 v4, s[12:15], s56 offen offset:1024 sc1 lds
    buffer_load_dwordx4 v4, s[12:15], s56 offen offset:2048 sc1 lds
    buffer_load_dwordx4 v4, s[12:15], s56 offen offset:3072 sc1 lds
    s_mov_b64 exec, -1
    s_add_u32 s91, s91, 16384
    s_and_b32 s91, s91, 0xffff
    s_add_u32 s92, s92, 16384
    s_add_u32 s56, s90, s91
    s_cmp_eq_u32 s40, 1
    s_cselect_b64 exec, 0, -1
    s_mov_b32 m0, s92
    s_nop 0
    buffer_load_dwordx4 v4, s[12:15], s56 offen offset:0 sc1 lds
    buffer_load_dwordx4 v4, s[12:15], s56 offen offset:1024 sc1 lds
    buffer_load_dwordx4 v4, s[12:15], s56 offen offset:2048 sc1 lds
    buffer_load_dwordx4 v4, s[12:15], s56 offen offset:3072 sc1 lds
    s_mov_b64 exec, -1
    s_add_u32 s91, s91, 16384
    s_and_b32 s91, s91, 0xffff
    s_add_u32 s92, s92, 16384
    s_add_u32 s56, s41, 0xa20000
    s_add_u32 m0, s42, 131072
    s_nop 0
    buffer_load_dwordx4 v4, s[12:15], s56 offen sc1 lds
    buffer_load_dwordx4 v4, s[12:15], s56 offen offset:1024 sc1 lds
    s_add_u32 s56, s90, s91
    s_cmp_eq_u32 s40, 2
    s_cselect_b64 exec, 0, -1
    s_mov_b32 m0, s92
    s_nop 0
    buffer_load_dwordx4 v4, s[12:15], s56 offen offset:0 sc1 lds
    buffer_load_dwordx4 v4, s[12:15], s56 offen offset:1024 sc1 lds
    buffer_load_dwordx4 v4, s[12:15], s56 offen offset:2048 sc1 lds
    buffer_load_dwordx4 v4, s[12:15], s56 offen offset:3072 sc1 lds
    s_mov_b64 exec, -1
    s_add_u32 s91, s91, 16384
    s_and_b32 s91, s91, 0xffff
    s_add_u32 s92, s92, 16384
    s_add_u32 s56, s90, s91
    s_cmp_eq_u32 s40, 3
    s_cselect_b64 exec, 0, -1
    s_mov_b32 m0, s92
    s_nop 0
    buffer_load_dwordx4 v4, s[12:15], s56 offen offset:0 sc1 lds
    buffer_load_dwordx4 v4, s[12:15], s56 offen offset:1024 sc1 lds
    buffer_load_dwordx4 v4, s[12:15], s56 offen offset:2048 sc1 lds
    buffer_load_dwordx4 v4, s[12:15], s56 offen offset:3072 sc1 lds
    s_mov_b64 exec, -1
    v_mfma_f32_32x32x16_bf16 v[144:159], a[128:131], v[236:239], 0
    v_mfma_f32_32x32x16_bf16 v[144:159], a[132:135], v[236:239], v[144:159]
    v_mfma_f32_32x32x16_bf16 v[144:159], a[136:139], v[236:239], v[144:159]
    v_mfma_f32_32x32x16_bf16 v[144:159], a[140:143], v[236:239], v[144:159]
    v_mfma_f32_32x32x16_bf16 v[144:159], a[144:147], v[236:239], v[144:159]
    v_mfma_f32_32x32x16_bf16 v[144:159], a[148:151], v[236:239], v[144:159]
    v_mfma_f32_32x32x16_bf16 v[144:159], a[152:155], v[236:239], v[144:159]
    v_mfma_f32_32x32x16_bf16 v[144:159], a[156:159], v[236:239], v[144:159]
    s_waitcnt vmcnt(14)
    s_barrier
    v_mfma_f32_32x32x16_bf16 v[144:159], a[160:163], v[236:239], v[144:159]
    s_and_b32 s71, s71, 31
    s_lshl_b32 s72, s71, 10
    s_add_u32 s72, s72, s70
    s_add_u32 s71, s71, 4
    buffer_load_dwordx4 a[208:211], v4, s[12:15], s72 offen offset:0 sc1
    ds_read_b128 v[68:71], v124 offset:0
    v_mfma_f32_32x32x16_bf16 v[144:159], a[164:167], v[236:239], v[144:159]
    ds_read_b128 v[64:67], v125 offset:0
    ds_read_b128 v[76:79], v124 offset:4096
    v_mfma_f32_32x32x16_bf16 v[144:159], a[168:171], v[236:239], v[144:159]
    buffer_load_dwordx4 a[212:215], v4, s[12:15], s72 offen offset:1024 sc1
    ds_read_b128 v[72:75], v125 offset:4096
    ds_read_b128 v[84:87], v124 offset:8192
    v_mfma_f32_32x32x16_bf16 v[144:159], a[172:175], v[236:239], v[144:159]
    ds_read_b128 v[80:83], v125 offset:8192
    ds_read_b128 v[92:95], v124 offset:12288
    v_mfma_f32_32x32x16_bf16 v[144:159], a[176:179], v[236:239], v[144:159]
    buffer_load_dwordx4 a[216:219], v4, s[12:15], s72 offen offset:2048 sc1
    ds_read_b128 v[88:91], v125 offset:12288
    v_mfma_f32_32x32x16_bf16 v[144:159], a[180:183], v[236:239], v[144:159]
    v_mfma_f32_32x32x16_bf16 v[144:159], a[184:187], v[236:239], v[144:159]
    buffer_load_dwordx4 a[220:223], v4, s[12:15], s72 offen offset:3072 sc1
    v_mfma_f32_32x32x16_bf16 v[144:159], a[188:191], v[236:239], v[144:159]
    s_waitcnt vmcnt(14)
    s_barrier
    s_waitcnt lgkmcnt(7)
    v_mfma_f32_32x32x16_bf16 v[48:63], a[64:67], v[68:71], 0
    s_and_b32 s71, s71, 31
    s_lshl_b32 s72, s71, 10
    s_add_u32 s72, s72, s70
    s_add_u32 s71, s71, 4
    buffer_load_dwordx4 a[224:227], v4, s[12:15], s72 offen offset:0 sc1
    ds_read_b128 v[28:31], v124 offset:16384
    s_waitcnt lgkmcnt(7)
    v_mfma_f32_32x32x16_bf16 v[32:47], a[64:67], v[64:67], 0
    ds_read_b128 v[24:27], v125 offset:16384
    ds_read_b128 v[100:103], v124 offset:20480
    s_waitcnt lgkmcnt(8)
    v_mfma_f32_32x32x16_bf16 v[48:63], a[68:71], v[76:79], v[48:63]
    buffer_load_dwordx4 a[228:231], v4, s[12:15], s72 offen offset:1024 sc1
    ds_read_b128 v[96:99], v125 offset:20480
    ds_read_b128 v[108:111], v124 offset:24576
    s_waitcnt lgkmcnt(9)
    v_mfma_f32_32x32x16_bf16 v[32:47], a[68:71], v[72:75], v[32:47]
    ds_read_b128 v[104:107], v125 offset:24576
    ds_read_b128 v[172:175], v124 offset:28672
    s_waitcnt lgkmcnt(10)
    v_mfma_f32_32x32x16_bf16 v[48:63], a[72:75], v[84:87], v[48:63]
    buffer_load_dwordx4 a[232:235], v4, s[12:15], s72 offen offset:2048 sc1
    ds_read_b128 v[168:171], v125 offset:28672
    s_waitcnt lgkmcnt(10)
    v_mfma_f32_32x32x16_bf16 v[32:47], a[72:75], v[80:83], v[32:47]
    s_waitcnt lgkmcnt(9)
    v_mfma_f32_32x32x16_bf16 v[48:63], a[76:79], v[92:95], v[48:63]
    buffer_load_dwordx4 a[236:239], v4, s[12:15], s72 offen offset:3072 sc1
    s_waitcnt lgkmcnt(8)
    v_mfma_f32_32x32x16_bf16 v[32:47], a[76:79], v[88:91], v[32:47]
    s_waitcnt vmcnt(12)
    s_barrier
    s_waitcnt lgkmcnt(7)
    v_mfma_f32_32x32x16_bf16 v[48:63], a[80:83], v[28:31], v[48:63]
    s_and_b32 s71, s71, 31
    s_lshl_b32 s72, s71, 10
    s_add_u32 s72, s72, s70
    s_add_u32 s71, s71, 4
    buffer_load_dwordx4 a[240:243], v4, s[12:15], s72 offen offset:0 sc1
    ds_read_b128 v[68:71], v124 offset:32768
    s_waitcnt lgkmcnt(7)
    v_mfma_f32_32x32x16_bf16 v[32:47], a[80:83], v[24:27], v[32:47]
    ds_read_b128 v[64:67], v125 offset:32768
    ds_read_b128 v[76:79], v124 offset:36864
    s_waitcnt lgkmcnt(8)
    v_mfma_f32_32x32x16_bf16 v[48:63], a[84:87], v[100:103], v[48:63]
    buffer_load_dwordx4 a[244:247], v4, s[12:15], s72 offen offset:1024 sc1
    ds_read_b128 v[72:75], v125 offset:36864
    ds_read_b128 v[84:87], v124 offset:40960
    s_waitcnt lgkmcnt(9)
    v_mfma_f32_32x32x16_bf16 v[32:47], a[84:87], v[96:99], v[32:47]
    ds_read_b128 v[80:83], v125 offset:40960
    ds_read_b128 v[92:95], v124 offset:45056
    s_waitcnt lgkmcnt(10)
    v_mfma_f32_32x32x16_bf16 v[48:63], a[88:91], v[108:111], v[48:63]
    buffer_load_dwordx4 a[248:251], v4, s[12:15], s72 offen offset:2048 sc1
    ds_read_b128 v[88:91], v125 offset:45056
    s_waitcnt lgkmcnt(10)
    v_mfma_f32_32x32x16_bf16 v[32:47], a[88:91], v[104:107], v[32:47]
    s_waitcnt lgkmcnt(9)
    v_mfma_f32_32x32x16_bf16 v[48:63], a[92:95], v[172:175], v[48:63]
    buffer_load_dwordx4 a[252:255], v4, s[12:15], s72 offen offset:3072 sc1
    s_waitcnt lgkmcnt(8)
    v_mfma_f32_32x32x16_bf16 v[32:47], a[92:95], v[168:171], v[32:47]
    s_waitcnt vmcnt(12)
    s_barrier
    s_waitcnt lgkmcnt(7)
    v_mfma_f32_32x32x16_bf16 v[48:63], a[96:99], v[68:71], v[48:63]
    s_lshl_b32 s70, s26, 2
    s_add_u32 s70, s70, s28
    s_mul_i32 s70, s70, 46
    s_add_u32 s70, s70, 3072
    s_lshl_b32 s70, s70, 10
    s_mul_i32 s71, s27, 12
    s_add_u32 s71, s71, 0
    s_sub_u32 s72, s71, 43
    s_cmp_ge_u32 s71, 43
    s_cselect_b32 s71, s72, s71
    s_lshl_b32 s72, s71, 10
    s_add_u32 s72, s72, s70
    s_add_u32 s71, s71, 4
    buffer_load_dwordx4 a[0:3], v4, s[12:15], s72 offen offset:0 sc1
    ds_read_b128 v[28:31], v124 offset:49152
    s_waitcnt lgkmcnt(7)
    v_mfma_f32_32x32x16_bf16 v[32:47], a[96:99], v[64:67], v[32:47]
    ds_read_b128 v[24:27], v125 offset:49152
    ds_read_b128 v[100:103], v124 offset:53248
    ds_read_b128 v[96:99], v125 offset:53248
    ds_read_b128 v[108:111], v124 offset:57344
    s_waitcnt lgkmcnt(10)
    v_mfma_f32_32x32x16_bf16 v[48:63], a[100:103], v[76:79], v[48:63]
    buffer_load_dwordx4 a[4:7], v4, s[12:15], s72 offen offset:1024 sc1
    ds_read_b128 v[104:107], v125 offset:57344
    ds_read_b128 v[172:175], v124 offset:61440
    ds_read_b128 v[168:171], v125 offset:61440
    ds_read_b64 v[220:221], v122 offset:0
    s_waitcnt lgkmcnt(13)
    v_mfma_f32_32x32x16_bf16 v[32:47], a[100:103], v[72:75], v[32:47]
    ds_read_b64 v[222:223], v122 offset:512
    ds_read_b64 v[224:225], v122 offset:1024
    ds_read_b64 v[226:227], v122 offset:1536
    ds_read_b64 v[228:229], v122 offset:2048
    s_waitcnt lgkmcnt(15)
    v_mfma_f32_32x32x16_bf16 v[48:63], a[104:107], v[84:87], v[48:63]
    buffer_load_dwordx4 a[8:11], v4, s[12:15], s72 offen offset:2048 sc1
    ds_read_b64 v[230:231], v122 offset:2560
    ds_read_b64 v[232:233], v122 offset:3072
    ds_read_b64 v[234:235], v122 offset:3584
    ds_read_b64 v[240:241], v122 offset:256
    v_mfma_f32_32x32x16_bf16 v[32:47], a[104:107], v[80:83], v[32:47]
    ds_read_b64 v[242:243], v122 offset:768
    ds_read_b64 v[244:245], v122 offset:1280
    ds_read_b64 v[246:247], v122 offset:1792
    ds_read_b64 v[248:249], v122 offset:2304
    s_waitcnt lgkmcnt(15)
    v_mfma_f32_32x32x16_bf16 v[48:63], a[108:111], v[92:95], v[48:63]
    buffer_load_dwordx4 a[12:15], v4, s[12:15], s72 offen offset:3072 sc1
    ds_read_b64 v[250:251], v122 offset:2816
    ds_read_b64 v[252:253], v122 offset:3328
    ds_read_b64 v[254:255], v122 offset:3840
    v_mfma_f32_32x32x16_bf16 v[32:47], a[108:111], v[88:91], v[32:47]
    v_mfma_f32_32x32x16_bf16 v[48:63], a[112:115], v[28:31], v[48:63]
    s_waitcnt lgkmcnt(14)
    v_add_f32 v220, v220, v222
    v_mfma_f32_32x32x16_bf16 v[48:63], a[116:119], v[100:103], v[48:63]
    v_add_f32 v221, v221, v223
    s_waitcnt lgkmcnt(12)
    v_add_f32 v224, v224, v226
    v_add_f32 v225, v225, v227
    s_waitcnt lgkmcnt(10)
    v_add_f32 v228, v228, v230
    v_add_f32 v229, v229, v231
    s_waitcnt lgkmcnt(8)
    v_add_f32 v232, v232, v234
    v_add_f32 v233, v233, v235
    v_mfma_f32_32x32x16_bf16 v[48:63], a[120:123], v[108:111], v[48:63]
    v_add_f32 v220, v220, v224
    v_add_f32 v221, v221, v225
    v_add_f32 v228, v228, v232
    v_add_f32 v229, v229, v233
    v_add_f32 v220, v220, v228
    v_add_f32 v221, v221, v229
    v_mov_b32 v222, v220
    v_mfma_f32_32x32x16_bf16 v[48:63], a[124:127], v[172:175], v[48:63]
    v_mov_b32 v223, v221
    v_nop
    v_permlane32_swap_b32 v220, v222
    v_permlane32_swap_b32 v221, v223
    v_add_f32 v220, v220, v222
    v_add_f32 v221, v221, v223
    v_mul_f32 v160, 0x3b000000, v220
    v_mfma_f32_32x32x16_bf16 v[32:47], a[112:115], v[24:27], v[32:47]
    v_mul_f32 v161, 0x3b000000, v221
    v_fma_f32 v161, -v160, v160, v161
    v_max_f32 v161, 0, v161
    v_add_f32 v161, 0x3727c5ac, v161
    v_rsq_f32 v161, v161
    v_sub_f32 v160, 0, v160
    s_waitcnt lgkmcnt(6)
    v_add_f32 v240, v240, v242
    v_mfma_f32_32x32x16_bf16 v[32:47], a[116:119], v[96:99], v[32:47]
    v_add_f32 v241, v241, v243
    s_waitcnt lgkmcnt(4)
    v_add_f32 v244, v244, v246
    v_add_f32 v245, v245, v247
    s_waitcnt lgkmcnt(2)
    v_add_f32 v248, v248, v250
    v_add_f32 v249, v249, v251
    s_waitcnt lgkmcnt(0)
    v_add_f32 v252, v252, v254
    v_add_f32 v253, v253, v255
    v_mfma_f32_32x32x16_bf16 v[32:47], a[120:123], v[104:107], v[32:47]
    v_add_f32 v240, v240, v244
    v_add_f32 v241, v241, v245
    v_add_f32 v248, v248, v252
    v_add_f32 v249, v249, v253
    v_add_f32 v240, v240, v248
    v_add_f32 v241, v241, v249
    v_mov_b32 v242, v240
    v_mfma_f32_32x32x16_bf16 v[32:47], a[124:127], v[168:171], v[32:47]
    v_mov_b32 v243, v241
    v_nop
    v_permlane32_swap_b32 v240, v242
    v_permlane32_swap_b32 v241, v243
    v_add_f32 v240, v240, v242
    v_add_f32 v241, v241, v243
    v_mul_f32 v162, 0x3b000000, v240
    v_mul_f32 v163, 0x3b000000, v241
    v_fma_f32 v163, -v162, v162, v163
    v_max_f32 v163, 0, v163
    v_add_f32 v163, 0x3727c5ac, v163
    v_rsq_f32 v163, v163
    v_sub_f32 v162, 0, v162
    s_cmp_eq_u32 s63, 1
    s_cselect_b64 s[56:57], -1, 0
    v_cndmask_b32 v164, v160, v162, s[56:57]
    v_cndmask_b32 v165, v161, v163, s[56:57]
    v_lshlrev_b32 v119, 4, v2
    v_lshl_add_u32 v119, v3, 10, v119
    s_mul_i32 s57, s25, 176128
    s_add_u32 s57, s57, 0x1400000
    s_add_u32 s56, s75, s76
    s_lshl_b32 s56, s56, 12
    s_add_u32 s78, s56, s57
    s_add_u32 s56, s75, s77
    s_lshl_b32 s56, s56, 12
    s_add_u32 s79, s56, s57
    s_lshl_b32 s56, s63, 9
    s_add_u32 s79, s79, s56
    s_add_u32 s80, s78, 512
    ds_write_b128 v115, v[48:51] offset:0
    ds_write_b128 v115, v[52:55] offset:1024
    ds_write_b128 v115, v[56:59] offset:2048
    ds_write_b128 v115, v[60:63] offset:3072
    s_waitcnt lgkmcnt(0)
    s_barrier
    ds_read_b128 v[48:51], v121 offset:0
    ds_read_b128 v[52:55], v121 offset:1024
    ds_read_b128 v[56:59], v121 offset:2048
    ds_read_b128 v[60:63], v121 offset:3072
    s_waitcnt lgkmcnt(3)
    v_pk_add_f32 v[32:33], v[32:33], v[48:49]
    v_pk_add_f32 v[34:35], v[34:35], v[50:51]
    s_waitcnt lgkmcnt(2)
    v_pk_add_f32 v[36:37], v[36:37], v[52:53]
    v_pk_add_f32 v[38:39], v[38:39], v[54:55]
    s_waitcnt lgkmcnt(1)
    v_pk_add_f32 v[40:41], v[40:41], v[56:57]
    v_pk_add_f32 v[42:43], v[42:43], v[58:59]
    s_waitcnt lgkmcnt(0)
    v_pk_add_f32 v[44:45], v[44:45], v[60:61]
    v_pk_add_f32 v[46:47], v[46:47], v[62:63]
    ds_read_b128 v[24:27], v123 offset:0
    ds_read_b128 v[28:31], v123 offset:2048
    ds_read_b128 v[168:171], v123 offset:4096
    ds_read_b128 v[172:175], v123 offset:6144
    ds_read_b128 v[48:51], v123 offset:8192
    ds_read_b128 v[52:55], v123 offset:10240
    s_waitcnt lgkmcnt(5)
    v_mfma_f32_32x32x16_bf16 v[64:79], a[128:131], v[24:27], 0
    v_fmac_f32 v32, v164, v204
    ds_read_b128 v[24:27], v123 offset:12288
    s_waitcnt lgkmcnt(5)
    v_mfma_f32_32x32x16_bf16 v[64:79], a[132:135], v[28:31], v[64:79]
    s_sub_u32 s72, s71, 43
    s_cmp_ge_u32 s71, 43
    s_cselect_b32 s71, s72, s71
    s_lshl_b32 s72, s71, 10
    s_add_u32 s72, s72, s70
    s_add_u32 s71, s71, 4
    buffer_load_dwordx4 a[16:19], v4, s[12:15], s72 offen offset:0 sc1
    v_fmac_f32 v33, v164, v205
    v_fmac_f32 v34, v164, v206
    v_fmac_f32 v35, v164, v207
    ds_read_b128 v[28:31], v123 offset:14336
    s_waitcnt lgkmcnt(5)
    v_mfma_f32_32x32x16_bf16 v[64:79], a[136:139], v[168:171], v[64:79]
    v_fmac_f32 v36, v164, v208
    v_fmac_f32 v37, v164, v209
    v_fmac_f32 v38, v164, v210
    ds_read_b128 v[168:171], v123 offset:16384
    s_waitcnt lgkmcnt(5)
    v_mfma_f32_32x32x16_bf16 v[64:79], a[140:143], v[172:175], v[64:79]
    v_fmac_f32 v39, v164, v211
    v_fmac_f32 v40, v164, v212
    v_fmac_f32 v41, v164, v213
    ds_read_b128 v[172:175], v123 offset:18432
    s_waitcnt lgkmcnt(5)
    v_mfma_f32_32x32x16_bf16 v[64:79], a[144:147], v[48:51], v[64:79]
    v_fmac_f32 v42, v164, v214
    v_fmac_f32 v43, v164, v215
    v_fmac_f32 v44, v164, v216
    ds_read_b128 v[48:51], v123 offset:20480
    s_waitcnt lgkmcnt(5)
    v_mfma_f32_32x32x16_bf16 v[64:79], a[148:151], v[52:55], v[64:79]
    buffer_load_dwordx4 a[20:23], v4, s[12:15], s72 offen offset:1024 sc1
    v_fmac_f32 v45, v164, v217
    v_fmac_f32 v46, v164, v218
    v_fmac_f32 v47, v164, v219
    ds_read_b128 v[52:55], v123 offset:22528
    s_waitcnt lgkmcnt(5)
    v_mfma_f32_32x32x16_bf16 v[64:79], a[152:155], v[24:27], v[64:79]
    v_mul_f32 v32, v165, v32
    v_mul_f32 v33, v165, v33
    v_mul_f32 v34, v165, v34
    v_mul_f32 v35, v165, v35
    ds_read_b128 v[24:27], v123 offset:24576
    s_waitcnt lgkmcnt(5)
    v_mfma_f32_32x32x16_bf16 v[64:79], a[156:159], v[28:31], v[64:79]
    v_mul_f32 v36, v165, v36
    v_mul_f32 v37, v165, v37
    v_mul_f32 v38, v165, v38
    ds_read_b128 v[28:31], v123 offset:26624
    s_waitcnt lgkmcnt(5)
    v_mfma_f32_32x32x16_bf16 v[64:79], a[160:163], v[168:171], v[64:79]
    v_mul_f32 v39, v165, v39
    v_mul_f32 v40, v165, v40
    v_mul_f32 v41, v165, v41
    ds_read_b128 v[168:171], v123 offset:28672
    s_waitcnt lgkmcnt(5)
    v_mfma_f32_32x32x16_bf16 v[64:79], a[164:167], v[172:175], v[64:79]
    buffer_load_dwordx4 a[24:27], v4, s[12:15], s72 offen offset:2048 sc1
    v_mul_f32 v42, v165, v42
    v_mul_f32 v43, v165, v43
    v_mul_f32 v44, v165, v44
    ds_read_b128 v[172:175], v123 offset:30720
    s_waitcnt lgkmcnt(5)
    v_mfma_f32_32x32x16_bf16 v[64:79], a[168:171], v[48:51], v[64:79]
    v_mul_f32 v45, v165, v45
    v_mul_f32 v46, v165, v46
    v_mul_f32 v47, v165, v47
    ds_read_b128 v[48:51], v123 offset:32768
    s_waitcnt lgkmcnt(5)
    v_mfma_f32_32x32x16_bf16 v[64:79], a[172:175], v[52:55], v[64:79]
    v_mul_f32 v96, v32, v32
    v_mul_f32 v97, v33, v33
    v_mul_f32 v98, v34, v34
    ds_read_b128 v[52:55], v123 offset:34816
    s_waitcnt lgkmcnt(5)
    v_mfma_f32_32x32x16_bf16 v[64:79], a[176:179], v[24:27], v[64:79]
    v_mul_f32 v99, v35, v35
    v_mul_f32 v100, v36, v36
    v_mul_f32 v101, v37, v37
    v_mul_f32 v102, v38, v38
    ds_read_b128 v[24:27], v123 offset:36864
    s_waitcnt lgkmcnt(5)
    v_mfma_f32_32x32x16_bf16 v[64:79], a[180:183], v[28:31], v[64:79]
    buffer_load_dwordx4 a[28:31], v4, s[12:15], s72 offen offset:3072 sc1
    v_mul_f32 v103, v39, v39
    v_mul_f32 v104, v40, v40
    v_mul_f32 v105, v41, v41
    ds_read_b128 v[28:31], v123 offset:38912
    s_waitcnt lgkmcnt(5)
    v_mfma_f32_32x32x16_bf16 v[64:79], a[184:187], v[168:171], v[64:79]
    v_mul_f32 v106, v42, v42
    v_mul_f32 v107, v43, v43
    v_mul_f32 v108, v44, v44
    ds_read_b128 v[168:171], v123 offset:40960
    s_waitcnt lgkmcnt(5)
    v_mfma_f32_32x32x16_bf16 v[64:79], a[188:191], v[172:175], v[64:79]
    v_mul_f32 v109, v45, v45
    v_mul_f32 v110, v46, v46
    v_mul_f32 v111, v47, v47
    ds_read_b128 v[172:175], v123 offset:43008
    s_waitcnt lgkmcnt(5)
    v_mfma_f32_32x32x16_bf16 v[64:79], a[192:195], v[48:51], v[64:79]
    v_fma_f32 v96, v96, s94, v126
    v_fma_f32 v97, v97, s94, v126
    v_fma_f32 v98, v98, s94, v126
    v_mfma_f32_32x32x16_bf16 v[144:159], a[192:195], v[236:239], v[144:159]
    s_sub_u32 s72, s71, 43
    s_cmp_ge_u32 s71, 43
    s_cselect_b32 s71, s72, s71
    s_lshl_b32 s72, s71, 10
    s_add_u32 s72, s72, s70
    s_add_u32 s71, s71, 4
    buffer_load_dwordx4 a[32:35], v4, s[12:15], s72 offen offset:0 sc1
    v_fma_f32 v99, v99, s94, v126
    v_fma_f32 v100, v100, s94, v126
    v_fma_f32 v101, v101, s94, v126
    ds_read_b128 v[48:51], v123 offset:45056
    s_waitcnt lgkmcnt(5)
    v_mfma_f32_32x32x16_bf16 v[64:79], a[196:199], v[52:55], v[64:79]
    v_fma_f32 v102, v102, s94, v126
    v_fma_f32 v103, v103, s94, v126
    v_fma_f32 v104, v104, s94, v126
    v_fma_f32 v105, v105, s94, v126
    v_mfma_f32_32x32x16_bf16 v[144:159], a[196:199], v[236:239], v[144:159]
    v_fma_f32 v106, v106, s94, v126
    v_fma_f32 v107, v107, s94, v126
    v_fma_f32 v108, v108, s94, v126
    ds_read_b128 v[52:55], v123 offset:47104
    s_waitcnt lgkmcnt(5)
    v_mfma_f32_32x32x16_bf16 v[64:79], a[200:203], v[24:27], v[64:79]
    v_fma_f32 v109, v109, s94, v126
    v_fma_f32 v110, v110, s94, v126
    v_fma_f32 v111, v111, s94, v126
    v_mfma_f32_32x32x16_bf16 v[144:159], a[200:203], v[236:239], v[144:159]
    buffer_load_dwordx4 a[36:39], v4, s[12:15], s72 offen offset:1024 sc1
    v_mul_f32 v96, v96, v32
    v_mul_f32 v97, v97, v33
    v_mul_f32 v98, v98, v34
    ds_read_b128 v[24:27], v123 offset:49152
    s_waitcnt lgkmcnt(5)
    v_mfma_f32_32x32x16_bf16 v[64:79], a[204:207], v[28:31], v[64:79]
    v_mul_f32 v99, v99, v35
    v_mul_f32 v100, v100, v36
    v_mul_f32 v101, v101, v37
    v_mfma_f32_32x32x16_bf16 v[144:159], a[204:207], v[236:239], v[144:159]
    v_mul_f32 v102, v102, v38
    v_mul_f32 v103, v103, v39
    v_mul_f32 v104, v104, v40
    ds_read_b128 v[28:31], v123 offset:51200
    s_waitcnt vmcnt(21)
    s_waitcnt lgkmcnt(5)
    v_mfma_f32_32x32x16_bf16 v[64:79], a[208:211], v[168:171], v[64:79]
    v_mul_f32 v105, v105, v41
    v_mul_f32 v106, v106, v42
    v_mul_f32 v107, v107, v43
    v_mul_f32 v108, v108, v44
    v_mfma_f32_32x32x16_bf16 v[144:159], a[208:211], v[236:239], v[144:159]
    buffer_load_dwordx4 a[40:43], v4, s[12:15], s72 offen offset:2048 sc1
    v_mul_f32 v109, v109, v45
    v_mul_f32 v110, v110, v46
    v_mul_f32 v111, v111, v47
    ds_read_b128 v[168:171], v123 offset:53248
    s_waitcnt vmcnt(21)
    s_waitcnt lgkmcnt(5)
    v_mfma_f32_32x32x16_bf16 v[64:79], a[212:215], v[172:175], v[64:79]
    v_exp_f32 v96, v96
    v_exp_f32 v97, v97
    v_exp_f32 v98, v98
    v_mfma_f32_32x32x16_bf16 v[144:159], a[212:215], v[236:239], v[144:159]
    v_exp_f32 v99, v99
    v_exp_f32 v100, v100
    v_exp_f32 v101, v101
    ds_read_b128 v[172:175], v123 offset:55296
    s_waitcnt vmcnt(20)
    s_waitcnt lgkmcnt(5)
    v_mfma_f32_32x32x16_bf16 v[64:79], a[216:219], v[48:51], v[64:79]
    v_exp_f32 v102, v102
    v_exp_f32 v103, v103
    v_exp_f32 v104, v104
    v_mfma_f32_32x32x16_bf16 v[144:159], a[216:219], v[236:239], v[144:159]
    buffer_load_dwordx4 a[44:47], v4, s[12:15], s72 offen offset:3072 sc1
    v_exp_f32 v105, v105
    v_exp_f32 v106, v106
    v_exp_f32 v107, v107
    ds_read_b128 v[48:51], v123 offset:57344
    s_waitcnt vmcnt(20)
    s_waitcnt lgkmcnt(5)
    v_mfma_f32_32x32x16_bf16 v[64:79], a[220:223], v[52:55], v[64:79]
    v_exp_f32 v108, v108
    v_exp_f32 v109, v109
    v_exp_f32 v110, v110
    v_exp_f32 v111, v111
    v_mfma_f32_32x32x16_bf16 v[144:159], a[220:223], v[236:239], v[144:159]
    v_add_f32 v96, 1.0, v96
    v_add_f32 v97, 1.0, v97
    v_add_f32 v98, 1.0, v98
    ds_read_b128 v[52:55], v123 offset:59392
    s_waitcnt vmcnt(19)
    s_waitcnt lgkmcnt(5)
    v_mfma_f32_32x32x16_bf16 v[64:79], a[224:227], v[24:27], v[64:79]
    v_add_f32 v99, 1.0, v99
    v_add_f32 v100, 1.0, v100
    v_add_f32 v101, 1.0, v101
    v_mfma_f32_32x32x16_bf16 v[144:159], a[224:227], v[236:239], v[144:159]
    s_sub_u32 s72, s71, 43
    s_cmp_ge_u32 s71, 43
    s_cselect_b32 s71, s72, s71
    s_lshl_b32 s72, s71, 10
    s_add_u32 s72, s72, s70
    s_add_u32 s71, s71, 4
    buffer_load_dwordx4 a[48:51], v4, s[12:15], s72 offen offset:0 sc1
    v_add_f32 v102, 1.0, v102
    v_add_f32 v103, 1.0, v103
    v_add_f32 v104, 1.0, v104
    ds_read_b128 v[24:27], v123 offset:61440
    s_waitcnt vmcnt(19)
    s_waitcnt lgkmcnt(5)
    v_mfma_f32_32x32x16_bf16 v[64:79], a[228:231], v[28:31], v[64:79]
    v_add_f32 v105, 1.0, v105
    v_add_f32 v106, 1.0, v106
    v_add_f32 v107, 1.0, v107
    v_mfma_f32_32x32x16_bf16 v[144:159], a[228:231], v[236:239], v[144:159]
    v_add_f32 v108, 1.0, v108
    v_add_f32 v109, 1.0, v109
    v_add_f32 v110, 1.0, v110
    ds_read_b128 v[28:31], v123 offset:63488
    s_waitcnt vmcnt(18)
    s_waitcnt lgkmcnt(5)
    v_mfma_f32_32x32x16_bf16 v[64:79], a[232:235], v[168:171], v[64:79]
    v_add_f32 v111, 1.0, v111
    v_rcp_f32 v96, v96
    v_rcp_f32 v97, v97
    v_rcp_f32 v98, v98
    v_mfma_f32_32x32x16_bf16 v[144:159], a[232:235], v[236:239], v[144:159]
    buffer_load_dwordx4 a[52:55], v4, s[12:15], s72 offen offset:1024 sc1
    v_rcp_f32 v99, v99
    v_rcp_f32 v100, v100
    v_rcp_f32 v101, v101
    s_waitcnt vmcnt(18)
    s_waitcnt lgkmcnt(4)
    v_mfma_f32_32x32x16_bf16 v[64:79], a[236:239], v[172:175], v[64:79]
    v_rcp_f32 v102, v102
    v_rcp_f32 v103, v103
    v_rcp_f32 v104, v104
    v_mfma_f32_32x32x16_bf16 v[144:159], a[236:239], v[236:239], v[144:159]
    v_rcp_f32 v105, v105
    v_rcp_f32 v106, v106
    v_rcp_f32 v107, v107
    s_waitcnt vmcnt(17)
    s_waitcnt lgkmcnt(3)
    v_mfma_f32_32x32x16_bf16 v[64:79], a[240:243], v[48:51], v[64:79]
    v_rcp_f32 v108, v108
    v_rcp_f32 v109, v109
    v_rcp_f32 v110, v110
    v_mfma_f32_32x32x16_bf16 v[144:159], a[240:243], v[236:239], v[144:159]
    buffer_load_dwordx4 a[56:59], v4, s[12:15], s72 offen offset:2048 sc1
    v_rcp_f32 v111, v111
    v_mul_f32 v32, v32, v96
    v_mul_f32 v33, v33, v97
    s_waitcnt vmcnt(17)
    s_waitcnt lgkmcnt(2)
    v_mfma_f32_32x32x16_bf16 v[64:79], a[244:247], v[52:55], v[64:79]
    v_mul_f32 v34, v34, v98
    v_mul_f32 v35, v35, v99
    v_mul_f32 v36, v36, v100
    v_mul_f32 v37, v37, v101
    v_mfma_f32_32x32x16_bf16 v[144:159], a[244:247], v[236:239], v[144:159]
    v_mul_f32 v38, v38, v102
    v_mul_f32 v39, v39, v103
    v_mul_f32 v40, v40, v104
    s_waitcnt vmcnt(16)
    s_waitcnt lgkmcnt(1)
    v_mfma_f32_32x32x16_bf16 v[64:79], a[248:251], v[24:27], v[64:79]
    v_mul_f32 v41, v41, v105
    v_mul_f32 v42, v42, v106
    v_mul_f32 v43, v43, v107
    v_mfma_f32_32x32x16_bf16 v[144:159], a[248:251], v[236:239], v[144:159]
    buffer_load_dwordx4 a[60:63], v4, s[12:15], s72 offen offset:3072 sc1
    v_mul_f32 v44, v44, v108
    v_mul_f32 v45, v45, v109
    v_mul_f32 v46, v46, v110
    s_waitcnt vmcnt(16)
    s_waitcnt lgkmcnt(0)
    v_mfma_f32_32x32x16_bf16 v[64:79], a[252:255], v[28:31], v[64:79]
    v_mul_f32 v47, v47, v111
    v_cvt_pk_bf16_f32 v104, v32, v33
    v_cvt_pk_bf16_f32 v105, v34, v35
    v_mfma_f32_32x32x16_bf16 v[144:159], a[252:255], v[236:239], v[144:159]
    v_cvt_pk_bf16_f32 v106, v36, v37
    v_cvt_pk_bf16_f32 v107, v38, v39
    v_cvt_pk_bf16_f32 v108, v40, v41
    v_cvt_pk_bf16_f32 v109, v42, v43
    v_cvt_pk_bf16_f32 v110, v44, v45
    v_cvt_pk_bf16_f32 v111, v46, v47
    s_cmp_eq_u32 s74, 0
    s_cselect_b64 exec, 0, -1
    buffer_store_dwordx4 v[104:107], v119, s[12:15], s79 offen sc1
    buffer_store_dwordx4 v[108:111], v119, s[12:15], s79 offen offset:2048 sc1
    s_mov_b64 exec, -1
    v_add_u32 v124, 512, v123
    ds_read_b128 v[24:27], v124 offset:0
    ds_read_b128 v[28:31], v124 offset:2048
    ds_read_b128 v[168:171], v124 offset:4096
    ds_read_b128 v[172:175], v124 offset:6144
    ds_read_b128 v[48:51], v124 offset:8192
    ds_read_b128 v[52:55], v124 offset:10240
    s_waitcnt lgkmcnt(5)
    v_mfma_f32_32x32x16_bf16 v[80:95], a[128:131], v[24:27], 0
    v_fmac_f32 v64, v160, v144
    ds_read_b128 v[24:27], v124 offset:12288
    s_waitcnt lgkmcnt(5)
    v_mfma_f32_32x32x16_bf16 v[80:95], a[132:135], v[28:31], v[80:95]
    s_sub_u32 s72, s71, 43
    s_cmp_ge_u32 s71, 43
    s_cselect_b32 s71, s72, s71
    s_lshl_b32 s72, s71, 10
    s_add_u32 s72, s72, s70
    s_add_u32 s71, s71, 4
    buffer_load_dwordx4 a[64:67], v4, s[12:15], s72 offen offset:0 sc1
    v_fmac_f32 v65, v160, v145
    v_fmac_f32 v66, v160, v146
    v_fmac_f32 v67, v160, v147
    v_fmac_f32 v68, v160, v148
    ds_read_b128 v[28:31], v124 offset:14336
    s_waitcnt lgkmcnt(5)
    v_mfma_f32_32x32x16_bf16 v[80:95], a[136:139], v[168:171], v[80:95]
    v_fmac_f32 v69, v160, v149
    v_fmac_f32 v70, v160, v150
    v_fmac_f32 v71, v160, v151
    v_fmac_f32 v72, v160, v152
    v_fmac_f32 v73, v160, v153
    ds_read_b128 v[168:171], v124 offset:16384
    s_waitcnt lgkmcnt(5)
    v_mfma_f32_32x32x16_bf16 v[80:95], a[140:143], v[172:175], v[80:95]
    v_fmac_f32 v74, v160, v154
    v_fmac_f32 v75, v160, v155
    v_fmac_f32 v76, v160, v156
    v_fmac_f32 v77, v160, v157
    v_fmac_f32 v78, v160, v158
    ds_read_b128 v[172:175], v124 offset:18432
    s_waitcnt lgkmcnt(5)
    v_mfma_f32_32x32x16_bf16 v[80:95], a[144:147], v[48:51], v[80:95]
    buffer_load_dwordx4 a[68:71], v4, s[12:15], s72 offen offset:1024 sc1
    v_fmac_f32 v79, v160, v159
    v_mul_f32 v64, v161, v64
    v_mul_f32 v65, v161, v65
    v_mul_f32 v66, v161, v66
    v_mul_f32 v67, v161, v67
    ds_read_b128 v[48:51], v124 offset:20480
    s_waitcnt lgkmcnt(5)
    v_mfma_f32_32x32x16_bf16 v[80:95], a[148:151], v[52:55], v[80:95]
    v_mul_f32 v68, v161, v68
    v_mul_f32 v69, v161, v69
    v_mul_f32 v70, v161, v70
    v_mul_f32 v71, v161, v71
    ds_read_b128 v[52:55], v124 offset:22528
    s_waitcnt lgkmcnt(5)
    v_mfma_f32_32x32x16_bf16 v[80:95], a[152:155], v[24:27], v[80:95]
    v_mul_f32 v72, v161, v72
    v_mul_f32 v73, v161, v73
    v_mul_f32 v74, v161, v74
    v_mul_f32 v75, v161, v75
    v_mul_f32 v76, v161, v76
    ds_read_b128 v[24:27], v124 offset:24576
    s_waitcnt lgkmcnt(5)
    v_mfma_f32_32x32x16_bf16 v[80:95], a[156:159], v[28:31], v[80:95]
    buffer_load_dwordx4 a[72:75], v4, s[12:15], s72 offen offset:2048 sc1
    v_mul_f32 v77, v161, v77
    v_mul_f32 v78, v161, v78
    v_mul_f32 v79, v161, v79
    v_mul_f32 v96, v64, v64
    v_mul_f32 v97, v65, v65
    ds_read_b128 v[28:31], v124 offset:26624
    s_waitcnt lgkmcnt(5)
    v_mfma_f32_32x32x16_bf16 v[80:95], a[160:163], v[168:171], v[80:95]
    v_mul_f32 v98, v66, v66
    v_mul_f32 v99, v67, v67
    v_mul_f32 v100, v68, v68
    v_mul_f32 v101, v69, v69
    v_mul_f32 v102, v70, v70
    ds_read_b128 v[168:171], v124 offset:28672
    s_waitcnt lgkmcnt(5)
    v_mfma_f32_32x32x16_bf16 v[80:95], a[164:167], v[172:175], v[80:95]
    v_mul_f32 v103, v71, v71
    v_mul_f32 v104, v72, v72
    v_mul_f32 v105, v73, v73
    v_mul_f32 v106, v74, v74
    ds_read_b128 v[172:175], v124 offset:30720
    s_waitcnt lgkmcnt(5)
    v_mfma_f32_32x32x16_bf16 v[80:95], a[168:171], v[48:51], v[80:95]
    buffer_load_dwordx4 a[76:79], v4, s[12:15], s72 offen offset:3072 sc1
    v_mul_f32 v107, v75, v75
    v_mul_f32 v108, v76, v76
    v_mul_f32 v109, v77, v77
    v_mul_f32 v110, v78, v78
    v_mul_f32 v111, v79, v79
    ds_read_b128 v[48:51], v124 offset:32768
    s_waitcnt lgkmcnt(5)
    v_mfma_f32_32x32x16_bf16 v[80:95], a[172:175], v[52:55], v[80:95]
    v_fma_f32 v96, v96, s94, v126
    v_fma_f32 v97, v97, s94, v126
    v_fma_f32 v98, v98, s94, v126
    v_fma_f32 v99, v99, s94, v126
    v_fma_f32 v100, v100, s94, v126
    ds_read_b128 v[52:55], v124 offset:34816
    s_waitcnt lgkmcnt(5)
    v_mfma_f32_32x32x16_bf16 v[80:95], a[176:179], v[24:27], v[80:95]
    v_fma_f32 v101, v101, s94, v126
    v_fma_f32 v102, v102, s94, v126
    v_fma_f32 v103, v103, s94, v126
    v_fma_f32 v104, v104, s94, v126
    v_fma_f32 v105, v105, s94, v126
    ds_read_b128 v[24:27], v124 offset:36864
    s_waitcnt lgkmcnt(5)
    v_mfma_f32_32x32x16_bf16 v[80:95], a[180:183], v[28:31], v[80:95]
    v_fma_f32 v106, v106, s94, v126
    v_fma_f32 v107, v107, s94, v126
    v_fma_f32 v108, v108, s94, v126
    v_fma_f32 v109, v109, s94, v126
    ds_read_b128 v[28:31], v124 offset:38912
    s_waitcnt lgkmcnt(5)
    v_mfma_f32_32x32x16_bf16 v[80:95], a[184:187], v[168:171], v[80:95]
    s_sub_u32 s72, s71, 43
    s_cmp_ge_u32 s71, 43
    s_cselect_b32 s71, s72, s71
    s_lshl_b32 s72, s71, 10
    s_add_u32 s72, s72, s70
    s_add_u32 s71, s71, 4
    buffer_load_dwordx4 a[80:83], v4, s[12:15], s72 offen offset:0 sc1
    v_fma_f32 v110, v110, s94, v126
    v_fma_f32 v111, v111, s94, v126
    v_mul_f32 v96, v96, v64
    v_mul_f32 v97, v97, v65
    v_mul_f32 v98, v98, v66
    ds_read_b128 v[168:171], v124 offset:40960
    s_waitcnt lgkmcnt(5)
    v_mfma_f32_32x32x16_bf16 v[80:95], a[188:191], v[172:175], v[80:95]
    v_mul_f32 v99, v99, v67
    v_mul_f32 v100, v100, v68
    v_mul_f32 v101, v101, v69
    v_mul_f32 v102, v102, v70
    v_mul_f32 v103, v103, v71
    ds_read_b128 v[172:175], v124 offset:43008
    s_waitcnt lgkmcnt(5)
    v_mfma_f32_32x32x16_bf16 v[80:95], a[192:195], v[48:51], v[80:95]
    v_mul_f32 v104, v104, v72
    v_mul_f32 v105, v105, v73
    v_mul_f32 v106, v106, v74
    v_mul_f32 v107, v107, v75
    v_mul_f32 v108, v108, v76
    ds_read_b128 v[48:51], v124 offset:45056
    s_waitcnt lgkmcnt(5)
    v_mfma_f32_32x32x16_bf16 v[80:95], a[196:199], v[52:55], v[80:95]
    buffer_load_dwordx4 a[84:87], v4, s[12:15], s72 offen offset:1024 sc1
    v_mul_f32 v109, v109, v77
    v_mul_f32 v110, v110, v78
    v_mul_f32 v111, v111, v79
    v_exp_f32 v96, v96
    ds_read_b128 v[52:55], v124 offset:47104
    s_waitcnt lgkmcnt(5)
    v_mfma_f32_32x32x16_bf16 v[80:95], a[200:203], v[24:27], v[80:95]
    v_exp_f32 v97, v97
    v_exp_f32 v98, v98
    v_exp_f32 v99, v99
    v_exp_f32 v100, v100
    v_exp_f32 v101, v101
    ds_read_b128 v[24:27], v124 offset:49152
    s_waitcnt lgkmcnt(5)
    v_mfma_f32_32x32x16_bf16 v[80:95], a[204:207], v[28:31], v[80:95]
    v_exp_f32 v102, v102
    v_exp_f32 v103, v103
    v_exp_f32 v104, v104
    v_exp_f32 v105, v105
    v_exp_f32 v106, v106
    ds_read_b128 v[28:31], v124 offset:51200
    s_waitcnt lgkmcnt(5)
    v_mfma_f32_32x32x16_bf16 v[80:95], a[208:211], v[168:171], v[80:95]
    buffer_load_dwordx4 a[88:91], v4, s[12:15], s72 offen offset:2048 sc1
    v_exp_f32 v107, v107
    v_exp_f32 v108, v108
    v_exp_f32 v109, v109
    v_exp_f32 v110, v110
    v_exp_f32 v111, v111
    ds_read_b128 v[168:171], v124 offset:53248
    s_waitcnt lgkmcnt(5)
    v_mfma_f32_32x32x16_bf16 v[80:95], a[212:215], v[172:175], v[80:95]
    v_add_f32 v96, 1.0, v96
    v_add_f32 v97, 1.0, v97
    v_add_f32 v98, 1.0, v98
    v_add_f32 v99, 1.0, v99
    ds_read_b128 v[172:175], v124 offset:55296
    s_waitcnt lgkmcnt(5)
    v_mfma_f32_32x32x16_bf16 v[80:95], a[216:219], v[48:51], v[80:95]
    v_add_f32 v100, 1.0, v100
    v_add_f32 v101, 1.0, v101
    v_add_f32 v102, 1.0, v102
    v_add_f32 v103, 1.0, v103
    v_add_f32 v104, 1.0, v104
    ds_read_b128 v[48:51], v124 offset:57344
    s_waitcnt lgkmcnt(5)
    v_mfma_f32_32x32x16_bf16 v[80:95], a[220:223], v[52:55], v[80:95]
    buffer_load_dwordx4 a[92:95], v4, s[12:15], s72 offen offset:3072 sc1
    v_add_f32 v105, 1.0, v105
    v_add_f32 v106, 1.0, v106
    v_add_f32 v107, 1.0, v107
    v_add_f32 v108, 1.0, v108
    v_add_f32 v109, 1.0, v109
    ds_read_b128 v[52:55], v124 offset:59392
    s_waitcnt lgkmcnt(5)
    v_mfma_f32_32x32x16_bf16 v[80:95], a[224:227], v[24:27], v[80:95]
    v_add_f32 v110, 1.0, v110
    v_add_f32 v111, 1.0, v111
    v_rcp_f32 v96, v96
    v_rcp_f32 v97, v97
    v_rcp_f32 v98, v98
    ds_read_b128 v[24:27], v124 offset:61440
    s_waitcnt lgkmcnt(5)
    v_mfma_f32_32x32x16_bf16 v[80:95], a[228:231], v[28:31], v[80:95]
    v_rcp_f32 v99, v99
    v_rcp_f32 v100, v100
    v_rcp_f32 v101, v101
    v_rcp_f32 v102, v102
    ds_read_b128 v[28:31], v124 offset:63488
    s_waitcnt lgkmcnt(5)
    v_mfma_f32_32x32x16_bf16 v[80:95], a[232:235], v[168:171], v[80:95]
    s_sub_u32 s72, s71, 43
    s_cmp_ge_u32 s71, 43
    s_cselect_b32 s71, s72, s71
    s_lshl_b32 s72, s71, 10
    s_add_u32 s72, s72, s70
    s_add_u32 s71, s71, 4
    buffer_load_dwordx4 a[96:99], v4, s[12:15], s72 offen offset:0 sc1
    v_rcp_f32 v103, v103
    v_rcp_f32 v104, v104
    v_rcp_f32 v105, v105
    v_rcp_f32 v106, v106
    v_rcp_f32 v107, v107
    s_waitcnt lgkmcnt(4)
    v_mfma_f32_32x32x16_bf16 v[80:95], a[236:239], v[172:175], v[80:95]
    v_rcp_f32 v108, v108
    v_rcp_f32 v109, v109
    v_rcp_f32 v110, v110
    v_rcp_f32 v111, v111
    v_mul_f32 v64, v64, v96
    s_waitcnt lgkmcnt(3)
    v_mfma_f32_32x32x16_bf16 v[80:95], a[240:243], v[48:51], v[80:95]
    v_mul_f32 v65, v65, v97
    v_mul_f32 v66, v66, v98
    v_mul_f32 v67, v67, v99
    v_mul_f32 v68, v68, v100
    v_mul_f32 v69, v69, v101
    s_waitcnt lgkmcnt(2)
    v_mfma_f32_32x32x16_bf16 v[80:95], a[244:247], v[52:55], v[80:95]
    v_mul_f32 v70, v70, v102
    v_mul_f32 v71, v71, v103
    v_mul_f32 v72, v72, v104
    v_mul_f32 v73, v73, v105
    s_waitcnt lgkmcnt(1)
    v_mfma_f32_32x32x16_bf16 v[80:95], a[248:251], v[24:27], v[80:95]
    buffer_load_dwordx4 a[100:103], v4, s[12:15], s72 offen offset:1024 sc1
    v_mul_f32 v74, v74, v106
    v_mul_f32 v75, v75, v107
    v_mul_f32 v76, v76, v108
    v_mul_f32 v77, v77, v109
    v_mul_f32 v78, v78, v110
    s_waitcnt lgkmcnt(0)
    v_mfma_f32_32x32x16_bf16 v[80:95], a[252:255], v[28:31], v[80:95]
    v_mul_f32 v79, v79, v111
    v_cvt_pk_bf16_f32 v104, v64, v65
    v_cvt_pk_bf16_f32 v105, v66, v67
    v_cvt_pk_bf16_f32 v106, v68, v69
    v_cvt_pk_bf16_f32 v107, v70, v71
    v_cvt_pk_bf16_f32 v108, v72, v73
    v_cvt_pk_bf16_f32 v109, v74, v75
    v_cvt_pk_bf16_f32 v110, v76, v77
    v_cvt_pk_bf16_f32 v111, v78, v79
    buffer_store_dwordx4 v[104:107], v119, s[12:15], s78 offen sc1
    buffer_store_dwordx4 v[108:111], v119, s[12:15], s78 offen offset:2048 sc1
    s_nop 0
    v_pk_fma_f32 v[80:81], v[144:145], v[162:163], v[80:81] op_sel_hi:[1,0,1]
    v_pk_mul_f32 v[80:81], v[80:81], v[162:163] op_sel:[0,1] op_sel_hi:[1,1]
    v_pk_fma_f32 v[82:83], v[146:147], v[162:163], v[82:83] op_sel_hi:[1,0,1]
    v_pk_mul_f32 v[82:83], v[82:83], v[162:163] op_sel:[0,1] op_sel_hi:[1,1]
    v_pk_fma_f32 v[84:85], v[148:149], v[162:163], v[84:85] op_sel_hi:[1,0,1]
    v_pk_mul_f32 v[84:85], v[84:85], v[162:163] op_sel:[0,1] op_sel_hi:[1,1]
    buffer_load_dwordx4 a[104:107], v4, s[12:15], s72 offen offset:2048 sc1
    v_pk_fma_f32 v[86:87], v[150:151], v[162:163], v[86:87] op_sel_hi:[1,0,1]
    v_pk_mul_f32 v[86:87], v[86:87], v[162:163] op_sel:[0,1] op_sel_hi:[1,1]
    v_pk_fma_f32 v[88:89], v[152:153], v[162:163], v[88:89] op_sel_hi:[1,0,1]
    v_pk_mul_f32 v[88:89], v[88:89], v[162:163] op_sel:[0,1] op_sel_hi:[1,1]
    v_pk_fma_f32 v[90:91], v[154:155], v[162:163], v[90:91] op_sel_hi:[1,0,1]
    v_pk_mul_f32 v[90:91], v[90:91], v[162:163] op_sel:[0,1] op_sel_hi:[1,1]
    v_pk_fma_f32 v[92:93], v[156:157], v[162:163], v[92:93] op_sel_hi:[1,0,1]
    v_pk_mul_f32 v[92:93], v[92:93], v[162:163] op_sel:[0,1] op_sel_hi:[1,1]
    v_pk_fma_f32 v[94:95], v[158:159], v[162:163], v[94:95] op_sel_hi:[1,0,1]
    v_pk_mul_f32 v[94:95], v[94:95], v[162:163] op_sel:[0,1] op_sel_hi:[1,1]
    v_pk_mul_f32 v[96:97], v[80:81], v[80:81]
    v_pk_mul_f32 v[98:99], v[82:83], v[82:83]
    buffer_load_dwordx4 a[108:111], v4, s[12:15], s72 offen offset:3072 sc1
    v_pk_mul_f32 v[100:101], v[84:85], v[84:85]
    v_pk_mul_f32 v[102:103], v[86:87], v[86:87]
    v_pk_mul_f32 v[104:105], v[88:89], v[88:89]
    v_pk_mul_f32 v[106:107], v[90:91], v[90:91]
    v_pk_mul_f32 v[108:109], v[92:93], v[92:93]
    v_pk_mul_f32 v[110:111], v[94:95], v[94:95]
    v_pk_fma_f32 v[96:97], v[96:97], s[94:95], v[126:127]
    v_pk_fma_f32 v[98:99], v[98:99], s[94:95], v[126:127]
    v_pk_fma_f32 v[100:101], v[100:101], s[94:95], v[126:127]
    v_pk_fma_f32 v[102:103], v[102:103], s[94:95], v[126:127]
    v_pk_fma_f32 v[104:105], v[104:105], s[94:95], v[126:127]
    v_pk_fma_f32 v[106:107], v[106:107], s[94:95], v[126:127]
    s_sub_u32 s72, s71, 43
    s_cmp_ge_u32 s71, 43
    s_cselect_b32 s71, s72, s71
    s_lshl_b32 s72, s71, 10
    s_add_u32 s72, s72, s70
    s_add_u32 s71, s71, 4
    buffer_load_dwordx4 a[112:115], v4, s[12:15], s72 offen offset:0 sc1
    v_pk_fma_f32 v[108:109], v[108:109], s[94:95], v[126:127]
    v_pk_fma_f32 v[110:111], v[110:111], s[94:95], v[126:127]
    v_pk_mul_f32 v[96:97], v[96:97], v[80:81]
    v_pk_mul_f32 v[98:99], v[98:99], v[82:83]
    v_pk_mul_f32 v[100:101], v[100:101], v[84:85]
    v_pk_mul_f32 v[102:103], v[102:103], v[86:87]
    v_pk_mul_f32 v[104:105], v[104:105], v[88:89]
    v_pk_mul_f32 v[106:107], v[106:107], v[90:91]
    v_pk_mul_f32 v[108:109], v[108:109], v[92:93]
    v_pk_mul_f32 v[110:111], v[110:111], v[94:95]
    v_exp_f32 v96, v96
    v_exp_f32 v97, v97
    buffer_load_dwordx4 v[200:203], v4, s[12:15], s72 offen offset:1024 sc1
    v_exp_f32 v98, v98
    v_exp_f32 v99, v99
    v_exp_f32 v100, v100
    v_exp_f32 v101, v101
    v_exp_f32 v102, v102
    v_exp_f32 v103, v103
    v_exp_f32 v104, v104
    v_exp_f32 v105, v105
    v_exp_f32 v106, v106
    v_exp_f32 v107, v107
    v_exp_f32 v108, v108
    v_exp_f32 v109, v109
    buffer_load_dwordx4 v[204:207], v4, s[12:15], s72 offen offset:2048 sc1
    v_exp_f32 v110, v110
    v_exp_f32 v111, v111
    v_pk_add_f32 v[96:97], v[96:97], 1.0 op_sel_hi:[1,0]
    v_pk_add_f32 v[98:99], v[98:99], 1.0 op_sel_hi:[1,0]
    v_pk_add_f32 v[100:101], v[100:101], 1.0 op_sel_hi:[1,0]
    v_pk_add_f32 v[102:103], v[102:103], 1.0 op_sel_hi:[1,0]
    v_pk_add_f32 v[104:105], v[104:105], 1.0 op_sel_hi:[1,0]
    v_pk_add_f32 v[106:107], v[106:107], 1.0 op_sel_hi:[1,0]
    v_pk_add_f32 v[108:109], v[108:109], 1.0 op_sel_hi:[1,0]
    v_pk_add_f32 v[110:111], v[110:111], 1.0 op_sel_hi:[1,0]
    v_rcp_f32 v96, v96
    v_rcp_f32 v97, v97
    buffer_load_dwordx4 v[208:211], v4, s[12:15], s72 offen offset:3072 sc1
    v_rcp_f32 v98, v98
    v_rcp_f32 v99, v99
    v_rcp_f32 v100, v100
    v_rcp_f32 v101, v101
    v_rcp_f32 v102, v102
    v_rcp_f32 v103, v103
    v_rcp_f32 v104, v104
    v_rcp_f32 v105, v105
    v_rcp_f32 v106, v106
    v_rcp_f32 v107, v107
    v_rcp_f32 v108, v108
    v_rcp_f32 v109, v109
    s_sub_u32 s72, s71, 43
    s_cmp_ge_u32 s71, 43
    s_cselect_b32 s71, s72, s71
    s_lshl_b32 s72, s71, 10
    s_add_u32 s72, s72, s70
    s_add_u32 s71, s71, 4
    buffer_load_dwordx4 v[212:215], v4, s[12:15], s72 offen offset:0 sc1
    v_rcp_f32 v110, v110
    v_rcp_f32 v111, v111
    v_pk_mul_f32 v[80:81], v[80:81], v[96:97]
    v_pk_mul_f32 v[82:83], v[82:83], v[98:99]
    v_pk_mul_f32 v[84:85], v[84:85], v[100:101]
    v_pk_mul_f32 v[86:87], v[86:87], v[102:103]
    v_pk_mul_f32 v[88:89], v[88:89], v[104:105]
    v_pk_mul_f32 v[90:91], v[90:91], v[106:107]
    v_pk_mul_f32 v[92:93], v[92:93], v[108:109]
    v_pk_mul_f32 v[94:95], v[94:95], v[110:111]
    v_cvt_pk_bf16_f32 v104, v80, v81
    v_cvt_pk_bf16_f32 v105, v82, v83
    buffer_load_dwordx4 v[216:219], v4, s[12:15], s72 offen offset:1024 sc1
    v_cvt_pk_bf16_f32 v106, v84, v85
    v_cvt_pk_bf16_f32 v107, v86, v87
    v_cvt_pk_bf16_f32 v108, v88, v89
    v_cvt_pk_bf16_f32 v109, v90, v91
    v_cvt_pk_bf16_f32 v110, v92, v93
    v_cvt_pk_bf16_f32 v111, v94, v95
    buffer_store_dwordx4 v[104:107], v119, s[12:15], s80 offen sc1
    buffer_store_dwordx4 v[108:111], v119, s[12:15], s80 offen offset:2048 sc1
    s_waitcnt vmcnt(0)
    s_barrier
    s_cmp_eq_u32 s28, 0
    s_cbranch_scc0 L_fl_32
    s_add_u32 s56, s35, 512
    s_mov_b64 exec, 1
    buffer_store_dwordx2 v[184:185], v186, s[12:15], s56 offen sc1
    s_mov_b64 exec, -1
L_fl_32:
    v_add_u32 v123, 0x10000, v113
    v_add_u32 v124, 0x10000, v114
    v_add_u32 v125, 0x20000, v113
    v_add_u32 v122, 0x20000, v114
    s_mul_i32 s56, s27, 48
    s_lshl_b32 s57, s75, 2
    s_add_u32 s78, s56, s57
    s_lshl_b32 s56, s28, 2
    s_add_u32 s78, s78, s56
    s_sub_u32 s81, s78, 172
    s_cmp_ge_u32 s78, 172
    s_cselect_b32 s78, s81, s78
    s_mul_i32 s79, s25, 176128
    s_add_u32 s79, s79, 0x1400000
    s_lshl_b32 s80, s28, 12
    v_mfma_f32_32x32x16_bf16 v[32:47], v[176:179], v[16:19], 0
    v_mfma_f32_32x32x16_bf16 v[32:47], v[180:183], v[20:23], v[32:47]
    v_mfma_f32_32x32x16_bf16 v[32:47], v[176:179], v[8:11], v[32:47]
    v_mfma_f32_32x32x16_bf16 v[32:47], v[180:183], v[12:15], v[32:47]
    s_add_u32 s56, s36, 512
    s_nop 0
    s_mov_b32 s69, 0
L_fw_33:
    buffer_load_dwordx2 v[6:7], v187, s[12:15], s56 offen sc1
    s_add_u32 s69, s69, 1
    s_cmp_gt_u32 s69, 200000
    s_cbranch_scc1 L_end
    s_waitcnt vmcnt(0)
    v_xor_b32 v6, s24, v6
    v_bitop3_b32 v6, v7, s24, v6 bitop3:0xbe
    v_cmp_ne_u32 vcc, 0, v6
    s_nop 4
    s_cbranch_vccnz L_fw_33
    s_nop 0
    s_sub_u32 s81, s78, 172
    s_cmp_ge_u32 s78, 172
    s_cselect_b32 s78, s81, s78
    s_lshl_b32 s81, s78, 10
    s_add_u32 s81, s81, s79
    s_add_u32 m0, s80, 0
    s_add_u32 s78, s78, 16
    buffer_load_dwordx4 v4, s[12:15], s81 offen offset:0 sc1 lds
    buffer_load_dwordx4 v4, s[12:15], s81 offen offset:1024 sc1 lds
    buffer_load_dwordx4 v4, s[12:15], s81 offen offset:2048 sc1 lds
    buffer_load_dwordx4 v4, s[12:15], s81 offen offset:3072 sc1 lds
    s_sub_u32 s81, s78, 172
    s_cmp_ge_u32 s78, 172
    s_cselect_b32 s78, s81, s78
    s_lshl_b32 s81, s78, 10
    s_add_u32 s81, s81, s79
    s_add_u32 m0, s80, 16384
    s_add_u32 s78, s78, 16
    buffer_load_dwordx4 v4, s[12:15], s81 offen offset:0 sc1 lds
    buffer_load_dwordx4 v4, s[12:15], s81 offen offset:1024 sc1 lds
    buffer_load_dwordx4 v4, s[12:15], s81 offen offset:2048 sc1 lds
    buffer_load_dwordx4 v4, s[12:15], s81 offen offset:3072 sc1 lds
    s_sub_u32 s81, s78, 172
    s_cmp_ge_u32 s78, 172
    s_cselect_b32 s78, s81, s78
    s_lshl_b32 s81, s78, 10
    s_add_u32 s81, s81, s79
    s_add_u32 m0, s80, 32768
    s_add_u32 s78, s78, 16
    buffer_load_dwordx4 v4, s[12:15], s81 offen offset:0 sc1 lds
    buffer_load_dwordx4 v4, s[12:15], s81 offen offset:1024 sc1 lds
    buffer_load_dwordx4 v4, s[12:15], s81 offen offset:2048 sc1 lds
    buffer_load_dwordx4 v4, s[12:15], s81 offen offset:3072 sc1 lds
    s_waitcnt vmcnt(8)
    s_barrier
    s_sub_u32 s81, s78, 172
    s_cmp_ge_u32 s78, 172
    s_cselect_b32 s78, s81, s78
    s_lshl_b32 s81, s78, 10
    s_add_u32 s81, s81, s79
    s_add_u32 m0, s80, 49152
    s_add_u32 s78, s78, 16
    buffer_load_dwordx4 v4, s[12:15], s81 offen offset:0 sc1 lds
    buffer_load_dwordx4 v4, s[12:15], s81 offen offset:1024 sc1 lds
    buffer_load_dwordx4 v4, s[12:15], s81 offen offset:2048 sc1 lds
    buffer_load_dwordx4 v4, s[12:15], s81 offen offset:3072 sc1 lds
    ds_read_b128 v[64:67], v113 offset:0
    ds_read_b128 v[68:71], v114 offset:0
    ds_read_b128 v[72:75], v113 offset:4096
    ds_read_b128 v[76:79], v114 offset:4096
    ds_read_b128 v[80:83], v113 offset:8192
    ds_read_b128 v[84:87], v114 offset:8192
    ds_read_b128 v[88:91], v113 offset:12288
    ds_read_b128 v[92:95], v114 offset:12288
    s_waitcnt vmcnt(8)
    s_barrier
    s_waitcnt lgkmcnt(7)
    v_mfma_f32_32x32x16_bf16 v[32:47], a[0:3], v[64:67], v[32:47]
    s_sub_u32 s81, s78, 172
    s_cmp_ge_u32 s78, 172
    s_cselect_b32 s78, s81, s78
    s_lshl_b32 s81, s78, 10
    s_add_u32 s81, s81, s79
    s_add_u32 m0, s80, 65536
    s_add_u32 s78, s78, 16
    buffer_load_dwordx4 v4, s[12:15], s81 offen offset:0 sc1 lds
    ds_read_b128 v[128:131], v113 offset:16384
    s_waitcnt lgkmcnt(7)
    v_mfma_f32_32x32x16_bf16 v[48:63], a[0:3], v[68:71], 0
    buffer_load_dwordx4 v4, s[12:15], s81 offen offset:1024 sc1 lds
    ds_read_b128 v[132:135], v114 offset:16384
    ds_read_b128 v[136:139], v113 offset:20480
    s_waitcnt lgkmcnt(8)
    v_mfma_f32_32x32x16_bf16 v[32:47], a[4:7], v[72:75], v[32:47]
    buffer_load_dwordx4 v4, s[12:15], s81 offen offset:2048 sc1 lds
    ds_read_b128 v[140:143], v114 offset:20480
    ds_read_b128 v[144:147], v113 offset:24576
    s_waitcnt lgkmcnt(9)
    v_mfma_f32_32x32x16_bf16 v[48:63], a[4:7], v[76:79], v[48:63]
    buffer_load_dwordx4 v4, s[12:15], s81 offen offset:3072 sc1 lds
    ds_read_b128 v[148:151], v114 offset:24576
    ds_read_b128 v[152:155], v113 offset:28672
    s_waitcnt lgkmcnt(10)
    v_mfma_f32_32x32x16_bf16 v[32:47], a[8:11], v[80:83], v[32:47]
    buffer_load_dwordx4 v[220:223], v4, s[12:15], s72 offen offset:2048 sc1
    ds_read_b128 v[156:159], v114 offset:28672
    s_waitcnt lgkmcnt(10)
    v_mfma_f32_32x32x16_bf16 v[48:63], a[8:11], v[84:87], v[48:63]
    buffer_load_dwordx4 v[224:227], v4, s[12:15], s72 offen offset:3072 sc1
    s_waitcnt lgkmcnt(9)
    v_mfma_f32_32x32x16_bf16 v[32:47], a[12:15], v[88:91], v[32:47]
    s_sub_u32 s72, s71, 43
    s_cmp_ge_u32 s71, 43
    s_cselect_b32 s71, s72, s71
    s_lshl_b32 s72, s71, 10
    s_add_u32 s72, s72, s70
    s_add_u32 s71, s71, 4
    buffer_load_dwordx4 v[228:231], v4, s[12:15], s72 offen offset:0 sc1
    s_waitcnt lgkmcnt(8)
    v_mfma_f32_32x32x16_bf16 v[48:63], a[12:15], v[92:95], v[48:63]
    buffer_load_dwordx4 v[232:235], v4, s[12:15], s72 offen offset:1024 sc1
    s_waitcnt vmcnt(12)
    s_barrier
    s_waitcnt lgkmcnt(7)
    v_mfma_f32_32x32x16_bf16 v[32:47], a[16:19], v[128:131], v[32:47]
    s_sub_u32 s81, s78, 172
    s_cmp_ge_u32 s78, 172
    s_cselect_b32 s78, s81, s78
    s_lshl_b32 s81, s78, 10
    s_add_u32 s81, s81, s79
    s_add_u32 m0, s80, 81920
    s_add_u32 s78, s78, 16
    buffer_load_dwordx4 v4, s[12:15], s81 offen offset:0 sc1 lds
    ds_read_b128 v[64:67], v113 offset:32768
    s_waitcnt lgkmcnt(7)
    v_mfma_f32_32x32x16_bf16 v[48:63], a[16:19], v[132:135], v[48:63]
    buffer_load_dwordx4 v4, s[12:15], s81 offen offset:1024 sc1 lds
    ds_read_b128 v[68:71], v114 offset:32768
    ds_read_b128 v[72:75], v113 offset:36864
    s_waitcnt lgkmcnt(8)
    v_mfma_f32_32x32x16_bf16 v[32:47], a[20:23], v[136:139], v[32:47]
    buffer_load_dwordx4 v4, s[12:15], s81 offen offset:2048 sc1 lds
    ds_read_b128 v[76:79], v114 offset:36864
    ds_read_b128 v[80:83], v113 offset:40960
    s_waitcnt lgkmcnt(9)
    v_mfma_f32_32x32x16_bf16 v[48:63], a[20:23], v[140:143], v[48:63]
    buffer_load_dwordx4 v4, s[12:15], s81 offen offset:3072 sc1 lds
    ds_read_b128 v[84:87], v114 offset:40960
    ds_read_b128 v[88:91], v113 offset:45056
    s_waitcnt lgkmcnt(10)
    v_mfma_f32_32x32x16_bf16 v[32:47], a[24:27], v[144:147], v[32:47]
    buffer_load_dwordx4 v[236:239], v4, s[12:15], s72 offen offset:2048 sc1
    ds_read_b128 v[92:95], v114 offset:45056
    s_waitcnt lgkmcnt(10)
    v_mfma_f32_32x32x16_bf16 v[48:63], a[24:27], v[148:151], v[48:63]
    buffer_load_dwordx4 v[240:243], v4, s[12:15], s72 offen offset:3072 sc1
    s_waitcnt lgkmcnt(9)
    v_mfma_f32_32x32x16_bf16 v[32:47], a[28:31], v[152:155], v[32:47]
    s_sub_u32 s72, s71, 43
    s_cmp_ge_u32 s71, 43
    s_cselect_b32 s71, s72, s71
    s_lshl_b32 s72, s71, 10
    s_add_u32 s72, s72, s70
    s_add_u32 s71, s71, 4
    buffer_load_dwordx4 v[244:247], v4, s[12:15], s72 offen offset:0 sc1
    s_waitcnt lgkmcnt(8)
    v_mfma_f32_32x32x16_bf16 v[48:63], a[28:31], v[156:159], v[48:63]
    buffer_load_dwordx4 v[248:251], v4, s[12:15], s72 offen offset:1024 sc1
    s_waitcnt vmcnt(16)
    s_barrier
    s_waitcnt lgkmcnt(7)
    v_mfma_f32_32x32x16_bf16 v[32:47], a[32:35], v[64:67], v[32:47]
    s_sub_u32 s81, s78, 172
    s_cmp_ge_u32 s78, 172
    s_cselect_b32 s78, s81, s78
    s_lshl_b32 s81, s78, 10
    s_add_u32 s81, s81, s79
    s_add_u32 m0, s80, 98304
    s_add_u32 s78, s78, 16
    buffer_load_dwordx4 v4, s[12:15], s81 offen offset:0 sc1 lds
    ds_read_b128 v[128:131], v113 offset:49152
    s_waitcnt lgkmcnt(7)
    v_mfma_f32_32x32x16_bf16 v[48:63], a[32:35], v[68:71], v[48:63]
    ds_read_b128 v[132:135], v114 offset:49152
    ds_read_b128 v[136:139], v113 offset:53248
    s_waitcnt lgkmcnt(8)
    v_mfma_f32_32x32x16_bf16 v[32:47], a[36:39], v[72:75], v[32:47]
    buffer_load_dwordx4 v4, s[12:15], s81 offen offset:1024 sc1 lds
    ds_read_b128 v[140:143], v114 offset:53248
    ds_read_b128 v[144:147], v113 offset:57344
    s_waitcnt lgkmcnt(9)
    v_mfma_f32_32x32x16_bf16 v[48:63], a[36:39], v[76:79], v[48:63]
    ds_read_b128 v[148:151], v114 offset:57344
    ds_read_b128 v[152:155], v113 offset:61440
    s_waitcnt lgkmcnt(10)
    v_mfma_f32_32x32x16_bf16 v[32:47], a[40:43], v[80:83], v[32:47]
    buffer_load_dwordx4 v4, s[12:15], s81 offen offset:2048 sc1 lds
    ds_read_b128 v[156:159], v114 offset:61440
    s_waitcnt lgkmcnt(10)
    v_mfma_f32_32x32x16_bf16 v[48:63], a[40:43], v[84:87], v[48:63]
    buffer_load_dwordx4 v4, s[12:15], s81 offen offset:3072 sc1 lds
    s_waitcnt lgkmcnt(9)
    v_mfma_f32_32x32x16_bf16 v[32:47], a[44:47], v[88:91], v[32:47]
    s_waitcnt lgkmcnt(8)
    v_mfma_f32_32x32x16_bf16 v[48:63], a[44:47], v[92:95], v[48:63]
    buffer_load_dwordx4 v[252:255], v4, s[12:15], s72 offen offset:2048 sc1
    s_waitcnt vmcnt(17)
    s_barrier
    s_waitcnt lgkmcnt(7)
    v_mfma_f32_32x32x16_bf16 v[32:47], a[48:51], v[128:131], v[32:47]
    s_sub_u32 s81, s78, 172
    s_cmp_ge_u32 s78, 172
    s_cselect_b32 s78, s81, s78
    s_lshl_b32 s81, s78, 10
    s_add_u32 s81, s81, s79
    s_add_u32 m0, s80, 114688
    s_add_u32 s78, s78, 16
    buffer_load_dwordx4 v4, s[12:15], s81 offen offset:0 sc1 lds
    ds_read_b128 v[64:67], v123 offset:0
    s_waitcnt lgkmcnt(7)
    v_mfma_f32_32x32x16_bf16 v[48:63], a[48:51], v[132:135], v[48:63]
    ds_read_b128 v[68:71], v124 offset:0
    ds_read_b128 v[72:75], v123 offset:4096
    s_waitcnt lgkmcnt(8)
    v_mfma_f32_32x32x16_bf16 v[32:47], a[52:55], v[136:139], v[32:47]
    buffer_load_dwordx4 v4, s[12:15], s81 offen offset:1024 sc1 lds
    ds_read_b128 v[76:79], v124 offset:4096
    ds_read_b128 v[80:83], v123 offset:8192
    s_waitcnt lgkmcnt(9)
    v_mfma_f32_32x32x16_bf16 v[48:63], a[52:55], v[140:143], v[48:63]
    ds_read_b128 v[84:87], v124 offset:8192
    ds_read_b128 v[88:91], v123 offset:12288
    s_waitcnt lgkmcnt(10)
    v_mfma_f32_32x32x16_bf16 v[32:47], a[56:59], v[144:147], v[32:47]
    buffer_load_dwordx4 v4, s[12:15], s81 offen offset:2048 sc1 lds
    ds_read_b128 v[92:95], v124 offset:12288
    s_waitcnt lgkmcnt(10)
    v_mfma_f32_32x32x16_bf16 v[48:63], a[56:59], v[148:151], v[48:63]
    s_waitcnt lgkmcnt(9)
    v_mfma_f32_32x32x16_bf16 v[32:47], a[60:63], v[152:155], v[32:47]
    buffer_load_dwordx4 v4, s[12:15], s81 offen offset:3072 sc1 lds
    s_waitcnt lgkmcnt(8)
    v_mfma_f32_32x32x16_bf16 v[48:63], a[60:63], v[156:159], v[48:63]
    s_waitcnt vmcnt(13)
    s_barrier
    s_waitcnt lgkmcnt(7)
    v_mfma_f32_32x32x16_bf16 v[32:47], a[64:67], v[64:67], v[32:47]
    s_sub_u32 s81, s78, 172
    s_cmp_ge_u32 s78, 172
    s_cselect_b32 s78, s81, s78
    s_lshl_b32 s81, s78, 10
    s_add_u32 s81, s81, s79
    s_add_u32 m0, s80, 131072
    s_add_u32 s78, s78, 16
    buffer_load_dwordx4 v4, s[12:15], s81 offen offset:0 sc1 lds
    ds_read_b128 v[128:131], v123 offset:16384
    s_waitcnt lgkmcnt(7)
    v_mfma_f32_32x32x16_bf16 v[48:63], a[64:67], v[68:71], v[48:63]
    ds_read_b128 v[132:135], v124 offset:16384
    ds_read_b128 v[136:139], v123 offset:20480
    s_waitcnt lgkmcnt(8)
    v_mfma_f32_32x32x16_bf16 v[32:47], a[68:71], v[72:75], v[32:47]
    buffer_load_dwordx4 v4, s[12:15], s81 offen offset:1024 sc1 lds
    ds_read_b128 v[140:143], v124 offset:20480
    ds_read_b128 v[144:147], v123 offset:24576
    s_waitcnt lgkmcnt(9)
    v_mfma_f32_32x32x16_bf16 v[48:63], a[68:71], v[76:79], v[48:63]
    ds_read_b128 v[148:151], v124 offset:24576
    ds_read_b128 v[152:155], v123 offset:28672
    s_waitcnt lgkmcnt(10)
    v_mfma_f32_32x32x16_bf16 v[32:47], a[72:75], v[80:83], v[32:47]
    buffer_load_dwordx4 v4, s[12:15], s81 offen offset:2048 sc1 lds
    ds_read_b128 v[156:159], v124 offset:28672
    s_waitcnt lgkmcnt(10)
    v_mfma_f32_32x32x16_bf16 v[48:63], a[72:75], v[84:87], v[48:63]
    s_waitcnt lgkmcnt(9)
    v_mfma_f32_32x32x16_bf16 v[32:47], a[76:79], v[88:91], v[32:47]
    buffer_load_dwordx4 v4, s[12:15], s81 offen offset:3072 sc1 lds
    s_waitcnt lgkmcnt(8)
    v_mfma_f32_32x32x16_bf16 v[48:63], a[76:79], v[92:95], v[48:63]
    s_waitcnt vmcnt(9)
    s_barrier
    s_waitcnt lgkmcnt(7)
    v_mfma_f32_32x32x16_bf16 v[32:47], a[80:83], v[128:131], v[32:47]
    s_sub_u32 s81, s78, 172
    s_cmp_ge_u32 s78, 172
    s_cselect_b32 s78, s81, s78
    s_lshl_b32 s81, s78, 10
    s_add_u32 s81, s81, s79
    s_add_u32 s82, s80, 147456
    s_sub_u32 s83, s82, 155648
    s_cmp_ge_u32 s28, 2
    s_cselect_b32 m0, s83, s82
    s_add_u32 s78, s78, 16
    buffer_load_dwordx4 v4, s[12:15], s81 offen offset:0 sc1 lds
    ds_read_b128 v[64:67], v123 offset:32768
    s_waitcnt lgkmcnt(7)
    v_mfma_f32_32x32x16_bf16 v[48:63], a[80:83], v[132:135], v[48:63]
    ds_read_b128 v[68:71], v124 offset:32768
    ds_read_b128 v[72:75], v123 offset:36864
    s_waitcnt lgkmcnt(8)
    v_mfma_f32_32x32x16_bf16 v[32:47], a[84:87], v[136:139], v[32:47]
    buffer_load_dwordx4 v4, s[12:15], s81 offen offset:1024 sc1 lds
    ds_read_b128 v[76:79], v124 offset:36864
    ds_read_b128 v[80:83], v123 offset:40960
    s_waitcnt lgkmcnt(9)
    v_mfma_f32_32x32x16_bf16 v[48:63], a[84:87], v[140:143], v[48:63]
    ds_read_b128 v[84:87], v124 offset:40960
    ds_read_b128 v[88:91], v123 offset:45056
    s_waitcnt lgkmcnt(10)
    v_mfma_f32_32x32x16_bf16 v[32:47], a[88:91], v[144:147], v[32:47]
    buffer_load_dwordx4 v4, s[12:15], s81 offen offset:2048 sc1 lds
    ds_read_b128 v[92:95], v124 offset:45056
    s_waitcnt lgkmcnt(10)
    v_mfma_f32_32x32x16_bf16 v[48:63], a[88:91], v[148:151], v[48:63]
    s_waitcnt lgkmcnt(9)
    v_mfma_f32_32x32x16_bf16 v[32:47], a[92:95], v[152:155], v[32:47]
    buffer_load_dwordx4 v4, s[12:15], s81 offen offset:3072 sc1 lds
    s_waitcnt lgkmcnt(8)
    v_mfma_f32_32x32x16_bf16 v[48:63], a[92:95], v[156:159], v[48:63]
    s_waitcnt vmcnt(8)
    s_barrier
    s_waitcnt lgkmcnt(7)
    v_mfma_f32_32x32x16_bf16 v[32:47], a[96:99], v[64:67], v[32:47]
    s_sub_u32 s81, s78, 172
    s_cmp_ge_u32 s78, 172
    s_cselect_b32 s78, s81, s78
    s_lshl_b32 s81, s78, 10
    s_add_u32 s81, s81, s79
    s_add_u32 m0, s80, 8192
    s_add_u32 s82, s78, 168
    s_sub_u32 s83, s82, 172
    s_cmp_ge_u32 s82, 172
    s_cselect_b32 s82, s83, s82
    s_cmp_eq_u32 s28, 3
    s_cselect_b32 s82, s82, s78
    s_lshl_b32 s81, s82, 10
    s_add_u32 s81, s81, s79
    s_cmp_eq_u32 s28, 3
    s_cselect_b32 s82, 4096, 0
    s_sub_u32 m0, m0, s82
    s_add_u32 s78, s78, 16
    buffer_load_dwordx4 v4, s[12:15], s81 offen offset:0 sc1 lds
    ds_read_b128 v[128:131], v123 offset:49152
    s_waitcnt lgkmcnt(7)
    v_mfma_f32_32x32x16_bf16 v[48:63], a[96:99], v[68:71], v[48:63]
    ds_read_b128 v[132:135], v124 offset:49152
    ds_read_b128 v[136:139], v123 offset:53248
    s_waitcnt lgkmcnt(8)
    v_mfma_f32_32x32x16_bf16 v[32:47], a[100:103], v[72:75], v[32:47]
    buffer_load_dwordx4 v4, s[12:15], s81 offen offset:1024 sc1 lds
    ds_read_b128 v[140:143], v124 offset:53248
    ds_read_b128 v[144:147], v123 offset:57344
    s_waitcnt lgkmcnt(9)
    v_mfma_f32_32x32x16_bf16 v[48:63], a[100:103], v[76:79], v[48:63]
    ds_read_b128 v[148:151], v124 offset:57344
    ds_read_b128 v[152:155], v123 offset:61440
    s_waitcnt lgkmcnt(10)
    v_mfma_f32_32x32x16_bf16 v[32:47], a[104:107], v[80:83], v[32:47]
    buffer_load_dwordx4 v4, s[12:15], s81 offen offset:2048 sc1 lds
    ds_read_b128 v[156:159], v124 offset:61440
    s_waitcnt lgkmcnt(10)
    v_mfma_f32_32x32x16_bf16 v[48:63], a[104:107], v[84:87], v[48:63]
    s_waitcnt lgkmcnt(9)
    v_mfma_f32_32x32x16_bf16 v[32:47], a[108:111], v[88:91], v[32:47]
    buffer_load_dwordx4 v4, s[12:15], s81 offen offset:3072 sc1 lds
    s_waitcnt lgkmcnt(8)
    v_mfma_f32_32x32x16_bf16 v[48:63], a[108:111], v[92:95], v[48:63]
    s_waitcnt vmcnt(8)
    s_barrier
    s_waitcnt lgkmcnt(7)
    v_mfma_f32_32x32x16_bf16 v[32:47], a[112:115], v[128:131], v[32:47]
    ds_read_b128 v[64:67], v125 offset:0
    s_waitcnt lgkmcnt(7)
    v_mfma_f32_32x32x16_bf16 v[48:63], a[112:115], v[132:135], v[48:63]
    ds_read_b128 v[68:71], v122 offset:0
    ds_read_b128 v[72:75], v125 offset:4096
    s_waitcnt lgkmcnt(8)
    v_mfma_f32_32x32x16_bf16 v[32:47], v[200:203], v[136:139], v[32:47]
    s_lshl_b32 s56, s28, 14
    s_add_u32 s57, s56, s31
    s_add_u32 s57, s57, s61
    v_lshrrev_b32 v7, 2, v1
    v_lshlrev_b32 v7, 10, v7
    v_and_b32 v6, 3, v1
    v_lshl_add_u32 v7, v6, 5, v7
    s_mov_b32 m0, 163584
    s_nop 0
    buffer_load_dword v7, s[20:23], s57 offen lds
    ds_read_b128 v[76:79], v122 offset:4096
    ds_read_b128 v[80:83], v125 offset:8192
    s_waitcnt lgkmcnt(9)
    v_mfma_f32_32x32x16_bf16 v[48:63], v[200:203], v[140:143], v[48:63]
    ds_read_b128 v[84:87], v122 offset:8192
    ds_read_b128 v[88:91], v125 offset:12288
    s_waitcnt lgkmcnt(10)
    v_mfma_f32_32x32x16_bf16 v[32:47], v[204:207], v[144:147], v[32:47]
    ds_read_b128 v[92:95], v122 offset:12288
    s_waitcnt lgkmcnt(10)
    v_mfma_f32_32x32x16_bf16 v[48:63], v[204:207], v[148:151], v[48:63]
    s_waitcnt lgkmcnt(9)
    v_mfma_f32_32x32x16_bf16 v[32:47], v[208:211], v[152:155], v[32:47]
    s_waitcnt lgkmcnt(8)
    v_mfma_f32_32x32x16_bf16 v[48:63], v[208:211], v[156:159], v[48:63]
    s_waitcnt vmcnt(5)
    s_barrier
    s_waitcnt lgkmcnt(7)
    v_mfma_f32_32x32x16_bf16 v[32:47], v[212:215], v[64:67], v[32:47]
    ds_read_b128 v[128:131], v125 offset:16384
    s_waitcnt lgkmcnt(7)
    v_mfma_f32_32x32x16_bf16 v[48:63], v[212:215], v[68:71], v[48:63]
    ds_read_b128 v[132:135], v122 offset:16384
    ds_read_b128 v[136:139], v125 offset:20480
    s_waitcnt lgkmcnt(8)
    v_mfma_f32_32x32x16_bf16 v[32:47], v[216:219], v[72:75], v[32:47]
    ds_read_b128 v[140:143], v122 offset:20480
    ds_read_b128 v[144:147], v113 offset:0
    s_waitcnt lgkmcnt(9)
    v_mfma_f32_32x32x16_bf16 v[48:63], v[216:219], v[76:79], v[48:63]
    ds_read_b128 v[148:151], v114 offset:0
    ds_read_b128 v[152:155], v113 offset:4096
    s_waitcnt lgkmcnt(10)
    v_mfma_f32_32x32x16_bf16 v[32:47], v[220:223], v[80:83], v[32:47]
    ds_read_b128 v[156:159], v114 offset:4096
    s_waitcnt lgkmcnt(10)
    v_mfma_f32_32x32x16_bf16 v[48:63], v[220:223], v[84:87], v[48:63]
    s_waitcnt lgkmcnt(9)
    v_mfma_f32_32x32x16_bf16 v[32:47], v[224:227], v[88:91], v[32:47]
    s_waitcnt lgkmcnt(8)
    v_mfma_f32_32x32x16_bf16 v[48:63], v[224:227], v[92:95], v[48:63]
    s_waitcnt vmcnt(1)
    s_barrier
    s_waitcnt lgkmcnt(7)
    v_mfma_f32_32x32x16_bf16 v[32:47], v[228:231], v[128:131], v[32:47]
    ds_read_b128 v[64:67], v113 offset:8192
    s_waitcnt lgkmcnt(7)
    v_mfma_f32_32x32x16_bf16 v[48:63], v[228:231], v[132:135], v[48:63]
    ds_read_b128 v[68:71], v114 offset:8192
    s_waitcnt lgkmcnt(7)
    v_mfma_f32_32x32x16_bf16 v[32:47], v[232:235], v[136:139], v[32:47]
    ds_read_b128 v[72:75], v113 offset:12288
    ds_read_b128 v[76:79], v114 offset:12288
    s_waitcnt lgkmcnt(8)
    v_mfma_f32_32x32x16_bf16 v[48:63], v[232:235], v[140:143], v[48:63]
    ds_read_b128 v[80:83], v113 offset:16384
    s_waitcnt lgkmcnt(8)
    v_mfma_f32_32x32x16_bf16 v[32:47], v[236:239], v[144:147], v[32:47]
    ds_read_b128 v[84:87], v114 offset:16384
    s_waitcnt lgkmcnt(8)
    v_mfma_f32_32x32x16_bf16 v[48:63], v[236:239], v[148:151], v[48:63]
    s_waitcnt lgkmcnt(7)
    v_mfma_f32_32x32x16_bf16 v[32:47], v[240:243], v[152:155], v[32:47]
    s_waitcnt lgkmcnt(6)
    v_mfma_f32_32x32x16_bf16 v[48:63], v[240:243], v[156:159], v[48:63]
    s_waitcnt lgkmcnt(5)
    v_mfma_f32_32x32x16_bf16 v[32:47], v[244:247], v[64:67], v[32:47]
    s_waitcnt lgkmcnt(4)
    v_mfma_f32_32x32x16_bf16 v[48:63], v[244:247], v[68:71], v[48:63]
    s_waitcnt lgkmcnt(3)
    v_mfma_f32_32x32x16_bf16 v[32:47], v[248:251], v[72:75], v[32:47]
    s_waitcnt lgkmcnt(2)
    v_mfma_f32_32x32x16_bf16 v[48:63], v[248:251], v[76:79], v[48:63]
    s_waitcnt lgkmcnt(1)
    v_mfma_f32_32x32x16_bf16 v[32:47], v[252:255], v[80:83], v[32:47]
    s_waitcnt lgkmcnt(0)
    v_mfma_f32_32x32x16_bf16 v[48:63], v[252:255], v[84:87], v[48:63]
    s_barrier
    s_nop 10
    ds_write_b128 v115, v[48:51] offset:0
    ds_write_b128 v115, v[52:55] offset:1024
    ds_write_b128 v115, v[56:59] offset:2048
    ds_write_b128 v115, v[60:63] offset:3072
    s_waitcnt lgkmcnt(0)
    s_barrier
    ds_read_b128 v[48:51], v116 offset:0
    ds_read_b128 v[52:55], v116 offset:1024
    ds_read_b128 v[56:59], v116 offset:2048
    ds_read_b128 v[60:63], v116 offset:3072
    s_waitcnt lgkmcnt(3)
    v_pk_add_f32 v[32:33], v[32:33], v[48:49]
    v_pk_add_f32 v[34:35], v[34:35], v[50:51]
    s_waitcnt lgkmcnt(2)
    v_pk_add_f32 v[36:37], v[36:37], v[52:53]
    v_pk_add_f32 v[38:39], v[38:39], v[54:55]
    s_waitcnt lgkmcnt(1)
    v_pk_add_f32 v[40:41], v[40:41], v[56:57]
    v_pk_add_f32 v[42:43], v[42:43], v[58:59]
    s_waitcnt lgkmcnt(0)
    v_pk_add_f32 v[44:45], v[44:45], v[60:61]
    v_pk_add_f32 v[46:47], v[46:47], v[62:63]
    v_cvt_pk_bf16_f32 v64, v32, v33
    v_cvt_pk_bf16_f32 v65, v34, v35
    v_cvt_pk_bf16_f32 v66, v36, v37
    v_cvt_pk_bf16_f32 v67, v38, v39
    v_cvt_pk_bf16_f32 v68, v40, v41
    v_cvt_pk_bf16_f32 v69, v42, v43
    v_cvt_pk_bf16_f32 v70, v44, v45
    v_cvt_pk_bf16_f32 v71, v46, v47
    s_lshl_b32 s56, s62, 5
    v_add_u32 v5, s56, v2
    v_lshlrev_b32 v5, 10, v5
    v_lshl_add_u32 v5, v3, 4, v5
    v_permlane32_swap_b32 v64, v66
    v_permlane32_swap_b32 v65, v67
    v_permlane32_swap_b32 v68, v70
    v_permlane32_swap_b32 v69, v71
    buffer_store_dwordx4 v[64:67], v5, s[20:23], s88 offen
    buffer_store_dwordx4 v[68:71], v5, s[20:23], s88 offen offset:32
    s_endpgm
L_end:
    s_endpgm

.section .rodata,"a"
.p2align 6
.amdhsa_kernel sequential_preLN__linear_kernel_hedgehog__mixer_s_mlp__prompt_kernel
  .amdhsa_next_free_vgpr 512
  .amdhsa_next_free_sgpr 102
  .amdhsa_accum_offset 256
  .amdhsa_group_segment_fixed_size 0
  .amdhsa_kernarg_size 96
  .amdhsa_user_sgpr_count 2
  .amdhsa_user_sgpr_kernarg_segment_ptr 1
  .amdhsa_system_sgpr_workgroup_id_x 1
.end_amdhsa_kernel
```
